```python
import torch

def _softmax(x, axis=-1):
    return torch.softmax(x, dim=axis)
def _gelu(x):
    return torch.nn.functional.gelu(x, approximate="tanh")
def _silu(x):
    return torch.nn.functional.silu(x)
def _sigmoid(x):
    return torch.sigmoid(x)
def _layernorm(x, axis=-1, eps=1e-5):
    m = x.mean(dim=axis, keepdim=True)
    v = x.var(dim=axis, keepdim=True, unbiased=False)
    return (x - m) / torch.sqrt(v + eps)
def _scatter_add(tgt, idx, src, axis=0):
    return tgt.clone().index_add_(axis, idx, src)
def _segment_sum(src, seg, n):
    out = torch.zeros((n,) + src.shape[1:], dtype=src.dtype)
    return out.index_add_(0, seg, src)
def _pad(x, pw):
    flat = tuple(v for pair in reversed(pw) for v in pair)
    return torch.nn.functional.pad(x, flat)

kernel_name = 'concat_heads__softmax_full_mha__ssm_conv_h3__prompt'

def setup_inputs():

    _w = (lambda a: (lambda t: t.to(torch.bfloat16) if t.is_floating_point() else t)(torch.as_tensor(a)))
    def _A_setup():
        B, S, D = 1, 2048, 640
        return {
            "x": _w((lambda *s: torch.randn(*s, dtype=torch.bfloat16) * 0.2)(B, S, D)),
            "wqkv": _w((lambda *s: torch.randn(*s, dtype=torch.bfloat16) * 0.2)(D, 3 * D)),
            "wo": _w((lambda *s: torch.randn(*s, dtype=torch.bfloat16) * 0.05)(D, D)),
        }
    _A_in = _A_setup()

    def _B_setup():
        B, S, D = 1, 2048, 640
        ks = 4
        return {
            "q": _w((lambda *s: torch.randn(*s, dtype=torch.bfloat16) * 0.05)(B, S, D)),
            "k": _w((lambda *s: torch.randn(*s, dtype=torch.bfloat16) * 0.4)(B, S, D)),
            "v": _w((lambda *s: torch.randn(*s, dtype=torch.bfloat16) * 0.4)(B, S, D)),
            "shift_k": _w((lambda *s: torch.randn(*s, dtype=torch.bfloat16) * 0.4)(D, ks) * 0.5),
            "ssm_k": _w((lambda *s: torch.randn(*s, dtype=torch.bfloat16) * 1.6)(D, S) * (1.0 / S ** 0.5)),
            "ssm_D": _w((lambda *s: torch.randn(*s, dtype=torch.bfloat16) * 0.4)(D)),
        }
    _B_in = _B_setup()

    return {
        "A_x": _A_in["x"],
        "A_wqkv": _A_in["wqkv"],
        "A_wo": _A_in["wo"],
        "B_q": _B_in["q"],
        "B_k": _B_in["k"],
        "B_v": _B_in["v"],
        "B_shift_k": _B_in["shift_k"],
        "B_ssm_k": _B_in["ssm_k"],
        "B_ssm_D": _B_in["ssm_D"],
    }

def reference(A_x, A_wqkv, A_wo, B_q, B_k, B_v, B_shift_k, B_ssm_k, B_ssm_D):
    def _A_ref(x, wqkv, wo):
        B, S, D = x.shape
        H = 32; Dh = D // H
        qkv = (lambda x, *d: x.permute(*d))((x @ wqkv).reshape(B, S, 3, H, Dh), 2, 0, 3, 1, 4)
        q, k, v = qkv[0], qkv[1], qkv[2]
        scale = Dh ** -0.5
        scores = torch.einsum("bhqd,bhkd->bhqk", q, k) * scale
        p = _softmax(scores, axis=-1)
        o = torch.einsum("bhqk,bhkd->bhqd", p, v)
        return (lambda x, *d: x.permute(*d))(o, 0, 2, 1, 3).reshape(B, S, D) @ wo

    def _B_ref(q, k, v, shift_k, ssm_k, ssm_D):
        B, S, D = q.shape
        ks = shift_k.shape[-1]
        k_pad = _pad(k, ((0, 0), (ks - 1, 0), (0, 0)))
        k_shift = torch.zeros_like(k)
        for t in range(ks):
            k_shift = k_shift + k_pad[:, t:t + S, :] * shift_k[:, ks - 1 - t][None, None, :]
        kv = k_shift * v
        L = 2 * S
        kv_pad = _pad(kv, ((0, 0), (0, S), (0, 0)))
        kf_pad = _pad(ssm_k, ((0, 0), (0, S)))
        kv_f = (lambda x, axes=(-2,-1): torch.fft.rfft2(x.float(), dim=axes))(kv_pad[:, None, :, :], axes=(1, 2))
        kf_f = (lambda x, axes=(-2,-1): torch.fft.rfft2(x.float(), dim=axes))(kf_pad[:, None, :], axes=(1, 2))
        kf_f = (lambda x, *d: x.permute(*d))(kf_f, 1, 2, 0)
        y_f = kv_f * kf_f[None, :, :, :]
        y = (lambda x, s, axes=(-2,-1): torch.fft.irfft2(x, s=s, dim=axes).to(torch.bfloat16))(y_f, (1, L), axes=(1, 2))[:, 0, :S, :]
        y = y + kv * ssm_D[None, None, :]
        return q * y

    a = _A_ref(A_x, A_wqkv, A_wo)
    b = _B_ref(B_q, B_k, B_v, B_shift_k, B_ssm_k, B_ssm_D)
    return torch.concatenate([a, b], axis=-1)
```

```asm
; @launch grid=(256,1,1) block=(704,1,1) lds=162304
.amdgcn_target "amdgcn-amd-amdhsa--gfx950"
.text
.globl concat_heads__softmax_full_mha__ssm_conv_h3__prompt_kernel
.p2align 8
.type concat_heads__softmax_full_mha__ssm_conv_h3__prompt_kernel,@function
concat_heads__softmax_full_mha__ssm_conv_h3__prompt_kernel:
    s_cmp_ge_u32 s2, 256
    s_cbranch_scc1 L_exit
    s_load_dwordx16 s[4:19], s[0:1], 0
    s_load_dwordx8 s[20:27], s[0:1], 64
    v_lshrrev_b32 v1, 6, v0
    v_and_b32 v0, 63, v0
    v_readfirstlane_b32 s40, v1
    s_and_b32 s41, s2, 7
    s_lshr_b32 s42, s2, 3
    s_lshr_b32 s43, s41, 1
    s_lshl_b32 s43, s43, 2
    s_and_b32 s49, s42, 3
    s_add_u32 s43, s43, s49
    s_and_b32 s48, s41, 1
    s_lshl_b32 s48, s48, 3
    s_lshr_b32 s49, s42, 2
    s_add_u32 s48, s48, s49
    s_cmp_lg_u32 s40, 0
    s_cbranch_scc1 L_noldsinit
    v_mov_b32 v2, 162048
    v_mov_b32 v4, 0
    v_mov_b32 v5, 0
    v_mov_b32 v6, 0
    v_mov_b32 v7, 0
    ds_write_b128 v2, v[4:7]
    ds_write_b128 v2, v[4:7] offset:16
    ds_write_b128 v2, v[4:7] offset:32
L_noldsinit:
    s_waitcnt lgkmcnt(0)
    s_barrier
    s_mov_b32 s28, s26
    s_mov_b32 s29, s27
    s_mov_b32 s30, 0x1214000
    s_mov_b32 s31, 0x00020000
    s_cmp_ge_u32 s40, 8
    s_cbranch_scc1 L_bw
    s_cmp_ge_u32 s48, 15
    s_cbranch_scc1 L_nog
    s_cmp_ge_u32 s40, 4
    s_cbranch_scc1 L_prod
    s_branch L_cons
L_prod:
    s_mov_b32 s32, s4
    s_mov_b32 s33, s5
    s_mov_b32 s34, 0x280000
    s_mov_b32 s35, 0x00020000
    s_mov_b32 s36, s6
    s_mov_b32 s37, s7
    s_mov_b32 s38, 0x258000
    s_mov_b32 s39, 0x00020000
    s_sub_u32 s55, s40, 4
    s_lshl_b32 s49, s55, 12
    s_mul_i32 s53, s55, 61440
    s_and_b32 s50, s43, 3
    s_mul_i32 s50, s50, 3
    s_add_u32 s50, s50, s48
    s_cmp_ge_u32 s50, 20
    s_cselect_b32 s51, 20, 0
    s_sub_u32 s50, s50, s51
    s_cmp_ge_u32 s50, 10
    s_cselect_b32 s51, 10, 0
    s_sub_u32 s50, s50, s51
    s_lshl_b32 s51, s50, 7
    s_mul_i32 s52, s50, 245760
    s_add_u32 s52, s52, s53
    v_lshrrev_b32 v2, 3, v0
    v_lshrrev_b32 v3, 4, v0
    v_and_b32 v4, 7, v0
    v_xor_b32 v4, v4, v3
    s_lshl_b32 s54, s43, 7
    s_lshl_b32 s55, s55, 5
    s_add_u32 s54, s54, s55
    v_add_u32 v2, s54, v2
    v_mul_u32_u24 v2, 1280, v2
    v_lshl_add_u32 v10, v4, 4, v2
    v_xor_b32 v11, 64, v10
    v_and_b32 v4, 15, v0
    v_lshlrev_b32 v5, 2, v3
    v_xor_b32 v4, v4, v5
    v_mul_u32_u24 v5, 3840, v3
    v_lshl_add_u32 v12, v4, 4, v5
    s_lshl_b32 s54, s48, 8
    v_add_u32 v12, s54, v12
    s_add_u32 m0, s49, 65536
    s_add_u32 s54, s51, 0
    buffer_load_dwordx4 v10, s[32:35], s54 offen lds
    s_add_u32 m0, s49, 66560
    s_add_u32 s54, s51, 10240
    buffer_load_dwordx4 v11, s[32:35], s54 offen lds
    s_add_u32 m0, s49, 67584
    s_add_u32 s54, s51, 20480
    buffer_load_dwordx4 v10, s[32:35], s54 offen lds
    s_add_u32 m0, s49, 68608
    s_add_u32 s54, s51, 30720
    buffer_load_dwordx4 v11, s[32:35], s54 offen lds
    s_add_u32 m0, s49, 81920
    s_add_u32 s54, s52, 0
    buffer_load_dwordx4 v12, s[36:39], s54 offen lds
    s_add_u32 m0, s49, 82944
    s_add_u32 s54, s52, 15360
    buffer_load_dwordx4 v12, s[36:39], s54 offen lds
    s_add_u32 m0, s49, 83968
    s_add_u32 s54, s52, 30720
    buffer_load_dwordx4 v12, s[36:39], s54 offen lds
    s_add_u32 m0, s49, 84992
    s_add_u32 s54, s52, 46080
    buffer_load_dwordx4 v12, s[36:39], s54 offen lds
    s_add_u32 s50, s50, 1
    s_cmp_eq_u32 s50, 10
    s_cselect_b32 s50, 0, s50
    s_lshl_b32 s51, s50, 7
    s_mul_i32 s52, s50, 245760
    s_add_u32 s52, s52, s53
    s_add_u32 m0, s49, 0
    s_add_u32 s54, s51, 0
    buffer_load_dwordx4 v10, s[32:35], s54 offen lds
    s_add_u32 m0, s49, 1024
    s_add_u32 s54, s51, 10240
    buffer_load_dwordx4 v11, s[32:35], s54 offen lds
    s_add_u32 m0, s49, 2048
    s_add_u32 s54, s51, 20480
    buffer_load_dwordx4 v10, s[32:35], s54 offen lds
    s_add_u32 m0, s49, 3072
    s_add_u32 s54, s51, 30720
    buffer_load_dwordx4 v11, s[32:35], s54 offen lds
    s_add_u32 m0, s49, 16384
    s_add_u32 s54, s52, 0
    buffer_load_dwordx4 v12, s[36:39], s54 offen lds
    s_add_u32 m0, s49, 17408
    s_add_u32 s54, s52, 15360
    buffer_load_dwordx4 v12, s[36:39], s54 offen lds
    s_add_u32 m0, s49, 18432
    s_add_u32 s54, s52, 30720
    buffer_load_dwordx4 v12, s[36:39], s54 offen lds
    s_add_u32 m0, s49, 19456
    s_add_u32 s54, s52, 46080
    buffer_load_dwordx4 v12, s[36:39], s54 offen lds
    s_add_u32 s50, s50, 1
    s_cmp_eq_u32 s50, 10
    s_cselect_b32 s50, 0, s50
    s_lshl_b32 s51, s50, 7
    s_mul_i32 s52, s50, 245760
    s_add_u32 s52, s52, s53
    s_add_u32 m0, s49, 32768
    s_add_u32 s54, s51, 0
    buffer_load_dwordx4 v10, s[32:35], s54 offen lds
    s_add_u32 m0, s49, 33792
    s_add_u32 s54, s51, 10240
    buffer_load_dwordx4 v11, s[32:35], s54 offen lds
    s_add_u32 m0, s49, 34816
    s_add_u32 s54, s51, 20480
    buffer_load_dwordx4 v10, s[32:35], s54 offen lds
    s_add_u32 m0, s49, 35840
    s_add_u32 s54, s51, 30720
    buffer_load_dwordx4 v11, s[32:35], s54 offen lds
    s_add_u32 m0, s49, 49152
    s_add_u32 s54, s52, 0
    buffer_load_dwordx4 v12, s[36:39], s54 offen lds
    s_add_u32 m0, s49, 50176
    s_add_u32 s54, s52, 15360
    buffer_load_dwordx4 v12, s[36:39], s54 offen lds
    s_add_u32 m0, s49, 51200
    s_add_u32 s54, s52, 30720
    buffer_load_dwordx4 v12, s[36:39], s54 offen lds
    s_add_u32 m0, s49, 52224
    s_add_u32 s54, s52, 46080
    buffer_load_dwordx4 v12, s[36:39], s54 offen lds
    s_add_u32 s50, s50, 1
    s_cmp_eq_u32 s50, 10
    s_cselect_b32 s50, 0, s50
    s_lshl_b32 s51, s50, 7
    s_mul_i32 s52, s50, 245760
    s_add_u32 s52, s52, s53
    s_branch L_prod1
L_bw:
    s_cmp_ge_u32 s48, 15
    s_cbranch_scc1 L_bnog_54
    s_cmp_eq_u32 s40, 10
    s_cbranch_scc1 L_b2_59
    s_lshl_b32 s56, s2, 1
    s_sub_u32 s57, s40, 8
    s_add_u32 s56, s56, s57
    s_mul_i32 s57, s56, 52429
    s_lshr_b32 s57, s57, 19
    s_mul_i32 s58, s57, 10
    s_sub_u32 s58, s56, s58
    v_and_b32 v2, 7, v0
    v_lshrrev_b32 v3, 3, v0
    v_lshlrev_b32 v12, 6, v2
    v_lshl_add_u32 v12, v3, 3, v12
    s_lshl_b32 s54, s56, 12
    s_add_u32 s54, s54, 8388608
    v_add_u32 v12, s54, v12
    s_lshl_b32 s54, s58, 6
    v_lshl_add_u32 v2, v2, 3, s54
    s_lshl_b32 s55, s57, 5
    v_lshl_add_u32 v3, v3, 2, s55
    v_mul_u32_u24 v4, 1280, v3
    v_lshl_add_u32 v10, v2, 1, v4
    v_lshlrev_b32 v11, 3, v2
    v_subrev_u32 v5, 3840, v10
    v_subrev_u32 v6, 2560, v10
    v_subrev_u32 v7, 1280, v10
    s_branch L_bcont_60
L_b2_59:
    s_cmp_ge_u32 s2, 128
    s_cbranch_scc1 L_bnt_55
    s_add_u32 s56, s2, 512
    s_mov_b32 s65, 0
    s_branch L_chonly_58
L_bcont_60:
    s_mov_b32 s44, s12
    s_mov_b32 s45, s13
    s_mov_b32 s46, 0x280000
    s_mov_b32 s47, 0x00020000
    buffer_load_dwordx4 v[16:19], v5, s[44:47], 0 offen
    buffer_load_dwordx4 v[20:23], v6, s[44:47], 0 offen
    buffer_load_dwordx4 v[24:27], v7, s[44:47], 0 offen
    buffer_load_dwordx4 v[28:31], v10, s[44:47], 0 offen offset:0
    buffer_load_dwordx4 v[32:35], v10, s[44:47], 0 offen offset:1280
    buffer_load_dwordx4 v[36:39], v10, s[44:47], 0 offen offset:2560
    buffer_load_dwordx4 v[40:43], v10, s[44:47], 0 offen offset:3840
    s_mov_b32 s44, s14
    s_mov_b32 s45, s15
    s_mov_b32 s46, 0x280000
    s_mov_b32 s47, 0x00020000
    buffer_load_dwordx4 v[44:47], v10, s[44:47], 0 offen offset:0
    buffer_load_dwordx4 v[48:51], v10, s[44:47], 0 offen offset:1280
    buffer_load_dwordx4 v[52:55], v10, s[44:47], 0 offen offset:2560
    buffer_load_dwordx4 v[56:59], v10, s[44:47], 0 offen offset:3840
    s_mov_b32 s44, s16
    s_mov_b32 s45, s17
    s_mov_b32 s46, 0x1400
    s_mov_b32 s47, 0x00020000
    buffer_load_dwordx4 v[60:63], v11, s[44:47], 0 offen offset:0
    buffer_load_dwordx4 v[64:67], v11, s[44:47], 0 offen offset:16
    buffer_load_dwordx4 v[68:71], v11, s[44:47], 0 offen offset:32
    buffer_load_dwordx4 v[72:75], v11, s[44:47], 0 offen offset:48
    s_mov_b32 s44, s18
    s_mov_b32 s45, s19
    s_mov_b32 s46, 0x280000
    s_mov_b32 s47, 0x00020000
    s_sub_u32 s57, s40, 8
    s_mul_i32 s57, s57, 21248
    s_add_u32 s57, s57, 98304
    s_lshl_b32 s58, s56, 12
    v_lshlrev_b32 v13, 4, v0
    v_add_u32 v13, s58, v13
    v_subrev_u32 v14, 8, v13
    buffer_load_dwordx2 v[136:137], v14, s[44:47], 0 offen
    buffer_load_dwordx4 v[138:141], v13, s[44:47], 0 offen offset:0
    buffer_load_dwordx2 v[142:143], v13, s[44:47], 0 offen offset:1016
    buffer_load_dwordx4 v[144:147], v13, s[44:47], 0 offen offset:1024
    buffer_load_dwordx2 v[148:149], v13, s[44:47], 0 offen offset:2040
    buffer_load_dwordx4 v[150:153], v13, s[44:47], 0 offen offset:2048
    buffer_load_dwordx2 v[154:155], v13, s[44:47], 0 offen offset:3064
    buffer_load_dwordx4 v[156:159], v13, s[44:47], 0 offen offset:3072
    s_branch L_bw1
L_prod1:
    s_waitcnt vmcnt(16)
    s_barrier
    s_waitcnt vmcnt(8)
    s_barrier
    s_add_u32 m0, s49, 65536
    s_add_u32 s54, s51, 0
    buffer_load_dwordx4 v10, s[32:35], s54 offen lds
    s_add_u32 m0, s49, 66560
    s_add_u32 s54, s51, 10240
    buffer_load_dwordx4 v11, s[32:35], s54 offen lds
    s_add_u32 m0, s49, 67584
    s_add_u32 s54, s51, 20480
    buffer_load_dwordx4 v10, s[32:35], s54 offen lds
    s_add_u32 m0, s49, 68608
    s_add_u32 s54, s51, 30720
    buffer_load_dwordx4 v11, s[32:35], s54 offen lds
    s_add_u32 m0, s49, 81920
    s_add_u32 s54, s52, 0
    buffer_load_dwordx4 v12, s[36:39], s54 offen lds
    s_add_u32 m0, s49, 82944
    s_add_u32 s54, s52, 15360
    buffer_load_dwordx4 v12, s[36:39], s54 offen lds
    s_add_u32 m0, s49, 83968
    s_add_u32 s54, s52, 30720
    buffer_load_dwordx4 v12, s[36:39], s54 offen lds
    s_add_u32 m0, s49, 84992
    s_add_u32 s54, s52, 46080
    buffer_load_dwordx4 v12, s[36:39], s54 offen lds
    s_add_u32 s50, s50, 1
    s_cmp_eq_u32 s50, 10
    s_cselect_b32 s50, 0, s50
    s_lshl_b32 s51, s50, 7
    s_mul_i32 s52, s50, 245760
    s_add_u32 s52, s52, s53
    s_waitcnt vmcnt(8)
    s_barrier
    s_add_u32 m0, s49, 0
    s_add_u32 s54, s51, 0
    buffer_load_dwordx4 v10, s[32:35], s54 offen lds
    s_add_u32 m0, s49, 1024
    s_add_u32 s54, s51, 10240
    buffer_load_dwordx4 v11, s[32:35], s54 offen lds
    s_add_u32 m0, s49, 2048
    s_add_u32 s54, s51, 20480
    buffer_load_dwordx4 v10, s[32:35], s54 offen lds
    s_add_u32 m0, s49, 3072
    s_add_u32 s54, s51, 30720
    buffer_load_dwordx4 v11, s[32:35], s54 offen lds
    s_add_u32 m0, s49, 16384
    s_add_u32 s54, s52, 0
    buffer_load_dwordx4 v12, s[36:39], s54 offen lds
    s_add_u32 m0, s49, 17408
    s_add_u32 s54, s52, 15360
    buffer_load_dwordx4 v12, s[36:39], s54 offen lds
    s_add_u32 m0, s49, 18432
    s_add_u32 s54, s52, 30720
    buffer_load_dwordx4 v12, s[36:39], s54 offen lds
    s_add_u32 m0, s49, 19456
    s_add_u32 s54, s52, 46080
    buffer_load_dwordx4 v12, s[36:39], s54 offen lds
    s_add_u32 s50, s50, 1
    s_cmp_eq_u32 s50, 10
    s_cselect_b32 s50, 0, s50
    s_lshl_b32 s51, s50, 7
    s_mul_i32 s52, s50, 245760
    s_add_u32 s52, s52, s53
    s_waitcnt vmcnt(8)
    s_barrier
    s_add_u32 m0, s49, 32768
    s_add_u32 s54, s51, 0
    buffer_load_dwordx4 v10, s[32:35], s54 offen lds
    s_add_u32 m0, s49, 33792
    s_add_u32 s54, s51, 10240
    buffer_load_dwordx4 v11, s[32:35], s54 offen lds
    s_add_u32 m0, s49, 34816
    s_add_u32 s54, s51, 20480
    buffer_load_dwordx4 v10, s[32:35], s54 offen lds
    s_add_u32 m0, s49, 35840
    s_add_u32 s54, s51, 30720
    buffer_load_dwordx4 v11, s[32:35], s54 offen lds
    s_add_u32 m0, s49, 49152
    s_add_u32 s54, s52, 0
    buffer_load_dwordx4 v12, s[36:39], s54 offen lds
    s_add_u32 m0, s49, 50176
    s_add_u32 s54, s52, 15360
    buffer_load_dwordx4 v12, s[36:39], s54 offen lds
    s_add_u32 m0, s49, 51200
    s_add_u32 s54, s52, 30720
    buffer_load_dwordx4 v12, s[36:39], s54 offen lds
    s_add_u32 m0, s49, 52224
    s_add_u32 s54, s52, 46080
    buffer_load_dwordx4 v12, s[36:39], s54 offen lds
    s_add_u32 s50, s50, 1
    s_cmp_eq_u32 s50, 10
    s_cselect_b32 s50, 0, s50
    s_lshl_b32 s51, s50, 7
    s_mul_i32 s52, s50, 245760
    s_add_u32 s52, s52, s53
    s_waitcnt vmcnt(8)
    s_barrier
    s_add_u32 m0, s49, 65536
    s_add_u32 s54, s51, 0
    buffer_load_dwordx4 v10, s[32:35], s54 offen lds
    s_add_u32 m0, s49, 66560
    s_add_u32 s54, s51, 10240
    buffer_load_dwordx4 v11, s[32:35], s54 offen lds
    s_add_u32 m0, s49, 67584
    s_add_u32 s54, s51, 20480
    buffer_load_dwordx4 v10, s[32:35], s54 offen lds
    s_add_u32 m0, s49, 68608
    s_add_u32 s54, s51, 30720
    buffer_load_dwordx4 v11, s[32:35], s54 offen lds
    s_add_u32 m0, s49, 81920
    s_add_u32 s54, s52, 0
    buffer_load_dwordx4 v12, s[36:39], s54 offen lds
    s_add_u32 m0, s49, 82944
    s_add_u32 s54, s52, 15360
    buffer_load_dwordx4 v12, s[36:39], s54 offen lds
    s_add_u32 m0, s49, 83968
    s_add_u32 s54, s52, 30720
    buffer_load_dwordx4 v12, s[36:39], s54 offen lds
    s_add_u32 m0, s49, 84992
    s_add_u32 s54, s52, 46080
    buffer_load_dwordx4 v12, s[36:39], s54 offen lds
    s_add_u32 s50, s50, 1
    s_cmp_eq_u32 s50, 10
    s_cselect_b32 s50, 0, s50
    s_lshl_b32 s51, s50, 7
    s_mul_i32 s52, s50, 245760
    s_add_u32 s52, s52, s53
    s_waitcnt vmcnt(8)
    s_barrier
    s_add_u32 m0, s49, 0
    s_add_u32 s54, s51, 0
    buffer_load_dwordx4 v10, s[32:35], s54 offen lds
    s_add_u32 m0, s49, 1024
    s_add_u32 s54, s51, 10240
    buffer_load_dwordx4 v11, s[32:35], s54 offen lds
    s_add_u32 m0, s49, 2048
    s_add_u32 s54, s51, 20480
    buffer_load_dwordx4 v10, s[32:35], s54 offen lds
    s_add_u32 m0, s49, 3072
    s_add_u32 s54, s51, 30720
    buffer_load_dwordx4 v11, s[32:35], s54 offen lds
    s_add_u32 m0, s49, 16384
    s_add_u32 s54, s52, 0
    buffer_load_dwordx4 v12, s[36:39], s54 offen lds
    s_add_u32 m0, s49, 17408
    s_add_u32 s54, s52, 15360
    buffer_load_dwordx4 v12, s[36:39], s54 offen lds
    s_add_u32 m0, s49, 18432
    s_add_u32 s54, s52, 30720
    buffer_load_dwordx4 v12, s[36:39], s54 offen lds
    s_add_u32 m0, s49, 19456
    s_add_u32 s54, s52, 46080
    buffer_load_dwordx4 v12, s[36:39], s54 offen lds
    s_add_u32 s50, s50, 1
    s_cmp_eq_u32 s50, 10
    s_cselect_b32 s50, 0, s50
    s_lshl_b32 s51, s50, 7
    s_mul_i32 s52, s50, 245760
    s_add_u32 s52, s52, s53
    s_waitcnt vmcnt(8)
    s_barrier
    s_add_u32 m0, s49, 32768
    s_add_u32 s54, s51, 0
    buffer_load_dwordx4 v10, s[32:35], s54 offen lds
    s_add_u32 m0, s49, 33792
    s_add_u32 s54, s51, 10240
    buffer_load_dwordx4 v11, s[32:35], s54 offen lds
    s_add_u32 m0, s49, 34816
    s_add_u32 s54, s51, 20480
    buffer_load_dwordx4 v10, s[32:35], s54 offen lds
    s_add_u32 m0, s49, 35840
    s_add_u32 s54, s51, 30720
    buffer_load_dwordx4 v11, s[32:35], s54 offen lds
    s_add_u32 m0, s49, 49152
    s_add_u32 s54, s52, 0
    buffer_load_dwordx4 v12, s[36:39], s54 offen lds
    s_add_u32 m0, s49, 50176
    s_add_u32 s54, s52, 15360
    buffer_load_dwordx4 v12, s[36:39], s54 offen lds
    s_add_u32 m0, s49, 51200
    s_add_u32 s54, s52, 30720
    buffer_load_dwordx4 v12, s[36:39], s54 offen lds
    s_add_u32 m0, s49, 52224
    s_add_u32 s54, s52, 46080
    buffer_load_dwordx4 v12, s[36:39], s54 offen lds
    s_add_u32 s50, s50, 1
    s_cmp_eq_u32 s50, 10
    s_cselect_b32 s50, 0, s50
    s_lshl_b32 s51, s50, 7
    s_mul_i32 s52, s50, 245760
    s_add_u32 s52, s52, s53
    s_waitcnt vmcnt(8)
    s_barrier
    s_add_u32 m0, s49, 65536
    s_add_u32 s54, s51, 0
    buffer_load_dwordx4 v10, s[32:35], s54 offen lds
    s_add_u32 m0, s49, 66560
    s_add_u32 s54, s51, 10240
    buffer_load_dwordx4 v11, s[32:35], s54 offen lds
    s_add_u32 m0, s49, 67584
    s_add_u32 s54, s51, 20480
    buffer_load_dwordx4 v10, s[32:35], s54 offen lds
    s_add_u32 m0, s49, 68608
    s_add_u32 s54, s51, 30720
    buffer_load_dwordx4 v11, s[32:35], s54 offen lds
    s_add_u32 m0, s49, 81920
    s_add_u32 s54, s52, 0
    buffer_load_dwordx4 v12, s[36:39], s54 offen lds
    s_add_u32 m0, s49, 82944
    s_add_u32 s54, s52, 15360
    buffer_load_dwordx4 v12, s[36:39], s54 offen lds
    s_add_u32 m0, s49, 83968
    s_add_u32 s54, s52, 30720
    buffer_load_dwordx4 v12, s[36:39], s54 offen lds
    s_add_u32 m0, s49, 84992
    s_add_u32 s54, s52, 46080
    buffer_load_dwordx4 v12, s[36:39], s54 offen lds
    s_add_u32 s50, s50, 1
    s_cmp_eq_u32 s50, 10
    s_cselect_b32 s50, 0, s50
    s_lshl_b32 s51, s50, 7
    s_mul_i32 s52, s50, 245760
    s_add_u32 s52, s52, s53
    s_waitcnt vmcnt(8)
    s_barrier
    s_waitcnt vmcnt(0)
    s_barrier
    s_branch L_heads
L_bw1:
    s_barrier
    s_barrier
    s_barrier
    s_barrier
    s_waitcnt vmcnt(8)
    v_lshlrev_b32 v80, 16, v16
    v_and_b32 v81, 0xffff0000, v16
    v_lshlrev_b32 v82, 16, v20
    v_and_b32 v83, 0xffff0000, v20
    v_lshlrev_b32 v84, 16, v24
    v_and_b32 v85, 0xffff0000, v24
    v_lshlrev_b32 v86, 16, v28
    v_and_b32 v87, 0xffff0000, v28
    v_lshlrev_b32 v88, 16, v32
    v_and_b32 v89, 0xffff0000, v32
    v_lshlrev_b32 v90, 16, v36
    v_and_b32 v91, 0xffff0000, v36
    v_lshlrev_b32 v92, 16, v40
    v_and_b32 v93, 0xffff0000, v40
    v_lshlrev_b32 v94, 16, v44
    v_and_b32 v95, 0xffff0000, v44
    v_lshlrev_b32 v96, 16, v48
    v_and_b32 v97, 0xffff0000, v48
    v_lshlrev_b32 v98, 16, v52
    v_and_b32 v99, 0xffff0000, v52
    v_lshlrev_b32 v100, 16, v56
    v_and_b32 v101, 0xffff0000, v56
    v_lshlrev_b32 v102, 16, v60
    v_and_b32 v104, 0xffff0000, v60
    v_lshlrev_b32 v106, 16, v61
    v_and_b32 v108, 0xffff0000, v61
    v_lshlrev_b32 v103, 16, v62
    v_and_b32 v105, 0xffff0000, v62
    v_lshlrev_b32 v107, 16, v63
    v_and_b32 v109, 0xffff0000, v63
    v_pk_mul_f32 v[110:111], v[80:81], v[108:109]
    v_pk_fma_f32 v[110:111], v[82:83], v[106:107], v[110:111]
    v_pk_fma_f32 v[110:111], v[84:85], v[104:105], v[110:111]
    v_pk_fma_f32 v[110:111], v[86:87], v[102:103], v[110:111]
    v_pk_mul_f32 v[110:111], v[110:111], v[94:95]
    v_pk_mul_f32 v[112:113], v[82:83], v[108:109]
    v_pk_fma_f32 v[112:113], v[84:85], v[106:107], v[112:113]
    v_pk_fma_f32 v[112:113], v[86:87], v[104:105], v[112:113]
    v_pk_fma_f32 v[112:113], v[88:89], v[102:103], v[112:113]
    v_pk_mul_f32 v[112:113], v[112:113], v[96:97]
    v_pk_mul_f32 v[114:115], v[84:85], v[108:109]
    v_pk_fma_f32 v[114:115], v[86:87], v[106:107], v[114:115]
    v_pk_fma_f32 v[114:115], v[88:89], v[104:105], v[114:115]
    v_pk_fma_f32 v[114:115], v[90:91], v[102:103], v[114:115]
    v_pk_mul_f32 v[114:115], v[114:115], v[98:99]
    v_pk_mul_f32 v[116:117], v[86:87], v[108:109]
    v_pk_fma_f32 v[116:117], v[88:89], v[106:107], v[116:117]
    v_pk_fma_f32 v[116:117], v[90:91], v[104:105], v[116:117]
    v_pk_fma_f32 v[116:117], v[92:93], v[102:103], v[116:117]
    v_pk_mul_f32 v[116:117], v[116:117], v[100:101]
    v_cvt_pk_bf16_f32 v120, v110, v112
    v_cvt_pk_bf16_f32 v121, v114, v116
    v_cvt_pk_bf16_f32 v122, v111, v113
    v_cvt_pk_bf16_f32 v123, v115, v117
    buffer_store_dwordx2 v[120:121], v12, s[28:31], 0 offen offset:0 sc1
    buffer_store_dwordx2 v[122:123], v12, s[28:31], 0 offen offset:512 sc1
    v_lshlrev_b32 v80, 16, v17
    v_and_b32 v81, 0xffff0000, v17
    v_lshlrev_b32 v82, 16, v21
    v_and_b32 v83, 0xffff0000, v21
    v_lshlrev_b32 v84, 16, v25
    v_and_b32 v85, 0xffff0000, v25
    v_lshlrev_b32 v86, 16, v29
    v_and_b32 v87, 0xffff0000, v29
    v_lshlrev_b32 v88, 16, v33
    v_and_b32 v89, 0xffff0000, v33
    v_lshlrev_b32 v90, 16, v37
    v_and_b32 v91, 0xffff0000, v37
    v_lshlrev_b32 v92, 16, v41
    v_and_b32 v93, 0xffff0000, v41
    v_lshlrev_b32 v94, 16, v45
    v_and_b32 v95, 0xffff0000, v45
    v_lshlrev_b32 v96, 16, v49
    v_and_b32 v97, 0xffff0000, v49
    v_lshlrev_b32 v98, 16, v53
    v_and_b32 v99, 0xffff0000, v53
    v_lshlrev_b32 v100, 16, v57
    v_and_b32 v101, 0xffff0000, v57
    v_lshlrev_b32 v102, 16, v64
    v_and_b32 v104, 0xffff0000, v64
    v_lshlrev_b32 v106, 16, v65
    v_and_b32 v108, 0xffff0000, v65
    v_lshlrev_b32 v103, 16, v66
    v_and_b32 v105, 0xffff0000, v66
    v_lshlrev_b32 v107, 16, v67
    v_and_b32 v109, 0xffff0000, v67
    v_pk_mul_f32 v[110:111], v[80:81], v[108:109]
    v_pk_fma_f32 v[110:111], v[82:83], v[106:107], v[110:111]
    v_pk_fma_f32 v[110:111], v[84:85], v[104:105], v[110:111]
    v_pk_fma_f32 v[110:111], v[86:87], v[102:103], v[110:111]
    v_pk_mul_f32 v[110:111], v[110:111], v[94:95]
    v_pk_mul_f32 v[112:113], v[82:83], v[108:109]
    v_pk_fma_f32 v[112:113], v[84:85], v[106:107], v[112:113]
    v_pk_fma_f32 v[112:113], v[86:87], v[104:105], v[112:113]
    v_pk_fma_f32 v[112:113], v[88:89], v[102:103], v[112:113]
    v_pk_mul_f32 v[112:113], v[112:113], v[96:97]
    v_pk_mul_f32 v[114:115], v[84:85], v[108:109]
    v_pk_fma_f32 v[114:115], v[86:87], v[106:107], v[114:115]
    v_pk_fma_f32 v[114:115], v[88:89], v[104:105], v[114:115]
    v_pk_fma_f32 v[114:115], v[90:91], v[102:103], v[114:115]
    v_pk_mul_f32 v[114:115], v[114:115], v[98:99]
    v_pk_mul_f32 v[116:117], v[86:87], v[108:109]
    v_pk_fma_f32 v[116:117], v[88:89], v[106:107], v[116:117]
    v_pk_fma_f32 v[116:117], v[90:91], v[104:105], v[116:117]
    v_pk_fma_f32 v[116:117], v[92:93], v[102:103], v[116:117]
    v_pk_mul_f32 v[116:117], v[116:117], v[100:101]
    v_cvt_pk_bf16_f32 v124, v110, v112
    v_cvt_pk_bf16_f32 v125, v114, v116
    v_cvt_pk_bf16_f32 v126, v111, v113
    v_cvt_pk_bf16_f32 v127, v115, v117
    buffer_store_dwordx2 v[124:125], v12, s[28:31], 0 offen offset:1024 sc1
    buffer_store_dwordx2 v[126:127], v12, s[28:31], 0 offen offset:1536 sc1
    s_barrier
    v_lshlrev_b32 v80, 16, v18
    v_and_b32 v81, 0xffff0000, v18
    v_lshlrev_b32 v82, 16, v22
    v_and_b32 v83, 0xffff0000, v22
    v_lshlrev_b32 v84, 16, v26
    v_and_b32 v85, 0xffff0000, v26
    v_lshlrev_b32 v86, 16, v30
    v_and_b32 v87, 0xffff0000, v30
    v_lshlrev_b32 v88, 16, v34
    v_and_b32 v89, 0xffff0000, v34
    v_lshlrev_b32 v90, 16, v38
    v_and_b32 v91, 0xffff0000, v38
    v_lshlrev_b32 v92, 16, v42
    v_and_b32 v93, 0xffff0000, v42
    v_lshlrev_b32 v94, 16, v46
    v_and_b32 v95, 0xffff0000, v46
    v_lshlrev_b32 v96, 16, v50
    v_and_b32 v97, 0xffff0000, v50
    v_lshlrev_b32 v98, 16, v54
    v_and_b32 v99, 0xffff0000, v54
    v_lshlrev_b32 v100, 16, v58
    v_and_b32 v101, 0xffff0000, v58
    v_lshlrev_b32 v102, 16, v68
    v_and_b32 v104, 0xffff0000, v68
    v_lshlrev_b32 v106, 16, v69
    v_and_b32 v108, 0xffff0000, v69
    v_lshlrev_b32 v103, 16, v70
    v_and_b32 v105, 0xffff0000, v70
    v_lshlrev_b32 v107, 16, v71
    v_and_b32 v109, 0xffff0000, v71
    v_pk_mul_f32 v[110:111], v[80:81], v[108:109]
    v_pk_fma_f32 v[110:111], v[82:83], v[106:107], v[110:111]
    v_pk_fma_f32 v[110:111], v[84:85], v[104:105], v[110:111]
    v_pk_fma_f32 v[110:111], v[86:87], v[102:103], v[110:111]
    v_pk_mul_f32 v[110:111], v[110:111], v[94:95]
    v_pk_mul_f32 v[112:113], v[82:83], v[108:109]
    v_pk_fma_f32 v[112:113], v[84:85], v[106:107], v[112:113]
    v_pk_fma_f32 v[112:113], v[86:87], v[104:105], v[112:113]
    v_pk_fma_f32 v[112:113], v[88:89], v[102:103], v[112:113]
    v_pk_mul_f32 v[112:113], v[112:113], v[96:97]
    v_pk_mul_f32 v[114:115], v[84:85], v[108:109]
    v_pk_fma_f32 v[114:115], v[86:87], v[106:107], v[114:115]
    v_pk_fma_f32 v[114:115], v[88:89], v[104:105], v[114:115]
    v_pk_fma_f32 v[114:115], v[90:91], v[102:103], v[114:115]
    v_pk_mul_f32 v[114:115], v[114:115], v[98:99]
    v_pk_mul_f32 v[116:117], v[86:87], v[108:109]
    v_pk_fma_f32 v[116:117], v[88:89], v[106:107], v[116:117]
    v_pk_fma_f32 v[116:117], v[90:91], v[104:105], v[116:117]
    v_pk_fma_f32 v[116:117], v[92:93], v[102:103], v[116:117]
    v_pk_mul_f32 v[116:117], v[116:117], v[100:101]
    v_cvt_pk_bf16_f32 v128, v110, v112
    v_cvt_pk_bf16_f32 v129, v114, v116
    v_cvt_pk_bf16_f32 v130, v111, v113
    v_cvt_pk_bf16_f32 v131, v115, v117
    buffer_store_dwordx2 v[128:129], v12, s[28:31], 0 offen offset:2048 sc1
    buffer_store_dwordx2 v[130:131], v12, s[28:31], 0 offen offset:2560 sc1
    v_lshlrev_b32 v80, 16, v19
    v_and_b32 v81, 0xffff0000, v19
    v_lshlrev_b32 v82, 16, v23
    v_and_b32 v83, 0xffff0000, v23
    v_lshlrev_b32 v84, 16, v27
    v_and_b32 v85, 0xffff0000, v27
    v_lshlrev_b32 v86, 16, v31
    v_and_b32 v87, 0xffff0000, v31
    v_lshlrev_b32 v88, 16, v35
    v_and_b32 v89, 0xffff0000, v35
    v_lshlrev_b32 v90, 16, v39
    v_and_b32 v91, 0xffff0000, v39
    v_lshlrev_b32 v92, 16, v43
    v_and_b32 v93, 0xffff0000, v43
    v_lshlrev_b32 v94, 16, v47
    v_and_b32 v95, 0xffff0000, v47
    v_lshlrev_b32 v96, 16, v51
    v_and_b32 v97, 0xffff0000, v51
    v_lshlrev_b32 v98, 16, v55
    v_and_b32 v99, 0xffff0000, v55
    v_lshlrev_b32 v100, 16, v59
    v_and_b32 v101, 0xffff0000, v59
    v_lshlrev_b32 v102, 16, v72
    v_and_b32 v104, 0xffff0000, v72
    v_lshlrev_b32 v106, 16, v73
    v_and_b32 v108, 0xffff0000, v73
    v_lshlrev_b32 v103, 16, v74
    v_and_b32 v105, 0xffff0000, v74
    v_lshlrev_b32 v107, 16, v75
    v_and_b32 v109, 0xffff0000, v75
    v_pk_mul_f32 v[110:111], v[80:81], v[108:109]
    v_pk_fma_f32 v[110:111], v[82:83], v[106:107], v[110:111]
    v_pk_fma_f32 v[110:111], v[84:85], v[104:105], v[110:111]
    v_pk_fma_f32 v[110:111], v[86:87], v[102:103], v[110:111]
    v_pk_mul_f32 v[110:111], v[110:111], v[94:95]
    v_pk_mul_f32 v[112:113], v[82:83], v[108:109]
    v_pk_fma_f32 v[112:113], v[84:85], v[106:107], v[112:113]
    v_pk_fma_f32 v[112:113], v[86:87], v[104:105], v[112:113]
    v_pk_fma_f32 v[112:113], v[88:89], v[102:103], v[112:113]
    v_pk_mul_f32 v[112:113], v[112:113], v[96:97]
    v_pk_mul_f32 v[114:115], v[84:85], v[108:109]
    v_pk_fma_f32 v[114:115], v[86:87], v[106:107], v[114:115]
    v_pk_fma_f32 v[114:115], v[88:89], v[104:105], v[114:115]
    v_pk_fma_f32 v[114:115], v[90:91], v[102:103], v[114:115]
    v_pk_mul_f32 v[114:115], v[114:115], v[98:99]
    v_pk_mul_f32 v[116:117], v[86:87], v[108:109]
    v_pk_fma_f32 v[116:117], v[88:89], v[106:107], v[116:117]
    v_pk_fma_f32 v[116:117], v[90:91], v[104:105], v[116:117]
    v_pk_fma_f32 v[116:117], v[92:93], v[102:103], v[116:117]
    v_pk_mul_f32 v[116:117], v[116:117], v[100:101]
    v_cvt_pk_bf16_f32 v132, v110, v112
    v_cvt_pk_bf16_f32 v133, v114, v116
    v_cvt_pk_bf16_f32 v134, v111, v113
    v_cvt_pk_bf16_f32 v135, v115, v117
    buffer_store_dwordx2 v[132:133], v12, s[28:31], 0 offen offset:3072 sc1
    buffer_store_dwordx2 v[134:135], v12, s[28:31], 0 offen offset:3584 sc1
    s_setprio 0
    v_mov_b32 v2, 0
    global_load_dword v9, v2, s[24:25] sc1
    s_barrier
    s_barrier
    s_waitcnt vmcnt(0)
    s_mov_b32 s65, 0
    v_readfirstlane_b32 s66, v9
    s_nop 3
    s_cmp_lg_u32 s66, 0
    s_cbranch_scc1 L_iok_61
    v_mov_b32 v2, 0
    v_mov_b32 v3, 1
    v_cmp_ne_u32 vcc, 0, v3
    s_mov_b32 s66, 200000
    s_nop 1
    s_mov_b64 exec, vcc
L_poll_63:
    global_load_dword v4, v2, s[24:25] sc1
    s_waitcnt vmcnt(0)
    v_cmp_ge_u32 vcc, v4, v3
    s_nop 3
    s_cmp_eq_u64 vcc, exec
    s_cbranch_scc1 L_polld_64
    s_sleep 8
    s_sub_u32 s66, s66, 1
    s_cmp_lg_u32 s66, 0
    s_cbranch_scc1 L_poll_63
L_polld_64:
    s_mov_b64 exec, -1
L_iok_61:
    v_mov_b32 v2, 162068
    v_mov_b32 v3, 1
    ds_write_b32 v2, v3
    s_cmp_ge_u32 s48, 15
    s_cselect_b32 s64, 10, 2
    v_mov_b32 v2, 162052
    v_mov_b32 v3, 1
    s_mov_b64 exec, 1
    ds_add_rtn_u32 v3, v2, v3
    s_waitcnt lgkmcnt(0)
    s_mov_b64 exec, -1
    v_readfirstlane_b32 s66, v3
    s_nop 3
    s_add_u32 s66, s66, 1
    s_cmp_lg_u32 s66, s64
    s_cbranch_scc1 L_usk_62
    s_and_b32 s66, s2, 7
    s_add_u32 s66, s66, 0
    s_lshl_b32 s66, s66, 7
    s_add_u32 s66, s66, 18874368
    v_mov_b32 v10, s66
    v_mov_b32 v11, 1
    s_mov_b64 exec, 1
    global_atomic_add v11, v10, v11, s[26:27] sc0 sc1
    s_mov_b64 exec, -1
    s_mov_b32 s65, 1
L_usk_62:
    s_barrier
    s_barrier
    s_cmp_eq_u32 s65, 0
    s_cbranch_scc1 L_uf_65
    s_waitcnt vmcnt(0)
    v_readfirstlane_b32 s66, v11
    s_nop 3
    s_cmp_lg_u32 s66, 31
    s_cbranch_scc1 L_uf_65
    v_add_u32 v10, 5120, v10
    v_mov_b32 v11, 1
    s_mov_b64 exec, 1
    global_store_dword v10, v11, s[26:27] sc1
    s_mov_b64 exec, -1
L_uf_65:
    s_mov_b32 s65, 0
    s_barrier
    s_branch L_conv
L_bnt_55:
    s_branch L_exit
L_chonly_58:
    s_mov_b32 s44, s18
    s_mov_b32 s45, s19
    s_mov_b32 s46, 0x280000
    s_mov_b32 s47, 0x00020000
    s_sub_u32 s57, s40, 8
    s_mul_i32 s57, s57, 21248
    s_add_u32 s57, s57, 98304
    s_lshl_b32 s58, s56, 12
    v_lshlrev_b32 v13, 4, v0
    v_add_u32 v13, s58, v13
    v_subrev_u32 v14, 8, v13
    buffer_load_dwordx2 v[136:137], v14, s[44:47], 0 offen
    buffer_load_dwordx4 v[138:141], v13, s[44:47], 0 offen offset:0
    buffer_load_dwordx2 v[142:143], v13, s[44:47], 0 offen offset:1016
    buffer_load_dwordx4 v[144:147], v13, s[44:47], 0 offen offset:1024
    buffer_load_dwordx2 v[148:149], v13, s[44:47], 0 offen offset:2040
    buffer_load_dwordx4 v[150:153], v13, s[44:47], 0 offen offset:2048
    buffer_load_dwordx2 v[154:155], v13, s[44:47], 0 offen offset:3064
    buffer_load_dwordx4 v[156:159], v13, s[44:47], 0 offen offset:3072
    s_barrier
    s_barrier
    s_barrier
    s_barrier
    s_barrier
    s_barrier
    s_barrier
    s_barrier
    s_barrier
    s_barrier
    s_branch L_conv
L_bnog_54:
    s_cmp_eq_u32 s40, 10
    s_cbranch_scc1 L_b2_66
    s_lshl_b32 s56, s2, 1
    s_sub_u32 s57, s40, 8
    s_add_u32 s56, s56, s57
    s_mul_i32 s57, s56, 52429
    s_lshr_b32 s57, s57, 19
    s_mul_i32 s58, s57, 10
    s_sub_u32 s58, s56, s58
    v_and_b32 v2, 7, v0
    v_lshrrev_b32 v3, 3, v0
    v_lshlrev_b32 v12, 6, v2
    v_lshl_add_u32 v12, v3, 3, v12
    s_lshl_b32 s54, s56, 12
    s_add_u32 s54, s54, 8388608
    v_add_u32 v12, s54, v12
    s_lshl_b32 s54, s58, 6
    v_lshl_add_u32 v2, v2, 3, s54
    s_lshl_b32 s55, s57, 5
    v_lshl_add_u32 v3, v3, 2, s55
    v_mul_u32_u24 v4, 1280, v3
    v_lshl_add_u32 v10, v2, 1, v4
    v_lshlrev_b32 v11, 3, v2
    v_subrev_u32 v5, 3840, v10
    v_subrev_u32 v6, 2560, v10
    v_subrev_u32 v7, 1280, v10
    s_branch L_bcont_67
L_b2_66:
    s_cmp_ge_u32 s2, 128
    s_cbranch_scc1 L_exit
    s_add_u32 s56, s2, 512
    s_mov_b32 s65, 0
    s_branch L_exit
L_bcont_67:
    s_mov_b32 s44, s12
    s_mov_b32 s45, s13
    s_mov_b32 s46, 0x280000
    s_mov_b32 s47, 0x00020000
    buffer_load_dwordx4 v[16:19], v5, s[44:47], 0 offen
    buffer_load_dwordx4 v[20:23], v6, s[44:47], 0 offen
    buffer_load_dwordx4 v[24:27], v7, s[44:47], 0 offen
    buffer_load_dwordx4 v[28:31], v10, s[44:47], 0 offen offset:0
    buffer_load_dwordx4 v[32:35], v10, s[44:47], 0 offen offset:1280
    buffer_load_dwordx4 v[36:39], v10, s[44:47], 0 offen offset:2560
    buffer_load_dwordx4 v[40:43], v10, s[44:47], 0 offen offset:3840
    s_mov_b32 s44, s14
    s_mov_b32 s45, s15
    s_mov_b32 s46, 0x280000
    s_mov_b32 s47, 0x00020000
    buffer_load_dwordx4 v[44:47], v10, s[44:47], 0 offen offset:0
    buffer_load_dwordx4 v[48:51], v10, s[44:47], 0 offen offset:1280
    buffer_load_dwordx4 v[52:55], v10, s[44:47], 0 offen offset:2560
    buffer_load_dwordx4 v[56:59], v10, s[44:47], 0 offen offset:3840
    s_mov_b32 s44, s16
    s_mov_b32 s45, s17
    s_mov_b32 s46, 0x1400
    s_mov_b32 s47, 0x00020000
    buffer_load_dwordx4 v[60:63], v11, s[44:47], 0 offen offset:0
    buffer_load_dwordx4 v[64:67], v11, s[44:47], 0 offen offset:16
    buffer_load_dwordx4 v[68:71], v11, s[44:47], 0 offen offset:32
    buffer_load_dwordx4 v[72:75], v11, s[44:47], 0 offen offset:48
    s_mov_b32 s44, s18
    s_mov_b32 s45, s19
    s_mov_b32 s46, 0x280000
    s_mov_b32 s47, 0x00020000
    s_sub_u32 s57, s40, 8
    s_mul_i32 s57, s57, 21248
    s_add_u32 s57, s57, 98304
    s_lshl_b32 s58, s56, 12
    v_lshlrev_b32 v13, 4, v0
    v_add_u32 v13, s58, v13
    v_subrev_u32 v14, 8, v13
    buffer_load_dwordx2 v[136:137], v14, s[44:47], 0 offen
    buffer_load_dwordx4 v[138:141], v13, s[44:47], 0 offen offset:0
    buffer_load_dwordx2 v[142:143], v13, s[44:47], 0 offen offset:1016
    buffer_load_dwordx4 v[144:147], v13, s[44:47], 0 offen offset:1024
    buffer_load_dwordx2 v[148:149], v13, s[44:47], 0 offen offset:2040
    buffer_load_dwordx4 v[150:153], v13, s[44:47], 0 offen offset:2048
    buffer_load_dwordx2 v[154:155], v13, s[44:47], 0 offen offset:3064
    buffer_load_dwordx4 v[156:159], v13, s[44:47], 0 offen offset:3072
    s_waitcnt vmcnt(8)
    v_lshlrev_b32 v80, 16, v16
    v_and_b32 v81, 0xffff0000, v16
    v_lshlrev_b32 v82, 16, v20
    v_and_b32 v83, 0xffff0000, v20
    v_lshlrev_b32 v84, 16, v24
    v_and_b32 v85, 0xffff0000, v24
    v_lshlrev_b32 v86, 16, v28
    v_and_b32 v87, 0xffff0000, v28
    v_lshlrev_b32 v88, 16, v32
    v_and_b32 v89, 0xffff0000, v32
    v_lshlrev_b32 v90, 16, v36
    v_and_b32 v91, 0xffff0000, v36
    v_lshlrev_b32 v92, 16, v40
    v_and_b32 v93, 0xffff0000, v40
    v_lshlrev_b32 v94, 16, v44
    v_and_b32 v95, 0xffff0000, v44
    v_lshlrev_b32 v96, 16, v48
    v_and_b32 v97, 0xffff0000, v48
    v_lshlrev_b32 v98, 16, v52
    v_and_b32 v99, 0xffff0000, v52
    v_lshlrev_b32 v100, 16, v56
    v_and_b32 v101, 0xffff0000, v56
    v_lshlrev_b32 v102, 16, v60
    v_and_b32 v104, 0xffff0000, v60
    v_lshlrev_b32 v106, 16, v61
    v_and_b32 v108, 0xffff0000, v61
    v_lshlrev_b32 v103, 16, v62
    v_and_b32 v105, 0xffff0000, v62
    v_lshlrev_b32 v107, 16, v63
    v_and_b32 v109, 0xffff0000, v63
    v_pk_mul_f32 v[110:111], v[80:81], v[108:109]
    v_pk_fma_f32 v[110:111], v[82:83], v[106:107], v[110:111]
    v_pk_fma_f32 v[110:111], v[84:85], v[104:105], v[110:111]
    v_pk_fma_f32 v[110:111], v[86:87], v[102:103], v[110:111]
    v_pk_mul_f32 v[110:111], v[110:111], v[94:95]
    v_pk_mul_f32 v[112:113], v[82:83], v[108:109]
    v_pk_fma_f32 v[112:113], v[84:85], v[106:107], v[112:113]
    v_pk_fma_f32 v[112:113], v[86:87], v[104:105], v[112:113]
    v_pk_fma_f32 v[112:113], v[88:89], v[102:103], v[112:113]
    v_pk_mul_f32 v[112:113], v[112:113], v[96:97]
    v_pk_mul_f32 v[114:115], v[84:85], v[108:109]
    v_pk_fma_f32 v[114:115], v[86:87], v[106:107], v[114:115]
    v_pk_fma_f32 v[114:115], v[88:89], v[104:105], v[114:115]
    v_pk_fma_f32 v[114:115], v[90:91], v[102:103], v[114:115]
    v_pk_mul_f32 v[114:115], v[114:115], v[98:99]
    v_pk_mul_f32 v[116:117], v[86:87], v[108:109]
    v_pk_fma_f32 v[116:117], v[88:89], v[106:107], v[116:117]
    v_pk_fma_f32 v[116:117], v[90:91], v[104:105], v[116:117]
    v_pk_fma_f32 v[116:117], v[92:93], v[102:103], v[116:117]
    v_pk_mul_f32 v[116:117], v[116:117], v[100:101]
    v_cvt_pk_bf16_f32 v120, v110, v112
    v_cvt_pk_bf16_f32 v121, v114, v116
    v_cvt_pk_bf16_f32 v122, v111, v113
    v_cvt_pk_bf16_f32 v123, v115, v117
    buffer_store_dwordx2 v[120:121], v12, s[28:31], 0 offen offset:0 sc1
    buffer_store_dwordx2 v[122:123], v12, s[28:31], 0 offen offset:512 sc1
    v_lshlrev_b32 v80, 16, v17
    v_and_b32 v81, 0xffff0000, v17
    v_lshlrev_b32 v82, 16, v21
    v_and_b32 v83, 0xffff0000, v21
    v_lshlrev_b32 v84, 16, v25
    v_and_b32 v85, 0xffff0000, v25
    v_lshlrev_b32 v86, 16, v29
    v_and_b32 v87, 0xffff0000, v29
    v_lshlrev_b32 v88, 16, v33
    v_and_b32 v89, 0xffff0000, v33
    v_lshlrev_b32 v90, 16, v37
    v_and_b32 v91, 0xffff0000, v37
    v_lshlrev_b32 v92, 16, v41
    v_and_b32 v93, 0xffff0000, v41
    v_lshlrev_b32 v94, 16, v45
    v_and_b32 v95, 0xffff0000, v45
    v_lshlrev_b32 v96, 16, v49
    v_and_b32 v97, 0xffff0000, v49
    v_lshlrev_b32 v98, 16, v53
    v_and_b32 v99, 0xffff0000, v53
    v_lshlrev_b32 v100, 16, v57
    v_and_b32 v101, 0xffff0000, v57
    v_lshlrev_b32 v102, 16, v64
    v_and_b32 v104, 0xffff0000, v64
    v_lshlrev_b32 v106, 16, v65
    v_and_b32 v108, 0xffff0000, v65
    v_lshlrev_b32 v103, 16, v66
    v_and_b32 v105, 0xffff0000, v66
    v_lshlrev_b32 v107, 16, v67
    v_and_b32 v109, 0xffff0000, v67
    v_pk_mul_f32 v[110:111], v[80:81], v[108:109]
    v_pk_fma_f32 v[110:111], v[82:83], v[106:107], v[110:111]
    v_pk_fma_f32 v[110:111], v[84:85], v[104:105], v[110:111]
    v_pk_fma_f32 v[110:111], v[86:87], v[102:103], v[110:111]
    v_pk_mul_f32 v[110:111], v[110:111], v[94:95]
    v_pk_mul_f32 v[112:113], v[82:83], v[108:109]
    v_pk_fma_f32 v[112:113], v[84:85], v[106:107], v[112:113]
    v_pk_fma_f32 v[112:113], v[86:87], v[104:105], v[112:113]
    v_pk_fma_f32 v[112:113], v[88:89], v[102:103], v[112:113]
    v_pk_mul_f32 v[112:113], v[112:113], v[96:97]
    v_pk_mul_f32 v[114:115], v[84:85], v[108:109]
    v_pk_fma_f32 v[114:115], v[86:87], v[106:107], v[114:115]
    v_pk_fma_f32 v[114:115], v[88:89], v[104:105], v[114:115]
    v_pk_fma_f32 v[114:115], v[90:91], v[102:103], v[114:115]
    v_pk_mul_f32 v[114:115], v[114:115], v[98:99]
    v_pk_mul_f32 v[116:117], v[86:87], v[108:109]
    v_pk_fma_f32 v[116:117], v[88:89], v[106:107], v[116:117]
    v_pk_fma_f32 v[116:117], v[90:91], v[104:105], v[116:117]
    v_pk_fma_f32 v[116:117], v[92:93], v[102:103], v[116:117]
    v_pk_mul_f32 v[116:117], v[116:117], v[100:101]
    v_cvt_pk_bf16_f32 v124, v110, v112
    v_cvt_pk_bf16_f32 v125, v114, v116
    v_cvt_pk_bf16_f32 v126, v111, v113
    v_cvt_pk_bf16_f32 v127, v115, v117
    buffer_store_dwordx2 v[124:125], v12, s[28:31], 0 offen offset:1024 sc1
    buffer_store_dwordx2 v[126:127], v12, s[28:31], 0 offen offset:1536 sc1
    v_lshlrev_b32 v80, 16, v18
    v_and_b32 v81, 0xffff0000, v18
    v_lshlrev_b32 v82, 16, v22
    v_and_b32 v83, 0xffff0000, v22
    v_lshlrev_b32 v84, 16, v26
    v_and_b32 v85, 0xffff0000, v26
    v_lshlrev_b32 v86, 16, v30
    v_and_b32 v87, 0xffff0000, v30
    v_lshlrev_b32 v88, 16, v34
    v_and_b32 v89, 0xffff0000, v34
    v_lshlrev_b32 v90, 16, v38
    v_and_b32 v91, 0xffff0000, v38
    v_lshlrev_b32 v92, 16, v42
    v_and_b32 v93, 0xffff0000, v42
    v_lshlrev_b32 v94, 16, v46
    v_and_b32 v95, 0xffff0000, v46
    v_lshlrev_b32 v96, 16, v50
    v_and_b32 v97, 0xffff0000, v50
    v_lshlrev_b32 v98, 16, v54
    v_and_b32 v99, 0xffff0000, v54
    v_lshlrev_b32 v100, 16, v58
    v_and_b32 v101, 0xffff0000, v58
    v_lshlrev_b32 v102, 16, v68
    v_and_b32 v104, 0xffff0000, v68
    v_lshlrev_b32 v106, 16, v69
    v_and_b32 v108, 0xffff0000, v69
    v_lshlrev_b32 v103, 16, v70
    v_and_b32 v105, 0xffff0000, v70
    v_lshlrev_b32 v107, 16, v71
    v_and_b32 v109, 0xffff0000, v71
    v_pk_mul_f32 v[110:111], v[80:81], v[108:109]
    v_pk_fma_f32 v[110:111], v[82:83], v[106:107], v[110:111]
    v_pk_fma_f32 v[110:111], v[84:85], v[104:105], v[110:111]
    v_pk_fma_f32 v[110:111], v[86:87], v[102:103], v[110:111]
    v_pk_mul_f32 v[110:111], v[110:111], v[94:95]
    v_pk_mul_f32 v[112:113], v[82:83], v[108:109]
    v_pk_fma_f32 v[112:113], v[84:85], v[106:107], v[112:113]
    v_pk_fma_f32 v[112:113], v[86:87], v[104:105], v[112:113]
    v_pk_fma_f32 v[112:113], v[88:89], v[102:103], v[112:113]
    v_pk_mul_f32 v[112:113], v[112:113], v[96:97]
    v_pk_mul_f32 v[114:115], v[84:85], v[108:109]
    v_pk_fma_f32 v[114:115], v[86:87], v[106:107], v[114:115]
    v_pk_fma_f32 v[114:115], v[88:89], v[104:105], v[114:115]
    v_pk_fma_f32 v[114:115], v[90:91], v[102:103], v[114:115]
    v_pk_mul_f32 v[114:115], v[114:115], v[98:99]
    v_pk_mul_f32 v[116:117], v[86:87], v[108:109]
    v_pk_fma_f32 v[116:117], v[88:89], v[106:107], v[116:117]
    v_pk_fma_f32 v[116:117], v[90:91], v[104:105], v[116:117]
    v_pk_fma_f32 v[116:117], v[92:93], v[102:103], v[116:117]
    v_pk_mul_f32 v[116:117], v[116:117], v[100:101]
    v_cvt_pk_bf16_f32 v128, v110, v112
    v_cvt_pk_bf16_f32 v129, v114, v116
    v_cvt_pk_bf16_f32 v130, v111, v113
    v_cvt_pk_bf16_f32 v131, v115, v117
    buffer_store_dwordx2 v[128:129], v12, s[28:31], 0 offen offset:2048 sc1
    buffer_store_dwordx2 v[130:131], v12, s[28:31], 0 offen offset:2560 sc1
    v_lshlrev_b32 v80, 16, v19
    v_and_b32 v81, 0xffff0000, v19
    v_lshlrev_b32 v82, 16, v23
    v_and_b32 v83, 0xffff0000, v23
    v_lshlrev_b32 v84, 16, v27
    v_and_b32 v85, 0xffff0000, v27
    v_lshlrev_b32 v86, 16, v31
    v_and_b32 v87, 0xffff0000, v31
    v_lshlrev_b32 v88, 16, v35
    v_and_b32 v89, 0xffff0000, v35
    v_lshlrev_b32 v90, 16, v39
    v_and_b32 v91, 0xffff0000, v39
    v_lshlrev_b32 v92, 16, v43
    v_and_b32 v93, 0xffff0000, v43
    v_lshlrev_b32 v94, 16, v47
    v_and_b32 v95, 0xffff0000, v47
    v_lshlrev_b32 v96, 16, v51
    v_and_b32 v97, 0xffff0000, v51
    v_lshlrev_b32 v98, 16, v55
    v_and_b32 v99, 0xffff0000, v55
    v_lshlrev_b32 v100, 16, v59
    v_and_b32 v101, 0xffff0000, v59
    v_lshlrev_b32 v102, 16, v72
    v_and_b32 v104, 0xffff0000, v72
    v_lshlrev_b32 v106, 16, v73
    v_and_b32 v108, 0xffff0000, v73
    v_lshlrev_b32 v103, 16, v74
    v_and_b32 v105, 0xffff0000, v74
    v_lshlrev_b32 v107, 16, v75
    v_and_b32 v109, 0xffff0000, v75
    v_pk_mul_f32 v[110:111], v[80:81], v[108:109]
    v_pk_fma_f32 v[110:111], v[82:83], v[106:107], v[110:111]
    v_pk_fma_f32 v[110:111], v[84:85], v[104:105], v[110:111]
    v_pk_fma_f32 v[110:111], v[86:87], v[102:103], v[110:111]
    v_pk_mul_f32 v[110:111], v[110:111], v[94:95]
    v_pk_mul_f32 v[112:113], v[82:83], v[108:109]
    v_pk_fma_f32 v[112:113], v[84:85], v[106:107], v[112:113]
    v_pk_fma_f32 v[112:113], v[86:87], v[104:105], v[112:113]
    v_pk_fma_f32 v[112:113], v[88:89], v[102:103], v[112:113]
    v_pk_mul_f32 v[112:113], v[112:113], v[96:97]
    v_pk_mul_f32 v[114:115], v[84:85], v[108:109]
    v_pk_fma_f32 v[114:115], v[86:87], v[106:107], v[114:115]
    v_pk_fma_f32 v[114:115], v[88:89], v[104:105], v[114:115]
    v_pk_fma_f32 v[114:115], v[90:91], v[102:103], v[114:115]
    v_pk_mul_f32 v[114:115], v[114:115], v[98:99]
    v_pk_mul_f32 v[116:117], v[86:87], v[108:109]
    v_pk_fma_f32 v[116:117], v[88:89], v[106:107], v[116:117]
    v_pk_fma_f32 v[116:117], v[90:91], v[104:105], v[116:117]
    v_pk_fma_f32 v[116:117], v[92:93], v[102:103], v[116:117]
    v_pk_mul_f32 v[116:117], v[116:117], v[100:101]
    v_cvt_pk_bf16_f32 v132, v110, v112
    v_cvt_pk_bf16_f32 v133, v114, v116
    v_cvt_pk_bf16_f32 v134, v111, v113
    v_cvt_pk_bf16_f32 v135, v115, v117
    buffer_store_dwordx2 v[132:133], v12, s[28:31], 0 offen offset:3072 sc1
    buffer_store_dwordx2 v[134:135], v12, s[28:31], 0 offen offset:3584 sc1
    v_mov_b32 v2, 0
    global_load_dword v9, v2, s[24:25] sc1
    s_waitcnt vmcnt(0)
    s_mov_b32 s65, 0
    v_readfirstlane_b32 s66, v9
    s_nop 3
    s_cmp_lg_u32 s66, 0
    s_cbranch_scc1 L_iok_68
    v_mov_b32 v2, 0
    v_mov_b32 v3, 1
    v_cmp_ne_u32 vcc, 0, v3
    s_mov_b32 s66, 200000
    s_nop 1
    s_mov_b64 exec, vcc
L_poll_70:
    global_load_dword v4, v2, s[24:25] sc1
    s_waitcnt vmcnt(0)
    v_cmp_ge_u32 vcc, v4, v3
    s_nop 3
    s_cmp_eq_u64 vcc, exec
    s_cbranch_scc1 L_polld_71
    s_sleep 8
    s_sub_u32 s66, s66, 1
    s_cmp_lg_u32 s66, 0
    s_cbranch_scc1 L_poll_70
L_polld_71:
    s_mov_b64 exec, -1
L_iok_68:
    v_mov_b32 v2, 162068
    v_mov_b32 v3, 1
    ds_write_b32 v2, v3
    s_cmp_ge_u32 s48, 15
    s_cselect_b32 s64, 10, 2
    v_mov_b32 v2, 162052
    v_mov_b32 v3, 1
    s_mov_b64 exec, 1
    ds_add_rtn_u32 v3, v2, v3
    s_waitcnt lgkmcnt(0)
    s_mov_b64 exec, -1
    v_readfirstlane_b32 s66, v3
    s_nop 3
    s_add_u32 s66, s66, 1
    s_cmp_lg_u32 s66, s64
    s_cbranch_scc1 L_usk_69
    s_and_b32 s66, s2, 7
    s_add_u32 s66, s66, 0
    s_lshl_b32 s66, s66, 7
    s_add_u32 s66, s66, 18874368
    v_mov_b32 v10, s66
    v_mov_b32 v11, 1
    s_mov_b64 exec, 1
    global_atomic_add v11, v10, v11, s[26:27] sc0 sc1
    s_mov_b64 exec, -1
    s_mov_b32 s65, 1
L_usk_69:
    s_branch L_conv
L_nogtask:
    s_sub_u32 s56, s42, 28
    s_lshl_b32 s56, s56, 2
    s_lshr_b32 s57, s41, 1
    s_add_u32 s56, s56, s57
    s_lshl_b32 s56, s56, 3
    s_add_u32 s56, s56, s40
    s_add_u32 s56, s56, 512
    s_mul_i32 s57, s56, 52429
    s_lshr_b32 s57, s57, 19
    s_mul_i32 s58, s57, 10
    s_sub_u32 s58, s56, s58
    v_and_b32 v2, 7, v0
    v_lshrrev_b32 v3, 3, v0
    v_lshlrev_b32 v12, 6, v2
    v_lshl_add_u32 v12, v3, 3, v12
    s_lshl_b32 s54, s56, 12
    s_add_u32 s54, s54, 8388608
    v_add_u32 v12, s54, v12
    s_lshl_b32 s54, s58, 6
    v_lshl_add_u32 v2, v2, 3, s54
    s_lshl_b32 s55, s57, 5
    v_lshl_add_u32 v3, v3, 2, s55
    v_mul_u32_u24 v4, 1280, v3
    v_lshl_add_u32 v10, v2, 1, v4
    v_lshlrev_b32 v11, 3, v2
    v_subrev_u32 v5, 3840, v10
    v_subrev_u32 v6, 2560, v10
    v_subrev_u32 v7, 1280, v10
    s_mov_b32 s44, s12
    s_mov_b32 s45, s13
    s_mov_b32 s46, 0x280000
    s_mov_b32 s47, 0x00020000
    buffer_load_dwordx4 v[16:19], v5, s[44:47], 0 offen
    buffer_load_dwordx4 v[20:23], v6, s[44:47], 0 offen
    buffer_load_dwordx4 v[24:27], v7, s[44:47], 0 offen
    buffer_load_dwordx4 v[28:31], v10, s[44:47], 0 offen offset:0
    buffer_load_dwordx4 v[32:35], v10, s[44:47], 0 offen offset:1280
    buffer_load_dwordx4 v[36:39], v10, s[44:47], 0 offen offset:2560
    buffer_load_dwordx4 v[40:43], v10, s[44:47], 0 offen offset:3840
    s_mov_b32 s44, s14
    s_mov_b32 s45, s15
    s_mov_b32 s46, 0x280000
    s_mov_b32 s47, 0x00020000
    buffer_load_dwordx4 v[44:47], v10, s[44:47], 0 offen offset:0
    buffer_load_dwordx4 v[48:51], v10, s[44:47], 0 offen offset:1280
    buffer_load_dwordx4 v[52:55], v10, s[44:47], 0 offen offset:2560
    buffer_load_dwordx4 v[56:59], v10, s[44:47], 0 offen offset:3840
    s_mov_b32 s44, s16
    s_mov_b32 s45, s17
    s_mov_b32 s46, 0x1400
    s_mov_b32 s47, 0x00020000
    buffer_load_dwordx4 v[60:63], v11, s[44:47], 0 offen offset:0
    buffer_load_dwordx4 v[64:67], v11, s[44:47], 0 offen offset:16
    buffer_load_dwordx4 v[68:71], v11, s[44:47], 0 offen offset:32
    buffer_load_dwordx4 v[72:75], v11, s[44:47], 0 offen offset:48
    s_waitcnt vmcnt(0)
    v_lshlrev_b32 v80, 16, v16
    v_and_b32 v81, 0xffff0000, v16
    v_lshlrev_b32 v82, 16, v20
    v_and_b32 v83, 0xffff0000, v20
    v_lshlrev_b32 v84, 16, v24
    v_and_b32 v85, 0xffff0000, v24
    v_lshlrev_b32 v86, 16, v28
    v_and_b32 v87, 0xffff0000, v28
    v_lshlrev_b32 v88, 16, v32
    v_and_b32 v89, 0xffff0000, v32
    v_lshlrev_b32 v90, 16, v36
    v_and_b32 v91, 0xffff0000, v36
    v_lshlrev_b32 v92, 16, v40
    v_and_b32 v93, 0xffff0000, v40
    v_lshlrev_b32 v94, 16, v44
    v_and_b32 v95, 0xffff0000, v44
    v_lshlrev_b32 v96, 16, v48
    v_and_b32 v97, 0xffff0000, v48
    v_lshlrev_b32 v98, 16, v52
    v_and_b32 v99, 0xffff0000, v52
    v_lshlrev_b32 v100, 16, v56
    v_and_b32 v101, 0xffff0000, v56
    v_lshlrev_b32 v102, 16, v60
    v_and_b32 v104, 0xffff0000, v60
    v_lshlrev_b32 v106, 16, v61
    v_and_b32 v108, 0xffff0000, v61
    v_lshlrev_b32 v103, 16, v62
    v_and_b32 v105, 0xffff0000, v62
    v_lshlrev_b32 v107, 16, v63
    v_and_b32 v109, 0xffff0000, v63
    v_pk_mul_f32 v[110:111], v[80:81], v[108:109]
    v_pk_fma_f32 v[110:111], v[82:83], v[106:107], v[110:111]
    v_pk_fma_f32 v[110:111], v[84:85], v[104:105], v[110:111]
    v_pk_fma_f32 v[110:111], v[86:87], v[102:103], v[110:111]
    v_pk_mul_f32 v[110:111], v[110:111], v[94:95]
    v_pk_mul_f32 v[112:113], v[82:83], v[108:109]
    v_pk_fma_f32 v[112:113], v[84:85], v[106:107], v[112:113]
    v_pk_fma_f32 v[112:113], v[86:87], v[104:105], v[112:113]
    v_pk_fma_f32 v[112:113], v[88:89], v[102:103], v[112:113]
    v_pk_mul_f32 v[112:113], v[112:113], v[96:97]
    v_pk_mul_f32 v[114:115], v[84:85], v[108:109]
    v_pk_fma_f32 v[114:115], v[86:87], v[106:107], v[114:115]
    v_pk_fma_f32 v[114:115], v[88:89], v[104:105], v[114:115]
    v_pk_fma_f32 v[114:115], v[90:91], v[102:103], v[114:115]
    v_pk_mul_f32 v[114:115], v[114:115], v[98:99]
    v_pk_mul_f32 v[116:117], v[86:87], v[108:109]
    v_pk_fma_f32 v[116:117], v[88:89], v[106:107], v[116:117]
    v_pk_fma_f32 v[116:117], v[90:91], v[104:105], v[116:117]
    v_pk_fma_f32 v[116:117], v[92:93], v[102:103], v[116:117]
    v_pk_mul_f32 v[116:117], v[116:117], v[100:101]
    v_cvt_pk_bf16_f32 v120, v110, v112
    v_cvt_pk_bf16_f32 v121, v114, v116
    v_cvt_pk_bf16_f32 v122, v111, v113
    v_cvt_pk_bf16_f32 v123, v115, v117
    buffer_store_dwordx2 v[120:121], v12, s[28:31], 0 offen offset:0 sc1
    buffer_store_dwordx2 v[122:123], v12, s[28:31], 0 offen offset:512 sc1
    v_lshlrev_b32 v80, 16, v17
    v_and_b32 v81, 0xffff0000, v17
    v_lshlrev_b32 v82, 16, v21
    v_and_b32 v83, 0xffff0000, v21
    v_lshlrev_b32 v84, 16, v25
    v_and_b32 v85, 0xffff0000, v25
    v_lshlrev_b32 v86, 16, v29
    v_and_b32 v87, 0xffff0000, v29
    v_lshlrev_b32 v88, 16, v33
    v_and_b32 v89, 0xffff0000, v33
    v_lshlrev_b32 v90, 16, v37
    v_and_b32 v91, 0xffff0000, v37
    v_lshlrev_b32 v92, 16, v41
    v_and_b32 v93, 0xffff0000, v41
    v_lshlrev_b32 v94, 16, v45
    v_and_b32 v95, 0xffff0000, v45
    v_lshlrev_b32 v96, 16, v49
    v_and_b32 v97, 0xffff0000, v49
    v_lshlrev_b32 v98, 16, v53
    v_and_b32 v99, 0xffff0000, v53
    v_lshlrev_b32 v100, 16, v57
    v_and_b32 v101, 0xffff0000, v57
    v_lshlrev_b32 v102, 16, v64
    v_and_b32 v104, 0xffff0000, v64
    v_lshlrev_b32 v106, 16, v65
    v_and_b32 v108, 0xffff0000, v65
    v_lshlrev_b32 v103, 16, v66
    v_and_b32 v105, 0xffff0000, v66
    v_lshlrev_b32 v107, 16, v67
    v_and_b32 v109, 0xffff0000, v67
    v_pk_mul_f32 v[110:111], v[80:81], v[108:109]
    v_pk_fma_f32 v[110:111], v[82:83], v[106:107], v[110:111]
    v_pk_fma_f32 v[110:111], v[84:85], v[104:105], v[110:111]
    v_pk_fma_f32 v[110:111], v[86:87], v[102:103], v[110:111]
    v_pk_mul_f32 v[110:111], v[110:111], v[94:95]
    v_pk_mul_f32 v[112:113], v[82:83], v[108:109]
    v_pk_fma_f32 v[112:113], v[84:85], v[106:107], v[112:113]
    v_pk_fma_f32 v[112:113], v[86:87], v[104:105], v[112:113]
    v_pk_fma_f32 v[112:113], v[88:89], v[102:103], v[112:113]
    v_pk_mul_f32 v[112:113], v[112:113], v[96:97]
    v_pk_mul_f32 v[114:115], v[84:85], v[108:109]
    v_pk_fma_f32 v[114:115], v[86:87], v[106:107], v[114:115]
    v_pk_fma_f32 v[114:115], v[88:89], v[104:105], v[114:115]
    v_pk_fma_f32 v[114:115], v[90:91], v[102:103], v[114:115]
    v_pk_mul_f32 v[114:115], v[114:115], v[98:99]
    v_pk_mul_f32 v[116:117], v[86:87], v[108:109]
    v_pk_fma_f32 v[116:117], v[88:89], v[106:107], v[116:117]
    v_pk_fma_f32 v[116:117], v[90:91], v[104:105], v[116:117]
    v_pk_fma_f32 v[116:117], v[92:93], v[102:103], v[116:117]
    v_pk_mul_f32 v[116:117], v[116:117], v[100:101]
    v_cvt_pk_bf16_f32 v124, v110, v112
    v_cvt_pk_bf16_f32 v125, v114, v116
    v_cvt_pk_bf16_f32 v126, v111, v113
    v_cvt_pk_bf16_f32 v127, v115, v117
    buffer_store_dwordx2 v[124:125], v12, s[28:31], 0 offen offset:1024 sc1
    buffer_store_dwordx2 v[126:127], v12, s[28:31], 0 offen offset:1536 sc1
    v_lshlrev_b32 v80, 16, v18
    v_and_b32 v81, 0xffff0000, v18
    v_lshlrev_b32 v82, 16, v22
    v_and_b32 v83, 0xffff0000, v22
    v_lshlrev_b32 v84, 16, v26
    v_and_b32 v85, 0xffff0000, v26
    v_lshlrev_b32 v86, 16, v30
    v_and_b32 v87, 0xffff0000, v30
    v_lshlrev_b32 v88, 16, v34
    v_and_b32 v89, 0xffff0000, v34
    v_lshlrev_b32 v90, 16, v38
    v_and_b32 v91, 0xffff0000, v38
    v_lshlrev_b32 v92, 16, v42
    v_and_b32 v93, 0xffff0000, v42
    v_lshlrev_b32 v94, 16, v46
    v_and_b32 v95, 0xffff0000, v46
    v_lshlrev_b32 v96, 16, v50
    v_and_b32 v97, 0xffff0000, v50
    v_lshlrev_b32 v98, 16, v54
    v_and_b32 v99, 0xffff0000, v54
    v_lshlrev_b32 v100, 16, v58
    v_and_b32 v101, 0xffff0000, v58
    v_lshlrev_b32 v102, 16, v68
    v_and_b32 v104, 0xffff0000, v68
    v_lshlrev_b32 v106, 16, v69
    v_and_b32 v108, 0xffff0000, v69
    v_lshlrev_b32 v103, 16, v70
    v_and_b32 v105, 0xffff0000, v70
    v_lshlrev_b32 v107, 16, v71
    v_and_b32 v109, 0xffff0000, v71
    v_pk_mul_f32 v[110:111], v[80:81], v[108:109]
    v_pk_fma_f32 v[110:111], v[82:83], v[106:107], v[110:111]
    v_pk_fma_f32 v[110:111], v[84:85], v[104:105], v[110:111]
    v_pk_fma_f32 v[110:111], v[86:87], v[102:103], v[110:111]
    v_pk_mul_f32 v[110:111], v[110:111], v[94:95]
    v_pk_mul_f32 v[112:113], v[82:83], v[108:109]
    v_pk_fma_f32 v[112:113], v[84:85], v[106:107], v[112:113]
    v_pk_fma_f32 v[112:113], v[86:87], v[104:105], v[112:113]
    v_pk_fma_f32 v[112:113], v[88:89], v[102:103], v[112:113]
    v_pk_mul_f32 v[112:113], v[112:113], v[96:97]
    v_pk_mul_f32 v[114:115], v[84:85], v[108:109]
    v_pk_fma_f32 v[114:115], v[86:87], v[106:107], v[114:115]
    v_pk_fma_f32 v[114:115], v[88:89], v[104:105], v[114:115]
    v_pk_fma_f32 v[114:115], v[90:91], v[102:103], v[114:115]
    v_pk_mul_f32 v[114:115], v[114:115], v[98:99]
    v_pk_mul_f32 v[116:117], v[86:87], v[108:109]
    v_pk_fma_f32 v[116:117], v[88:89], v[106:107], v[116:117]
    v_pk_fma_f32 v[116:117], v[90:91], v[104:105], v[116:117]
    v_pk_fma_f32 v[116:117], v[92:93], v[102:103], v[116:117]
    v_pk_mul_f32 v[116:117], v[116:117], v[100:101]
    v_cvt_pk_bf16_f32 v128, v110, v112
    v_cvt_pk_bf16_f32 v129, v114, v116
    v_cvt_pk_bf16_f32 v130, v111, v113
    v_cvt_pk_bf16_f32 v131, v115, v117
    buffer_store_dwordx2 v[128:129], v12, s[28:31], 0 offen offset:2048 sc1
    buffer_store_dwordx2 v[130:131], v12, s[28:31], 0 offen offset:2560 sc1
    v_lshlrev_b32 v80, 16, v19
    v_and_b32 v81, 0xffff0000, v19
    v_lshlrev_b32 v82, 16, v23
    v_and_b32 v83, 0xffff0000, v23
    v_lshlrev_b32 v84, 16, v27
    v_and_b32 v85, 0xffff0000, v27
    v_lshlrev_b32 v86, 16, v31
    v_and_b32 v87, 0xffff0000, v31
    v_lshlrev_b32 v88, 16, v35
    v_and_b32 v89, 0xffff0000, v35
    v_lshlrev_b32 v90, 16, v39
    v_and_b32 v91, 0xffff0000, v39
    v_lshlrev_b32 v92, 16, v43
    v_and_b32 v93, 0xffff0000, v43
    v_lshlrev_b32 v94, 16, v47
    v_and_b32 v95, 0xffff0000, v47
    v_lshlrev_b32 v96, 16, v51
    v_and_b32 v97, 0xffff0000, v51
    v_lshlrev_b32 v98, 16, v55
    v_and_b32 v99, 0xffff0000, v55
    v_lshlrev_b32 v100, 16, v59
    v_and_b32 v101, 0xffff0000, v59
    v_lshlrev_b32 v102, 16, v72
    v_and_b32 v104, 0xffff0000, v72
    v_lshlrev_b32 v106, 16, v73
    v_and_b32 v108, 0xffff0000, v73
    v_lshlrev_b32 v103, 16, v74
    v_and_b32 v105, 0xffff0000, v74
    v_lshlrev_b32 v107, 16, v75
    v_and_b32 v109, 0xffff0000, v75
    v_pk_mul_f32 v[110:111], v[80:81], v[108:109]
    v_pk_fma_f32 v[110:111], v[82:83], v[106:107], v[110:111]
    v_pk_fma_f32 v[110:111], v[84:85], v[104:105], v[110:111]
    v_pk_fma_f32 v[110:111], v[86:87], v[102:103], v[110:111]
    v_pk_mul_f32 v[110:111], v[110:111], v[94:95]
    v_pk_mul_f32 v[112:113], v[82:83], v[108:109]
    v_pk_fma_f32 v[112:113], v[84:85], v[106:107], v[112:113]
    v_pk_fma_f32 v[112:113], v[86:87], v[104:105], v[112:113]
    v_pk_fma_f32 v[112:113], v[88:89], v[102:103], v[112:113]
    v_pk_mul_f32 v[112:113], v[112:113], v[96:97]
    v_pk_mul_f32 v[114:115], v[84:85], v[108:109]
    v_pk_fma_f32 v[114:115], v[86:87], v[106:107], v[114:115]
    v_pk_fma_f32 v[114:115], v[88:89], v[104:105], v[114:115]
    v_pk_fma_f32 v[114:115], v[90:91], v[102:103], v[114:115]
    v_pk_mul_f32 v[114:115], v[114:115], v[98:99]
    v_pk_mul_f32 v[116:117], v[86:87], v[108:109]
    v_pk_fma_f32 v[116:117], v[88:89], v[106:107], v[116:117]
    v_pk_fma_f32 v[116:117], v[90:91], v[104:105], v[116:117]
    v_pk_fma_f32 v[116:117], v[92:93], v[102:103], v[116:117]
    v_pk_mul_f32 v[116:117], v[116:117], v[100:101]
    v_cvt_pk_bf16_f32 v132, v110, v112
    v_cvt_pk_bf16_f32 v133, v114, v116
    v_cvt_pk_bf16_f32 v134, v111, v113
    v_cvt_pk_bf16_f32 v135, v115, v117
    buffer_store_dwordx2 v[132:133], v12, s[28:31], 0 offen offset:3072 sc1
    buffer_store_dwordx2 v[134:135], v12, s[28:31], 0 offen offset:3584 sc1
    v_mov_b32 v2, 0
    global_load_dword v9, v2, s[24:25] sc1
    s_waitcnt vmcnt(0)
    s_mov_b32 s65, 0
    v_readfirstlane_b32 s66, v9
    s_nop 3
    s_cmp_lg_u32 s66, 0
    s_cbranch_scc1 L_iok_72
    v_mov_b32 v2, 0
    v_mov_b32 v3, 1
    v_cmp_ne_u32 vcc, 0, v3
    s_mov_b32 s66, 200000
    s_nop 1
    s_mov_b64 exec, vcc
L_poll_74:
    global_load_dword v4, v2, s[24:25] sc1
    s_waitcnt vmcnt(0)
    v_cmp_ge_u32 vcc, v4, v3
    s_nop 3
    s_cmp_eq_u64 vcc, exec
    s_cbranch_scc1 L_polld_75
    s_sleep 8
    s_sub_u32 s66, s66, 1
    s_cmp_lg_u32 s66, 0
    s_cbranch_scc1 L_poll_74
L_polld_75:
    s_mov_b64 exec, -1
L_iok_72:
    v_mov_b32 v2, 162068
    v_mov_b32 v3, 1
    ds_write_b32 v2, v3
    s_cmp_ge_u32 s48, 15
    s_cselect_b32 s64, 10, 2
    v_mov_b32 v2, 162052
    v_mov_b32 v3, 1
    s_mov_b64 exec, 1
    ds_add_rtn_u32 v3, v2, v3
    s_waitcnt lgkmcnt(0)
    s_mov_b64 exec, -1
    v_readfirstlane_b32 s66, v3
    s_nop 3
    s_add_u32 s66, s66, 1
    s_cmp_lg_u32 s66, s64
    s_cbranch_scc1 L_usk_73
    s_and_b32 s66, s2, 7
    s_add_u32 s66, s66, 0
    s_lshl_b32 s66, s66, 7
    s_add_u32 s66, s66, 18874368
    v_mov_b32 v10, s66
    v_mov_b32 v11, 1
    s_mov_b64 exec, 1
    global_atomic_add v11, v10, v11, s[26:27] sc0 sc1
    s_mov_b64 exec, -1
    s_mov_b32 s65, 1
L_usk_73:
    s_cmp_eq_u32 s65, 0
    s_cbranch_scc1 L_uf_76
    s_waitcnt vmcnt(0)
    v_readfirstlane_b32 s66, v11
    s_nop 3
    s_cmp_lg_u32 s66, 31
    s_cbranch_scc1 L_uf_76
    v_add_u32 v10, 5120, v10
    v_mov_b32 v11, 1
    s_mov_b64 exec, 1
    global_store_dword v10, v11, s[26:27] sc1
    s_mov_b64 exec, -1
L_uf_76:
    s_branch L_nogdone
L_cons:
    s_lshr_b32 s56, s40, 1
    s_and_b32 s57, s40, 1
    v_and_b32 v2, 31, v0
    v_lshrrev_b32 v3, 5, v0
    v_bfe_u32 v4, v0, 1, 3
    s_lshl_b32 s54, s56, 6
    v_add_u32 v5, s54, v2
    v_lshlrev_b32 v5, 7, v5
    v_add_u32 v6, 0, v3
    v_xor_b32 v6, v6, v4
    v_lshl_add_u32 v16, v6, 4, v5
    v_add_u32 v20, 0x10000, v16
    v_add_u32 v6, 2, v3
    v_xor_b32 v6, v6, v4
    v_lshl_add_u32 v17, v6, 4, v5
    v_add_u32 v21, 0x10000, v17
    v_add_u32 v6, 4, v3
    v_xor_b32 v6, v6, v4
    v_lshl_add_u32 v18, v6, 4, v5
    v_add_u32 v22, 0x10000, v18
    v_add_u32 v6, 6, v3
    v_xor_b32 v6, v6, v4
    v_lshl_add_u32 v19, v6, 4, v5
    v_add_u32 v23, 0x10000, v19
    s_cmp_ge_u32 s48, 10
    s_cbranch_scc1 L_vpath_1
    s_cmp_ge_u32 s48, 5
    s_cselect_b32 s55, 5, 0
    s_sub_u32 s55, s48, s55
    s_lshl_b32 s55, s55, 1
    s_add_u32 s55, s55, s57
    s_cmp_lg_u32 s55, 0
    s_cbranch_scc1 L_var_4
    s_mov_b32 s60, 0x8730ca2
    s_mov_b32 s61, 0x4a
    s_mov_b32 s62, 0x9d1835ec
    s_mov_b32 s63, 0x9c
    s_branch L_vdone_3
L_var_4:
    s_cmp_lg_u32 s55, 1
    s_cbranch_scc1 L_var_5
    s_mov_b32 s60, 0x31bd5f36
    s_mov_b32 s61, 0xef
    s_mov_b32 s62, 0x7d458540
    s_mov_b32 s63, 0xfd
    s_branch L_vdone_3
L_var_5:
    s_cmp_lg_u32 s55, 2
    s_cbranch_scc1 L_var_6
    s_mov_b32 s60, 0x84520460
    s_mov_b32 s61, 0x39
    s_mov_b32 s62, 0x18f72daa
    s_mov_b32 s63, 0x8c
    s_branch L_vdone_3
L_var_6:
    s_cmp_lg_u32 s55, 3
    s_cbranch_scc1 L_var_7
    s_mov_b32 s60, 0xad9c56f4
    s_mov_b32 s61, 0xde
    s_mov_b32 s62, 0x7dc9a648
    s_mov_b32 s63, 0xff
    s_branch L_vdone_3
L_var_7:
    s_cmp_lg_u32 s55, 4
    s_cbranch_scc1 L_var_8
    s_mov_b32 s60, 0xc0620861
    s_mov_b32 s61, 0x29
    s_mov_b32 s62, 0x94d62568
    s_mov_b32 s63, 0x7b
    s_branch L_vdone_3
L_var_8:
    s_cmp_lg_u32 s55, 5
    s_cbranch_scc1 L_var_9
    s_mov_b32 s60, 0x297b4eb2
    s_mov_b32 s61, 0xce
    s_mov_b32 s62, 0x7dcdc750
    s_mov_b32 s63, 0xff
    s_branch L_vdone_3
L_var_9:
    s_cmp_lg_u32 s55, 6
    s_cbranch_scc1 L_var_10
    s_mov_b32 s60, 0x10b51d26
    s_mov_b32 s61, 0x6b
    s_mov_b32 s62, 0xa55a0660
    s_mov_b32 s63, 0xbd
    s_branch L_vdone_3
L_var_10:
    s_cmp_lg_u32 s55, 7
    s_cbranch_scc1 L_var_11
    s_mov_b32 s60, 0xb9d88e02
    s_mov_b32 s61, 0xff
    s_mov_b32 s62, 0x758795c4
    s_mov_b32 s63, 0xde
    s_branch L_vdone_3
L_var_11:
    s_cmp_lg_u32 s55, 8
    s_cbranch_scc1 L_var_12
    s_mov_b32 s60, 0x8c9414e4
    s_mov_b32 s61, 0x5a
    s_mov_b32 s62, 0x21393e2e
    s_mov_b32 s63, 0xad
    s_branch L_vdone_3
L_var_12:
    s_cmp_lg_u32 s55, 9
    s_cbranch_scc1 L_var_13
    s_mov_b32 s60, 0xb5de0760
    s_mov_b32 s61, 0xff
    s_mov_b32 s62, 0xf1668d82
    s_mov_b32 s63, 0xcd
    s_branch L_vdone_3
L_var_13:
    s_mov_b64 s[60:61], 0
    s_mov_b64 s[62:63], 0
L_vdone_3:
    v_lshrrev_b32 v2, 4, v0
    v_bfe_u32 v3, v0, 2, 2
    v_and_b32 v4, 3, v0
    v_lshrrev_b32 v5, 1, v2
    v_lshl_add_u32 v5, v5, 3, v3
    v_lshlrev_b32 v5, 8, v5
    v_add_u32 v5, 16384, v5
    v_and_b32 v6, 1, v2
    v_lshl_add_u32 v6, v6, 2, v4
    v_mul_u32_u24 v6, 5, v6
    v_lshlrev_b32 v7, 2, v3
    v_lshrrev_b64 v[8:9], v6, s[60:61]
    v_and_b32 v8, 31, v8
    v_lshrrev_b32 v9, 1, v8
    v_xor_b32 v9, v9, v7
    v_and_b32 v8, 1, v8
    v_lshlrev_b32 v8, 3, v8
    v_lshl_add_u32 v8, v9, 4, v8
    v_add_u32 v24, v5, v8
    v_add_u32 v26, 0x10000, v24
    v_lshrrev_b64 v[8:9], v6, s[62:63]
    v_and_b32 v8, 31, v8
    v_lshrrev_b32 v9, 1, v8
    v_xor_b32 v9, v9, v7
    v_and_b32 v8, 1, v8
    v_lshlrev_b32 v8, 3, v8
    v_lshl_add_u32 v8, v9, 4, v8
    v_add_u32 v25, v5, v8
    v_add_u32 v27, 0x10000, v25
    s_mov_b32 s58, 0x3ea52b5c
    s_cmp_ge_u32 s48, 5
    s_cmov_b32 s58, 0x3f800000
    s_mov_b32 s59, s58
    v_lshlrev_b32 v128, 4, v0
    s_lshl_b32 s54, s43, 2
    s_lshl_b32 s55, s56, 1
    s_add_u32 s54, s54, s55
    s_lshl_b32 s55, s48, 6
    s_add_u32 s54, s54, s55
    s_mul_i32 s54, s54, 8320
    s_lshl_b32 s55, s57, 12
    s_add_u32 s64, s54, s55
    s_add_u32 s65, s64, 8320
    s_barrier
    ds_read_b128 v[32:35], v20 offset:0
    ds_read_b64_tr_b16 v[40:41], v26 offset:0
    ds_read_b64_tr_b16 v[42:43], v26 offset:1024
    ds_read_b128 v[36:39], v20 offset:4096
    ds_read_b64_tr_b16 v[44:45], v27 offset:0
    ds_read_b64_tr_b16 v[46:47], v27 offset:1024
    ds_read_b128 v[48:51], v21 offset:0
    ds_read_b64_tr_b16 v[56:57], v26 offset:4096
    ds_read_b64_tr_b16 v[58:59], v26 offset:5120
    ds_read_b128 v[52:55], v21 offset:4096
    ds_read_b64_tr_b16 v[60:61], v27 offset:4096
    ds_read_b64_tr_b16 v[62:63], v27 offset:5120
    s_waitcnt lgkmcnt(6)
    v_mfma_f32_32x32x16_bf16 v[64:79], v[40:43], v[32:35], 0
    ds_read_b128 v[132:135], v22 offset:0
    ds_read_b64_tr_b16 v[140:141], v26 offset:8192
    ds_read_b64_tr_b16 v[142:143], v26 offset:9216
    ds_read_b128 v[136:139], v22 offset:4096
    ds_read_b64_tr_b16 v[144:145], v27 offset:8192
    ds_read_b64_tr_b16 v[146:147], v27 offset:9216
    v_mfma_f32_32x32x16_bf16 v[80:95], v[40:43], v[36:39], 0
    v_mfma_f32_32x32x16_bf16 v[96:111], v[44:47], v[32:35], 0
    v_mfma_f32_32x32x16_bf16 v[112:127], v[44:47], v[36:39], 0
    s_waitcnt lgkmcnt(6)
    v_mfma_f32_32x32x16_bf16 v[64:79], v[56:59], v[48:51], v[64:79]
    ds_read_b128 v[32:35], v23 offset:0
    ds_read_b64_tr_b16 v[40:41], v26 offset:12288
    ds_read_b64_tr_b16 v[42:43], v26 offset:13312
    ds_read_b128 v[36:39], v23 offset:4096
    ds_read_b64_tr_b16 v[44:45], v27 offset:12288
    ds_read_b64_tr_b16 v[46:47], v27 offset:13312
    v_mfma_f32_32x32x16_bf16 v[80:95], v[56:59], v[52:55], v[80:95]
    v_mfma_f32_32x32x16_bf16 v[96:111], v[60:63], v[48:51], v[96:111]
    v_mfma_f32_32x32x16_bf16 v[112:127], v[60:63], v[52:55], v[112:127]
    s_waitcnt lgkmcnt(0)
    s_barrier
    v_mfma_f32_32x32x16_bf16 v[64:79], v[140:143], v[132:135], v[64:79]
    ds_read_b128 v[48:51], v16 offset:0
    ds_read_b64_tr_b16 v[56:57], v24 offset:0
    ds_read_b64_tr_b16 v[58:59], v24 offset:1024
    ds_read_b128 v[52:55], v16 offset:4096
    ds_read_b64_tr_b16 v[60:61], v25 offset:0
    ds_read_b64_tr_b16 v[62:63], v25 offset:1024
    v_mfma_f32_32x32x16_bf16 v[80:95], v[140:143], v[136:139], v[80:95]
    v_mfma_f32_32x32x16_bf16 v[96:111], v[144:147], v[132:135], v[96:111]
    v_mfma_f32_32x32x16_bf16 v[112:127], v[144:147], v[136:139], v[112:127]
    s_waitcnt lgkmcnt(6)
    v_mfma_f32_32x32x16_bf16 v[64:79], v[40:43], v[32:35], v[64:79]
    ds_read_b128 v[132:135], v17 offset:0
    ds_read_b64_tr_b16 v[140:141], v24 offset:4096
    ds_read_b64_tr_b16 v[142:143], v24 offset:5120
    ds_read_b128 v[136:139], v17 offset:4096
    ds_read_b64_tr_b16 v[144:145], v25 offset:4096
    ds_read_b64_tr_b16 v[146:147], v25 offset:5120
    v_mfma_f32_32x32x16_bf16 v[80:95], v[40:43], v[36:39], v[80:95]
    v_mfma_f32_32x32x16_bf16 v[96:111], v[44:47], v[32:35], v[96:111]
    v_mfma_f32_32x32x16_bf16 v[112:127], v[44:47], v[36:39], v[112:127]
    s_waitcnt lgkmcnt(6)
    v_mfma_f32_32x32x16_bf16 v[64:79], v[56:59], v[48:51], v[64:79]
    ds_read_b128 v[32:35], v18 offset:0
    ds_read_b64_tr_b16 v[40:41], v24 offset:8192
    ds_read_b64_tr_b16 v[42:43], v24 offset:9216
    ds_read_b128 v[36:39], v18 offset:4096
    ds_read_b64_tr_b16 v[44:45], v25 offset:8192
    ds_read_b64_tr_b16 v[46:47], v25 offset:9216
    v_mfma_f32_32x32x16_bf16 v[80:95], v[56:59], v[52:55], v[80:95]
    v_mfma_f32_32x32x16_bf16 v[96:111], v[60:63], v[48:51], v[96:111]
    v_mfma_f32_32x32x16_bf16 v[112:127], v[60:63], v[52:55], v[112:127]
    s_waitcnt lgkmcnt(6)
    v_mfma_f32_32x32x16_bf16 v[64:79], v[140:143], v[132:135], v[64:79]
    ds_read_b128 v[48:51], v19 offset:0
    ds_read_b64_tr_b16 v[56:57], v24 offset:12288
    ds_read_b64_tr_b16 v[58:59], v24 offset:13312
    ds_read_b128 v[52:55], v19 offset:4096
    ds_read_b64_tr_b16 v[60:61], v25 offset:12288
    ds_read_b64_tr_b16 v[62:63], v25 offset:13312
    v_mfma_f32_32x32x16_bf16 v[80:95], v[140:143], v[136:139], v[80:95]
    v_mfma_f32_32x32x16_bf16 v[96:111], v[144:147], v[132:135], v[96:111]
    v_mfma_f32_32x32x16_bf16 v[112:127], v[144:147], v[136:139], v[112:127]
    s_waitcnt lgkmcnt(0)
    s_barrier
    v_mfma_f32_32x32x16_bf16 v[64:79], v[40:43], v[32:35], v[64:79]
    ds_read_b128 v[132:135], v16 offset:32768
    ds_read_b64_tr_b16 v[140:141], v24 offset:32768
    ds_read_b64_tr_b16 v[142:143], v24 offset:33792
    ds_read_b128 v[136:139], v16 offset:36864
    ds_read_b64_tr_b16 v[144:145], v25 offset:32768
    ds_read_b64_tr_b16 v[146:147], v25 offset:33792
    v_mfma_f32_32x32x16_bf16 v[80:95], v[40:43], v[36:39], v[80:95]
    v_mfma_f32_32x32x16_bf16 v[96:111], v[44:47], v[32:35], v[96:111]
    v_mfma_f32_32x32x16_bf16 v[112:127], v[44:47], v[36:39], v[112:127]
    s_waitcnt lgkmcnt(6)
    v_mfma_f32_32x32x16_bf16 v[64:79], v[56:59], v[48:51], v[64:79]
    ds_read_b128 v[32:35], v17 offset:32768
    ds_read_b64_tr_b16 v[40:41], v24 offset:36864
    ds_read_b64_tr_b16 v[42:43], v24 offset:37888
    ds_read_b128 v[36:39], v17 offset:36864
    ds_read_b64_tr_b16 v[44:45], v25 offset:36864
    ds_read_b64_tr_b16 v[46:47], v25 offset:37888
    v_mfma_f32_32x32x16_bf16 v[80:95], v[56:59], v[52:55], v[80:95]
    v_mfma_f32_32x32x16_bf16 v[96:111], v[60:63], v[48:51], v[96:111]
    v_mfma_f32_32x32x16_bf16 v[112:127], v[60:63], v[52:55], v[112:127]
    s_waitcnt lgkmcnt(6)
    v_mfma_f32_32x32x16_bf16 v[64:79], v[140:143], v[132:135], v[64:79]
    ds_read_b128 v[48:51], v18 offset:32768
    ds_read_b64_tr_b16 v[56:57], v24 offset:40960
    ds_read_b64_tr_b16 v[58:59], v24 offset:41984
    ds_read_b128 v[52:55], v18 offset:36864
    ds_read_b64_tr_b16 v[60:61], v25 offset:40960
    ds_read_b64_tr_b16 v[62:63], v25 offset:41984
    v_mfma_f32_32x32x16_bf16 v[80:95], v[140:143], v[136:139], v[80:95]
    v_mfma_f32_32x32x16_bf16 v[96:111], v[144:147], v[132:135], v[96:111]
    v_mfma_f32_32x32x16_bf16 v[112:127], v[144:147], v[136:139], v[112:127]
    s_waitcnt lgkmcnt(6)
    v_mfma_f32_32x32x16_bf16 v[64:79], v[40:43], v[32:35], v[64:79]
    ds_read_b128 v[132:135], v19 offset:32768
    ds_read_b64_tr_b16 v[140:141], v24 offset:45056
    ds_read_b64_tr_b16 v[142:143], v24 offset:46080
    ds_read_b128 v[136:139], v19 offset:36864
    ds_read_b64_tr_b16 v[144:145], v25 offset:45056
    ds_read_b64_tr_b16 v[146:147], v25 offset:46080
    v_mfma_f32_32x32x16_bf16 v[80:95], v[40:43], v[36:39], v[80:95]
    v_mfma_f32_32x32x16_bf16 v[96:111], v[44:47], v[32:35], v[96:111]
    v_mfma_f32_32x32x16_bf16 v[112:127], v[44:47], v[36:39], v[112:127]
    s_waitcnt lgkmcnt(0)
    s_barrier
    v_mfma_f32_32x32x16_bf16 v[64:79], v[56:59], v[48:51], v[64:79]
    ds_read_b128 v[32:35], v20 offset:0
    ds_read_b64_tr_b16 v[40:41], v26 offset:0
    ds_read_b64_tr_b16 v[42:43], v26 offset:1024
    ds_read_b128 v[36:39], v20 offset:4096
    ds_read_b64_tr_b16 v[44:45], v27 offset:0
    ds_read_b64_tr_b16 v[46:47], v27 offset:1024
    v_mfma_f32_32x32x16_bf16 v[80:95], v[56:59], v[52:55], v[80:95]
    v_mfma_f32_32x32x16_bf16 v[96:111], v[60:63], v[48:51], v[96:111]
    v_mfma_f32_32x32x16_bf16 v[112:127], v[60:63], v[52:55], v[112:127]
    s_waitcnt lgkmcnt(6)
    v_mfma_f32_32x32x16_bf16 v[64:79], v[140:143], v[132:135], v[64:79]
    ds_read_b128 v[48:51], v21 offset:0
    ds_read_b64_tr_b16 v[56:57], v26 offset:4096
    ds_read_b64_tr_b16 v[58:59], v26 offset:5120
    ds_read_b128 v[52:55], v21 offset:4096
    ds_read_b64_tr_b16 v[60:61], v27 offset:4096
    ds_read_b64_tr_b16 v[62:63], v27 offset:5120
    v_mfma_f32_32x32x16_bf16 v[80:95], v[140:143], v[136:139], v[80:95]
    v_mfma_f32_32x32x16_bf16 v[96:111], v[144:147], v[132:135], v[96:111]
    v_mfma_f32_32x32x16_bf16 v[112:127], v[144:147], v[136:139], v[112:127]
    s_waitcnt lgkmcnt(6)
    v_mfma_f32_32x32x16_bf16 v[64:79], v[40:43], v[32:35], v[64:79]
    ds_read_b128 v[132:135], v22 offset:0
    ds_read_b64_tr_b16 v[140:141], v26 offset:8192
    ds_read_b64_tr_b16 v[142:143], v26 offset:9216
    ds_read_b128 v[136:139], v22 offset:4096
    ds_read_b64_tr_b16 v[144:145], v27 offset:8192
    ds_read_b64_tr_b16 v[146:147], v27 offset:9216
    v_mfma_f32_32x32x16_bf16 v[80:95], v[40:43], v[36:39], v[80:95]
    v_mfma_f32_32x32x16_bf16 v[96:111], v[44:47], v[32:35], v[96:111]
    v_mfma_f32_32x32x16_bf16 v[112:127], v[44:47], v[36:39], v[112:127]
    s_waitcnt lgkmcnt(6)
    v_mfma_f32_32x32x16_bf16 v[64:79], v[56:59], v[48:51], v[64:79]
    ds_read_b128 v[32:35], v23 offset:0
    ds_read_b64_tr_b16 v[40:41], v26 offset:12288
    ds_read_b64_tr_b16 v[42:43], v26 offset:13312
    ds_read_b128 v[36:39], v23 offset:4096
    ds_read_b64_tr_b16 v[44:45], v27 offset:12288
    ds_read_b64_tr_b16 v[46:47], v27 offset:13312
    v_mfma_f32_32x32x16_bf16 v[80:95], v[56:59], v[52:55], v[80:95]
    v_mfma_f32_32x32x16_bf16 v[96:111], v[60:63], v[48:51], v[96:111]
    v_mfma_f32_32x32x16_bf16 v[112:127], v[60:63], v[52:55], v[112:127]
    s_waitcnt lgkmcnt(0)
    s_barrier
    v_mfma_f32_32x32x16_bf16 v[64:79], v[140:143], v[132:135], v[64:79]
    ds_read_b128 v[48:51], v16 offset:0
    ds_read_b64_tr_b16 v[56:57], v24 offset:0
    ds_read_b64_tr_b16 v[58:59], v24 offset:1024
    ds_read_b128 v[52:55], v16 offset:4096
    ds_read_b64_tr_b16 v[60:61], v25 offset:0
    ds_read_b64_tr_b16 v[62:63], v25 offset:1024
    v_mfma_f32_32x32x16_bf16 v[80:95], v[140:143], v[136:139], v[80:95]
    v_mfma_f32_32x32x16_bf16 v[96:111], v[144:147], v[132:135], v[96:111]
    v_mfma_f32_32x32x16_bf16 v[112:127], v[144:147], v[136:139], v[112:127]
    s_waitcnt lgkmcnt(6)
    v_mfma_f32_32x32x16_bf16 v[64:79], v[40:43], v[32:35], v[64:79]
    ds_read_b128 v[132:135], v17 offset:0
    ds_read_b64_tr_b16 v[140:141], v24 offset:4096
    ds_read_b64_tr_b16 v[142:143], v24 offset:5120
    ds_read_b128 v[136:139], v17 offset:4096
    ds_read_b64_tr_b16 v[144:145], v25 offset:4096
    ds_read_b64_tr_b16 v[146:147], v25 offset:5120
    v_mfma_f32_32x32x16_bf16 v[80:95], v[40:43], v[36:39], v[80:95]
    v_mfma_f32_32x32x16_bf16 v[96:111], v[44:47], v[32:35], v[96:111]
    v_mfma_f32_32x32x16_bf16 v[112:127], v[44:47], v[36:39], v[112:127]
    s_waitcnt lgkmcnt(6)
    v_mfma_f32_32x32x16_bf16 v[64:79], v[56:59], v[48:51], v[64:79]
    ds_read_b128 v[32:35], v18 offset:0
    ds_read_b64_tr_b16 v[40:41], v24 offset:8192
    ds_read_b64_tr_b16 v[42:43], v24 offset:9216
    ds_read_b128 v[36:39], v18 offset:4096
    ds_read_b64_tr_b16 v[44:45], v25 offset:8192
    ds_read_b64_tr_b16 v[46:47], v25 offset:9216
    v_mfma_f32_32x32x16_bf16 v[80:95], v[56:59], v[52:55], v[80:95]
    v_mfma_f32_32x32x16_bf16 v[96:111], v[60:63], v[48:51], v[96:111]
    v_mfma_f32_32x32x16_bf16 v[112:127], v[60:63], v[52:55], v[112:127]
    s_waitcnt lgkmcnt(6)
    v_mfma_f32_32x32x16_bf16 v[64:79], v[140:143], v[132:135], v[64:79]
    ds_read_b128 v[48:51], v19 offset:0
    ds_read_b64_tr_b16 v[56:57], v24 offset:12288
    ds_read_b64_tr_b16 v[58:59], v24 offset:13312
    ds_read_b128 v[52:55], v19 offset:4096
    ds_read_b64_tr_b16 v[60:61], v25 offset:12288
    ds_read_b64_tr_b16 v[62:63], v25 offset:13312
    v_mfma_f32_32x32x16_bf16 v[80:95], v[140:143], v[136:139], v[80:95]
    v_mfma_f32_32x32x16_bf16 v[96:111], v[144:147], v[132:135], v[96:111]
    v_mfma_f32_32x32x16_bf16 v[112:127], v[144:147], v[136:139], v[112:127]
    s_waitcnt lgkmcnt(0)
    s_barrier
    v_mfma_f32_32x32x16_bf16 v[64:79], v[40:43], v[32:35], v[64:79]
    ds_read_b128 v[132:135], v16 offset:32768
    ds_read_b64_tr_b16 v[140:141], v24 offset:32768
    ds_read_b64_tr_b16 v[142:143], v24 offset:33792
    ds_read_b128 v[136:139], v16 offset:36864
    ds_read_b64_tr_b16 v[144:145], v25 offset:32768
    ds_read_b64_tr_b16 v[146:147], v25 offset:33792
    v_mfma_f32_32x32x16_bf16 v[80:95], v[40:43], v[36:39], v[80:95]
    v_mfma_f32_32x32x16_bf16 v[96:111], v[44:47], v[32:35], v[96:111]
    v_mfma_f32_32x32x16_bf16 v[112:127], v[44:47], v[36:39], v[112:127]
    s_waitcnt lgkmcnt(6)
    v_mfma_f32_32x32x16_bf16 v[64:79], v[56:59], v[48:51], v[64:79]
    ds_read_b128 v[32:35], v17 offset:32768
    ds_read_b64_tr_b16 v[40:41], v24 offset:36864
    ds_read_b64_tr_b16 v[42:43], v24 offset:37888
    ds_read_b128 v[36:39], v17 offset:36864
    ds_read_b64_tr_b16 v[44:45], v25 offset:36864
    ds_read_b64_tr_b16 v[46:47], v25 offset:37888
    v_mfma_f32_32x32x16_bf16 v[80:95], v[56:59], v[52:55], v[80:95]
    v_mfma_f32_32x32x16_bf16 v[96:111], v[60:63], v[48:51], v[96:111]
    v_mfma_f32_32x32x16_bf16 v[112:127], v[60:63], v[52:55], v[112:127]
    s_waitcnt lgkmcnt(6)
    v_mfma_f32_32x32x16_bf16 v[64:79], v[140:143], v[132:135], v[64:79]
    ds_read_b128 v[48:51], v18 offset:32768
    ds_read_b64_tr_b16 v[56:57], v24 offset:40960
    ds_read_b64_tr_b16 v[58:59], v24 offset:41984
    ds_read_b128 v[52:55], v18 offset:36864
    ds_read_b64_tr_b16 v[60:61], v25 offset:40960
    ds_read_b64_tr_b16 v[62:63], v25 offset:41984
    v_mfma_f32_32x32x16_bf16 v[80:95], v[140:143], v[136:139], v[80:95]
    v_mfma_f32_32x32x16_bf16 v[96:111], v[144:147], v[132:135], v[96:111]
    v_mfma_f32_32x32x16_bf16 v[112:127], v[144:147], v[136:139], v[112:127]
    s_waitcnt lgkmcnt(6)
    v_mfma_f32_32x32x16_bf16 v[64:79], v[40:43], v[32:35], v[64:79]
    ds_read_b128 v[132:135], v19 offset:32768
    ds_read_b64_tr_b16 v[140:141], v24 offset:45056
    ds_read_b64_tr_b16 v[142:143], v24 offset:46080
    ds_read_b128 v[136:139], v19 offset:36864
    ds_read_b64_tr_b16 v[144:145], v25 offset:45056
    ds_read_b64_tr_b16 v[146:147], v25 offset:46080
    v_mfma_f32_32x32x16_bf16 v[80:95], v[40:43], v[36:39], v[80:95]
    v_mfma_f32_32x32x16_bf16 v[96:111], v[44:47], v[32:35], v[96:111]
    v_mfma_f32_32x32x16_bf16 v[112:127], v[44:47], v[36:39], v[112:127]
    s_waitcnt lgkmcnt(0)
    s_barrier
    v_mfma_f32_32x32x16_bf16 v[64:79], v[56:59], v[48:51], v[64:79]
    ds_read_b128 v[32:35], v20 offset:0
    ds_read_b64_tr_b16 v[40:41], v26 offset:0
    ds_read_b64_tr_b16 v[42:43], v26 offset:1024
    ds_read_b128 v[36:39], v20 offset:4096
    ds_read_b64_tr_b16 v[44:45], v27 offset:0
    ds_read_b64_tr_b16 v[46:47], v27 offset:1024
    v_mfma_f32_32x32x16_bf16 v[80:95], v[56:59], v[52:55], v[80:95]
    v_mfma_f32_32x32x16_bf16 v[96:111], v[60:63], v[48:51], v[96:111]
    v_mfma_f32_32x32x16_bf16 v[112:127], v[60:63], v[52:55], v[112:127]
    s_waitcnt lgkmcnt(6)
    v_mfma_f32_32x32x16_bf16 v[64:79], v[140:143], v[132:135], v[64:79]
    ds_read_b128 v[48:51], v21 offset:0
    ds_read_b64_tr_b16 v[56:57], v26 offset:4096
    ds_read_b64_tr_b16 v[58:59], v26 offset:5120
    ds_read_b128 v[52:55], v21 offset:4096
    ds_read_b64_tr_b16 v[60:61], v27 offset:4096
    ds_read_b64_tr_b16 v[62:63], v27 offset:5120
    v_mfma_f32_32x32x16_bf16 v[80:95], v[140:143], v[136:139], v[80:95]
    v_mfma_f32_32x32x16_bf16 v[96:111], v[144:147], v[132:135], v[96:111]
    v_mfma_f32_32x32x16_bf16 v[112:127], v[144:147], v[136:139], v[112:127]
    s_waitcnt lgkmcnt(6)
    v_mfma_f32_32x32x16_bf16 v[64:79], v[40:43], v[32:35], v[64:79]
    ds_read_b128 v[132:135], v22 offset:0
    ds_read_b64_tr_b16 v[140:141], v26 offset:8192
    ds_read_b64_tr_b16 v[142:143], v26 offset:9216
    ds_read_b128 v[136:139], v22 offset:4096
    ds_read_b64_tr_b16 v[144:145], v27 offset:8192
    ds_read_b64_tr_b16 v[146:147], v27 offset:9216
    v_mfma_f32_32x32x16_bf16 v[80:95], v[40:43], v[36:39], v[80:95]
    v_mfma_f32_32x32x16_bf16 v[96:111], v[44:47], v[32:35], v[96:111]
    v_mfma_f32_32x32x16_bf16 v[112:127], v[44:47], v[36:39], v[112:127]
    s_waitcnt lgkmcnt(6)
    v_mfma_f32_32x32x16_bf16 v[64:79], v[56:59], v[48:51], v[64:79]
    ds_read_b128 v[32:35], v23 offset:0
    ds_read_b64_tr_b16 v[40:41], v26 offset:12288
    ds_read_b64_tr_b16 v[42:43], v26 offset:13312
    ds_read_b128 v[36:39], v23 offset:4096
    ds_read_b64_tr_b16 v[44:45], v27 offset:12288
    ds_read_b64_tr_b16 v[46:47], v27 offset:13312
    v_mfma_f32_32x32x16_bf16 v[80:95], v[56:59], v[52:55], v[80:95]
    v_mfma_f32_32x32x16_bf16 v[96:111], v[60:63], v[48:51], v[96:111]
    v_mfma_f32_32x32x16_bf16 v[112:127], v[60:63], v[52:55], v[112:127]
    s_waitcnt lgkmcnt(0)
    s_barrier
    v_mfma_f32_32x32x16_bf16 v[64:79], v[140:143], v[132:135], v[64:79]
    ds_read_b128 v[48:51], v16 offset:0
    ds_read_b64_tr_b16 v[56:57], v24 offset:0
    ds_read_b64_tr_b16 v[58:59], v24 offset:1024
    ds_read_b128 v[52:55], v16 offset:4096
    ds_read_b64_tr_b16 v[60:61], v25 offset:0
    ds_read_b64_tr_b16 v[62:63], v25 offset:1024
    v_mfma_f32_32x32x16_bf16 v[80:95], v[140:143], v[136:139], v[80:95]
    v_mfma_f32_32x32x16_bf16 v[96:111], v[144:147], v[132:135], v[96:111]
    v_mfma_f32_32x32x16_bf16 v[112:127], v[144:147], v[136:139], v[112:127]
    s_waitcnt lgkmcnt(6)
    v_mfma_f32_32x32x16_bf16 v[64:79], v[40:43], v[32:35], v[64:79]
    ds_read_b128 v[132:135], v17 offset:0
    ds_read_b64_tr_b16 v[140:141], v24 offset:4096
    ds_read_b64_tr_b16 v[142:143], v24 offset:5120
    ds_read_b128 v[136:139], v17 offset:4096
    ds_read_b64_tr_b16 v[144:145], v25 offset:4096
    ds_read_b64_tr_b16 v[146:147], v25 offset:5120
    v_mfma_f32_32x32x16_bf16 v[80:95], v[40:43], v[36:39], v[80:95]
    v_mfma_f32_32x32x16_bf16 v[96:111], v[44:47], v[32:35], v[96:111]
    v_mfma_f32_32x32x16_bf16 v[112:127], v[44:47], v[36:39], v[112:127]
    s_waitcnt lgkmcnt(6)
    v_mfma_f32_32x32x16_bf16 v[64:79], v[56:59], v[48:51], v[64:79]
    ds_read_b128 v[32:35], v18 offset:0
    ds_read_b64_tr_b16 v[40:41], v24 offset:8192
    ds_read_b64_tr_b16 v[42:43], v24 offset:9216
    ds_read_b128 v[36:39], v18 offset:4096
    ds_read_b64_tr_b16 v[44:45], v25 offset:8192
    ds_read_b64_tr_b16 v[46:47], v25 offset:9216
    v_mfma_f32_32x32x16_bf16 v[80:95], v[56:59], v[52:55], v[80:95]
    v_mfma_f32_32x32x16_bf16 v[96:111], v[60:63], v[48:51], v[96:111]
    v_mfma_f32_32x32x16_bf16 v[112:127], v[60:63], v[52:55], v[112:127]
    s_waitcnt lgkmcnt(6)
    v_mfma_f32_32x32x16_bf16 v[64:79], v[140:143], v[132:135], v[64:79]
    ds_read_b128 v[48:51], v19 offset:0
    ds_read_b64_tr_b16 v[56:57], v24 offset:12288
    ds_read_b64_tr_b16 v[58:59], v24 offset:13312
    ds_read_b128 v[52:55], v19 offset:4096
    ds_read_b64_tr_b16 v[60:61], v25 offset:12288
    ds_read_b64_tr_b16 v[62:63], v25 offset:13312
    v_mfma_f32_32x32x16_bf16 v[80:95], v[140:143], v[136:139], v[80:95]
    v_mfma_f32_32x32x16_bf16 v[96:111], v[144:147], v[132:135], v[96:111]
    v_mfma_f32_32x32x16_bf16 v[112:127], v[144:147], v[136:139], v[112:127]
    s_waitcnt lgkmcnt(0)
    s_barrier
    v_mfma_f32_32x32x16_bf16 v[64:79], v[40:43], v[32:35], v[64:79]
    ds_read_b128 v[132:135], v16 offset:32768
    ds_read_b64_tr_b16 v[140:141], v24 offset:32768
    ds_read_b64_tr_b16 v[142:143], v24 offset:33792
    ds_read_b128 v[136:139], v16 offset:36864
    ds_read_b64_tr_b16 v[144:145], v25 offset:32768
    ds_read_b64_tr_b16 v[146:147], v25 offset:33792
    v_mfma_f32_32x32x16_bf16 v[80:95], v[40:43], v[36:39], v[80:95]
    v_mfma_f32_32x32x16_bf16 v[96:111], v[44:47], v[32:35], v[96:111]
    v_mfma_f32_32x32x16_bf16 v[112:127], v[44:47], v[36:39], v[112:127]
    s_waitcnt lgkmcnt(6)
    v_mfma_f32_32x32x16_bf16 v[64:79], v[56:59], v[48:51], v[64:79]
    ds_read_b128 v[32:35], v17 offset:32768
    ds_read_b64_tr_b16 v[40:41], v24 offset:36864
    ds_read_b64_tr_b16 v[42:43], v24 offset:37888
    ds_read_b128 v[36:39], v17 offset:36864
    ds_read_b64_tr_b16 v[44:45], v25 offset:36864
    ds_read_b64_tr_b16 v[46:47], v25 offset:37888
    v_mfma_f32_32x32x16_bf16 v[80:95], v[56:59], v[52:55], v[80:95]
    v_mfma_f32_32x32x16_bf16 v[96:111], v[60:63], v[48:51], v[96:111]
    v_mfma_f32_32x32x16_bf16 v[112:127], v[60:63], v[52:55], v[112:127]
    s_waitcnt lgkmcnt(6)
    v_mfma_f32_32x32x16_bf16 v[64:79], v[140:143], v[132:135], v[64:79]
    ds_read_b128 v[48:51], v18 offset:32768
    ds_read_b64_tr_b16 v[56:57], v24 offset:40960
    ds_read_b64_tr_b16 v[58:59], v24 offset:41984
    ds_read_b128 v[52:55], v18 offset:36864
    ds_read_b64_tr_b16 v[60:61], v25 offset:40960
    ds_read_b64_tr_b16 v[62:63], v25 offset:41984
    v_mfma_f32_32x32x16_bf16 v[80:95], v[140:143], v[136:139], v[80:95]
    v_mfma_f32_32x32x16_bf16 v[96:111], v[144:147], v[132:135], v[96:111]
    v_mfma_f32_32x32x16_bf16 v[112:127], v[144:147], v[136:139], v[112:127]
    s_waitcnt lgkmcnt(6)
    v_mfma_f32_32x32x16_bf16 v[64:79], v[40:43], v[32:35], v[64:79]
    ds_read_b128 v[132:135], v19 offset:32768
    ds_read_b64_tr_b16 v[140:141], v24 offset:45056
    ds_read_b64_tr_b16 v[142:143], v24 offset:46080
    ds_read_b128 v[136:139], v19 offset:36864
    ds_read_b64_tr_b16 v[144:145], v25 offset:45056
    ds_read_b64_tr_b16 v[146:147], v25 offset:46080
    v_mfma_f32_32x32x16_bf16 v[80:95], v[40:43], v[36:39], v[80:95]
    v_mfma_f32_32x32x16_bf16 v[96:111], v[44:47], v[32:35], v[96:111]
    v_mfma_f32_32x32x16_bf16 v[112:127], v[44:47], v[36:39], v[112:127]
    s_waitcnt lgkmcnt(0)
    s_barrier
    v_mfma_f32_32x32x16_bf16 v[64:79], v[56:59], v[48:51], v[64:79]
    ds_read_b128 v[32:35], v20 offset:0
    ds_read_b64_tr_b16 v[40:41], v26 offset:0
    ds_read_b64_tr_b16 v[42:43], v26 offset:1024
    ds_read_b128 v[36:39], v20 offset:4096
    ds_read_b64_tr_b16 v[44:45], v27 offset:0
    ds_read_b64_tr_b16 v[46:47], v27 offset:1024
    v_mfma_f32_32x32x16_bf16 v[80:95], v[56:59], v[52:55], v[80:95]
    v_mfma_f32_32x32x16_bf16 v[96:111], v[60:63], v[48:51], v[96:111]
    v_mfma_f32_32x32x16_bf16 v[112:127], v[60:63], v[52:55], v[112:127]
    s_waitcnt lgkmcnt(6)
    v_mfma_f32_32x32x16_bf16 v[64:79], v[140:143], v[132:135], v[64:79]
    ds_read_b128 v[48:51], v21 offset:0
    ds_read_b64_tr_b16 v[56:57], v26 offset:4096
    ds_read_b64_tr_b16 v[58:59], v26 offset:5120
    ds_read_b128 v[52:55], v21 offset:4096
    ds_read_b64_tr_b16 v[60:61], v27 offset:4096
    ds_read_b64_tr_b16 v[62:63], v27 offset:5120
    v_mfma_f32_32x32x16_bf16 v[80:95], v[140:143], v[136:139], v[80:95]
    v_mfma_f32_32x32x16_bf16 v[96:111], v[144:147], v[132:135], v[96:111]
    v_mfma_f32_32x32x16_bf16 v[112:127], v[144:147], v[136:139], v[112:127]
    s_waitcnt lgkmcnt(6)
    v_mfma_f32_32x32x16_bf16 v[64:79], v[40:43], v[32:35], v[64:79]
    ds_read_b128 v[132:135], v22 offset:0
    ds_read_b64_tr_b16 v[140:141], v26 offset:8192
    ds_read_b64_tr_b16 v[142:143], v26 offset:9216
    ds_read_b128 v[136:139], v22 offset:4096
    ds_read_b64_tr_b16 v[144:145], v27 offset:8192
    ds_read_b64_tr_b16 v[146:147], v27 offset:9216
    v_mfma_f32_32x32x16_bf16 v[80:95], v[40:43], v[36:39], v[80:95]
    v_mfma_f32_32x32x16_bf16 v[96:111], v[44:47], v[32:35], v[96:111]
    v_mfma_f32_32x32x16_bf16 v[112:127], v[44:47], v[36:39], v[112:127]
    s_waitcnt lgkmcnt(6)
    v_mfma_f32_32x32x16_bf16 v[64:79], v[56:59], v[48:51], v[64:79]
    ds_read_b128 v[32:35], v23 offset:0
    ds_read_b64_tr_b16 v[40:41], v26 offset:12288
    ds_read_b64_tr_b16 v[42:43], v26 offset:13312
    ds_read_b128 v[36:39], v23 offset:4096
    ds_read_b64_tr_b16 v[44:45], v27 offset:12288
    ds_read_b64_tr_b16 v[46:47], v27 offset:13312
    v_mfma_f32_32x32x16_bf16 v[80:95], v[56:59], v[52:55], v[80:95]
    v_mfma_f32_32x32x16_bf16 v[96:111], v[60:63], v[48:51], v[96:111]
    v_mfma_f32_32x32x16_bf16 v[112:127], v[60:63], v[52:55], v[112:127]
    s_waitcnt lgkmcnt(6)
    v_mfma_f32_32x32x16_bf16 v[64:79], v[140:143], v[132:135], v[64:79]
    v_mfma_f32_32x32x16_bf16 v[80:95], v[140:143], v[136:139], v[80:95]
    v_mfma_f32_32x32x16_bf16 v[96:111], v[144:147], v[132:135], v[96:111]
    v_mfma_f32_32x32x16_bf16 v[112:127], v[144:147], v[136:139], v[112:127]
    s_waitcnt lgkmcnt(0)
    v_mfma_f32_32x32x16_bf16 v[64:79], v[40:43], v[32:35], v[64:79]
    v_mfma_f32_32x32x16_bf16 v[80:95], v[40:43], v[36:39], v[80:95]
    v_mfma_f32_32x32x16_bf16 v[96:111], v[44:47], v[32:35], v[96:111]
    v_mfma_f32_32x32x16_bf16 v[112:127], v[44:47], v[36:39], v[112:127]
    s_nop 15
    v_pk_mul_f32 v[64:65], v[64:65], s[58:59]
    v_pk_mul_f32 v[66:67], v[66:67], s[58:59]
    v_pk_mul_f32 v[68:69], v[68:69], s[58:59]
    v_pk_mul_f32 v[70:71], v[70:71], s[58:59]
    v_pk_mul_f32 v[72:73], v[72:73], s[58:59]
    v_pk_mul_f32 v[74:75], v[74:75], s[58:59]
    v_pk_mul_f32 v[76:77], v[76:77], s[58:59]
    v_pk_mul_f32 v[78:79], v[78:79], s[58:59]
    v_cvt_pk_bf16_f32 v64, v64, v65
    v_cvt_pk_bf16_f32 v65, v66, v67
    v_cvt_pk_bf16_f32 v66, v68, v69
    v_cvt_pk_bf16_f32 v67, v70, v71
    buffer_store_dwordx4 v[64:67], v128, s[28:31], s64 offen offset:0 sc1
    v_cvt_pk_bf16_f32 v72, v72, v73
    v_cvt_pk_bf16_f32 v73, v74, v75
    v_cvt_pk_bf16_f32 v74, v76, v77
    v_cvt_pk_bf16_f32 v75, v78, v79
    buffer_store_dwordx4 v[72:75], v128, s[28:31], s64 offen offset:1024 sc1
    v_pk_mul_f32 v[80:81], v[80:81], s[58:59]
    v_pk_mul_f32 v[82:83], v[82:83], s[58:59]
    v_pk_mul_f32 v[84:85], v[84:85], s[58:59]
    v_pk_mul_f32 v[86:87], v[86:87], s[58:59]
    v_pk_mul_f32 v[88:89], v[88:89], s[58:59]
    v_pk_mul_f32 v[90:91], v[90:91], s[58:59]
    v_pk_mul_f32 v[92:93], v[92:93], s[58:59]
    v_pk_mul_f32 v[94:95], v[94:95], s[58:59]
    v_cvt_pk_bf16_f32 v80, v80, v81
    v_cvt_pk_bf16_f32 v81, v82, v83
    v_cvt_pk_bf16_f32 v82, v84, v85
    v_cvt_pk_bf16_f32 v83, v86, v87
    buffer_store_dwordx4 v[80:83], v128, s[28:31], s65 offen offset:0 sc1
    v_cvt_pk_bf16_f32 v88, v88, v89
    v_cvt_pk_bf16_f32 v89, v90, v91
    v_cvt_pk_bf16_f32 v90, v92, v93
    v_cvt_pk_bf16_f32 v91, v94, v95
    buffer_store_dwordx4 v[88:91], v128, s[28:31], s65 offen offset:1024 sc1
    v_pk_mul_f32 v[96:97], v[96:97], s[58:59]
    v_pk_mul_f32 v[98:99], v[98:99], s[58:59]
    v_pk_mul_f32 v[100:101], v[100:101], s[58:59]
    v_pk_mul_f32 v[102:103], v[102:103], s[58:59]
    v_pk_mul_f32 v[104:105], v[104:105], s[58:59]
    v_pk_mul_f32 v[106:107], v[106:107], s[58:59]
    v_pk_mul_f32 v[108:109], v[108:109], s[58:59]
    v_pk_mul_f32 v[110:111], v[110:111], s[58:59]
    v_cvt_pk_bf16_f32 v96, v96, v97
    v_cvt_pk_bf16_f32 v97, v98, v99
    v_cvt_pk_bf16_f32 v98, v100, v101
    v_cvt_pk_bf16_f32 v99, v102, v103
    buffer_store_dwordx4 v[96:99], v128, s[28:31], s64 offen offset:2048 sc1
    v_cvt_pk_bf16_f32 v104, v104, v105
    v_cvt_pk_bf16_f32 v105, v106, v107
    v_cvt_pk_bf16_f32 v106, v108, v109
    v_cvt_pk_bf16_f32 v107, v110, v111
    buffer_store_dwordx4 v[104:107], v128, s[28:31], s64 offen offset:3072 sc1
    v_pk_mul_f32 v[112:113], v[112:113], s[58:59]
    v_pk_mul_f32 v[114:115], v[114:115], s[58:59]
    v_pk_mul_f32 v[116:117], v[116:117], s[58:59]
    v_pk_mul_f32 v[118:119], v[118:119], s[58:59]
    v_pk_mul_f32 v[120:121], v[120:121], s[58:59]
    v_pk_mul_f32 v[122:123], v[122:123], s[58:59]
    v_pk_mul_f32 v[124:125], v[124:125], s[58:59]
    v_pk_mul_f32 v[126:127], v[126:127], s[58:59]
    v_cvt_pk_bf16_f32 v112, v112, v113
    v_cvt_pk_bf16_f32 v113, v114, v115
    v_cvt_pk_bf16_f32 v114, v116, v117
    v_cvt_pk_bf16_f32 v115, v118, v119
    buffer_store_dwordx4 v[112:115], v128, s[28:31], s65 offen offset:2048 sc1
    v_cvt_pk_bf16_f32 v120, v120, v121
    v_cvt_pk_bf16_f32 v121, v122, v123
    v_cvt_pk_bf16_f32 v122, v124, v125
    v_cvt_pk_bf16_f32 v123, v126, v127
    buffer_store_dwordx4 v[120:123], v128, s[28:31], s65 offen offset:3072 sc1
    s_branch L_gsig_2
L_vpath_1:
    s_lshl_b32 s54, s57, 4
    s_mul_i32 s55, s54, 0x42108421
    s_mul_hi_u32 s61, s54, 0x42108421
    s_mul_i32 s66, s54, 0x8
    s_add_u32 s61, s61, s66
    s_add_u32 s60, s55, 0x8a418820
    s_addc_u32 s61, s61, 0x39
    s_add_u32 s62, s60, 0x10842108
    s_addc_u32 s63, s61, 0x42
    v_lshrrev_b32 v2, 4, v0
    v_bfe_u32 v3, v0, 2, 2
    v_and_b32 v4, 3, v0
    v_lshrrev_b32 v5, 1, v2
    v_lshl_add_u32 v5, v5, 3, v3
    v_lshlrev_b32 v5, 8, v5
    v_add_u32 v5, 16384, v5
    v_and_b32 v6, 1, v2
    v_lshl_add_u32 v6, v6, 2, v4
    v_mul_u32_u24 v6, 5, v6
    v_lshlrev_b32 v7, 2, v3
    v_lshrrev_b64 v[8:9], v6, s[60:61]
    v_and_b32 v8, 31, v8
    v_lshrrev_b32 v9, 1, v8
    v_xor_b32 v9, v9, v7
    v_and_b32 v8, 1, v8
    v_lshlrev_b32 v8, 3, v8
    v_lshl_add_u32 v8, v9, 4, v8
    v_add_u32 v24, v5, v8
    v_add_u32 v26, 0x10000, v24
    v_lshrrev_b64 v[8:9], v6, s[62:63]
    v_and_b32 v8, 31, v8
    v_lshrrev_b32 v9, 1, v8
    v_xor_b32 v9, v9, v7
    v_and_b32 v8, 1, v8
    v_lshlrev_b32 v8, 3, v8
    v_lshl_add_u32 v8, v9, 4, v8
    v_add_u32 v25, v5, v8
    v_add_u32 v27, 0x10000, v25
    v_lshlrev_b32 v128, 4, v0
    s_lshl_b32 s54, s43, 2
    s_lshl_b32 s55, s48, 6
    s_add_u32 s54, s54, s55
    s_add_u32 s55, s54, s40
    s_mul_i32 s55, s55, 8320
    s_add_u32 s58, s55, 8192
    s_lshl_b32 s55, s56, 1
    s_add_u32 s54, s54, s55
    s_mul_i32 s54, s54, 8320
    s_lshl_b32 s55, s57, 11
    s_add_u32 s62, s54, s55
    s_add_u32 s63, s62, 4096
    s_add_u32 s64, s62, 8320
    s_add_u32 s65, s64, 4096
    s_barrier
    ds_read_b128 v[32:35], v20 offset:0
    ds_read_b64_tr_b16 v[40:41], v26 offset:0
    ds_read_b64_tr_b16 v[42:43], v26 offset:1024
    ds_read_b128 v[36:39], v20 offset:4096
    ds_read_b64_tr_b16 v[44:45], v27 offset:0
    ds_read_b64_tr_b16 v[46:47], v27 offset:1024
    ds_read_b128 v[48:51], v21 offset:0
    ds_read_b64_tr_b16 v[56:57], v26 offset:4096
    ds_read_b64_tr_b16 v[58:59], v26 offset:5120
    ds_read_b128 v[52:55], v21 offset:4096
    ds_read_b64_tr_b16 v[60:61], v27 offset:4096
    ds_read_b64_tr_b16 v[62:63], v27 offset:5120
    s_waitcnt lgkmcnt(6)
    v_mfma_f32_32x32x16_bf16 v[64:79], v[32:35], v[40:43], 0
    ds_read_b128 v[132:135], v22 offset:0
    ds_read_b64_tr_b16 v[140:141], v26 offset:8192
    ds_read_b64_tr_b16 v[142:143], v26 offset:9216
    ds_read_b128 v[136:139], v22 offset:4096
    ds_read_b64_tr_b16 v[144:145], v27 offset:8192
    ds_read_b64_tr_b16 v[146:147], v27 offset:9216
    v_mfma_f32_32x32x16_bf16 v[80:95], v[36:39], v[40:43], 0
    v_mfma_f32_32x32x16_bf16 v[96:111], v[32:35], v[44:47], 0
    v_mfma_f32_32x32x16_bf16 v[112:127], v[36:39], v[44:47], 0
    s_waitcnt lgkmcnt(6)
    v_mfma_f32_32x32x16_bf16 v[64:79], v[48:51], v[56:59], v[64:79]
    ds_read_b128 v[32:35], v23 offset:0
    ds_read_b64_tr_b16 v[40:41], v26 offset:12288
    ds_read_b64_tr_b16 v[42:43], v26 offset:13312
    ds_read_b128 v[36:39], v23 offset:4096
    ds_read_b64_tr_b16 v[44:45], v27 offset:12288
    ds_read_b64_tr_b16 v[46:47], v27 offset:13312
    v_mfma_f32_32x32x16_bf16 v[80:95], v[52:55], v[56:59], v[80:95]
    v_mfma_f32_32x32x16_bf16 v[96:111], v[48:51], v[60:63], v[96:111]
    v_mfma_f32_32x32x16_bf16 v[112:127], v[52:55], v[60:63], v[112:127]
    s_waitcnt lgkmcnt(0)
    s_barrier
    v_mfma_f32_32x32x16_bf16 v[64:79], v[132:135], v[140:143], v[64:79]
    ds_read_b128 v[48:51], v16 offset:0
    ds_read_b64_tr_b16 v[56:57], v24 offset:0
    ds_read_b64_tr_b16 v[58:59], v24 offset:1024
    ds_read_b128 v[52:55], v16 offset:4096
    ds_read_b64_tr_b16 v[60:61], v25 offset:0
    ds_read_b64_tr_b16 v[62:63], v25 offset:1024
    v_mfma_f32_32x32x16_bf16 v[80:95], v[136:139], v[140:143], v[80:95]
    v_mfma_f32_32x32x16_bf16 v[96:111], v[132:135], v[144:147], v[96:111]
    v_mfma_f32_32x32x16_bf16 v[112:127], v[136:139], v[144:147], v[112:127]
    s_waitcnt lgkmcnt(6)
    v_mfma_f32_32x32x16_bf16 v[64:79], v[32:35], v[40:43], v[64:79]
    ds_read_b128 v[132:135], v17 offset:0
    ds_read_b64_tr_b16 v[140:141], v24 offset:4096
    ds_read_b64_tr_b16 v[142:143], v24 offset:5120
    ds_read_b128 v[136:139], v17 offset:4096
    ds_read_b64_tr_b16 v[144:145], v25 offset:4096
    ds_read_b64_tr_b16 v[146:147], v25 offset:5120
    v_mfma_f32_32x32x16_bf16 v[80:95], v[36:39], v[40:43], v[80:95]
    v_mfma_f32_32x32x16_bf16 v[96:111], v[32:35], v[44:47], v[96:111]
    v_mfma_f32_32x32x16_bf16 v[112:127], v[36:39], v[44:47], v[112:127]
    s_waitcnt lgkmcnt(6)
    v_mfma_f32_32x32x16_bf16 v[64:79], v[48:51], v[56:59], v[64:79]
    ds_read_b128 v[32:35], v18 offset:0
    ds_read_b64_tr_b16 v[40:41], v24 offset:8192
    ds_read_b64_tr_b16 v[42:43], v24 offset:9216
    ds_read_b128 v[36:39], v18 offset:4096
    ds_read_b64_tr_b16 v[44:45], v25 offset:8192
    ds_read_b64_tr_b16 v[46:47], v25 offset:9216
    v_mfma_f32_32x32x16_bf16 v[80:95], v[52:55], v[56:59], v[80:95]
    v_mfma_f32_32x32x16_bf16 v[96:111], v[48:51], v[60:63], v[96:111]
    v_mfma_f32_32x32x16_bf16 v[112:127], v[52:55], v[60:63], v[112:127]
    s_waitcnt lgkmcnt(6)
    v_mfma_f32_32x32x16_bf16 v[64:79], v[132:135], v[140:143], v[64:79]
    ds_read_b128 v[48:51], v19 offset:0
    ds_read_b64_tr_b16 v[56:57], v24 offset:12288
    ds_read_b64_tr_b16 v[58:59], v24 offset:13312
    ds_read_b128 v[52:55], v19 offset:4096
    ds_read_b64_tr_b16 v[60:61], v25 offset:12288
    ds_read_b64_tr_b16 v[62:63], v25 offset:13312
    v_mfma_f32_32x32x16_bf16 v[80:95], v[136:139], v[140:143], v[80:95]
    v_mfma_f32_32x32x16_bf16 v[96:111], v[132:135], v[144:147], v[96:111]
    v_mfma_f32_32x32x16_bf16 v[112:127], v[136:139], v[144:147], v[112:127]
    s_waitcnt lgkmcnt(0)
    s_barrier
    v_mfma_f32_32x32x16_bf16 v[64:79], v[32:35], v[40:43], v[64:79]
    ds_read_b128 v[132:135], v16 offset:32768
    ds_read_b64_tr_b16 v[140:141], v24 offset:32768
    ds_read_b64_tr_b16 v[142:143], v24 offset:33792
    ds_read_b128 v[136:139], v16 offset:36864
    ds_read_b64_tr_b16 v[144:145], v25 offset:32768
    ds_read_b64_tr_b16 v[146:147], v25 offset:33792
    v_mfma_f32_32x32x16_bf16 v[80:95], v[36:39], v[40:43], v[80:95]
    v_mfma_f32_32x32x16_bf16 v[96:111], v[32:35], v[44:47], v[96:111]
    v_mfma_f32_32x32x16_bf16 v[112:127], v[36:39], v[44:47], v[112:127]
    s_waitcnt lgkmcnt(6)
    v_mfma_f32_32x32x16_bf16 v[64:79], v[48:51], v[56:59], v[64:79]
    ds_read_b128 v[32:35], v17 offset:32768
    ds_read_b64_tr_b16 v[40:41], v24 offset:36864
    ds_read_b64_tr_b16 v[42:43], v24 offset:37888
    ds_read_b128 v[36:39], v17 offset:36864
    ds_read_b64_tr_b16 v[44:45], v25 offset:36864
    ds_read_b64_tr_b16 v[46:47], v25 offset:37888
    v_mfma_f32_32x32x16_bf16 v[80:95], v[52:55], v[56:59], v[80:95]
    v_mfma_f32_32x32x16_bf16 v[96:111], v[48:51], v[60:63], v[96:111]
    v_mfma_f32_32x32x16_bf16 v[112:127], v[52:55], v[60:63], v[112:127]
    s_waitcnt lgkmcnt(6)
    v_mfma_f32_32x32x16_bf16 v[64:79], v[132:135], v[140:143], v[64:79]
    ds_read_b128 v[48:51], v18 offset:32768
    ds_read_b64_tr_b16 v[56:57], v24 offset:40960
    ds_read_b64_tr_b16 v[58:59], v24 offset:41984
    ds_read_b128 v[52:55], v18 offset:36864
    ds_read_b64_tr_b16 v[60:61], v25 offset:40960
    ds_read_b64_tr_b16 v[62:63], v25 offset:41984
    v_mfma_f32_32x32x16_bf16 v[80:95], v[136:139], v[140:143], v[80:95]
    v_mfma_f32_32x32x16_bf16 v[96:111], v[132:135], v[144:147], v[96:111]
    v_mfma_f32_32x32x16_bf16 v[112:127], v[136:139], v[144:147], v[112:127]
    s_waitcnt lgkmcnt(6)
    v_mfma_f32_32x32x16_bf16 v[64:79], v[32:35], v[40:43], v[64:79]
    ds_read_b128 v[132:135], v19 offset:32768
    ds_read_b64_tr_b16 v[140:141], v24 offset:45056
    ds_read_b64_tr_b16 v[142:143], v24 offset:46080
    ds_read_b128 v[136:139], v19 offset:36864
    ds_read_b64_tr_b16 v[144:145], v25 offset:45056
    ds_read_b64_tr_b16 v[146:147], v25 offset:46080
    v_mfma_f32_32x32x16_bf16 v[80:95], v[36:39], v[40:43], v[80:95]
    v_mfma_f32_32x32x16_bf16 v[96:111], v[32:35], v[44:47], v[96:111]
    v_mfma_f32_32x32x16_bf16 v[112:127], v[36:39], v[44:47], v[112:127]
    s_waitcnt lgkmcnt(0)
    s_barrier
    v_mfma_f32_32x32x16_bf16 v[64:79], v[48:51], v[56:59], v[64:79]
    ds_read_b128 v[32:35], v20 offset:0
    ds_read_b64_tr_b16 v[40:41], v26 offset:0
    ds_read_b64_tr_b16 v[42:43], v26 offset:1024
    ds_read_b128 v[36:39], v20 offset:4096
    ds_read_b64_tr_b16 v[44:45], v27 offset:0
    ds_read_b64_tr_b16 v[46:47], v27 offset:1024
    v_mfma_f32_32x32x16_bf16 v[80:95], v[52:55], v[56:59], v[80:95]
    v_mfma_f32_32x32x16_bf16 v[96:111], v[48:51], v[60:63], v[96:111]
    v_mfma_f32_32x32x16_bf16 v[112:127], v[52:55], v[60:63], v[112:127]
    s_waitcnt lgkmcnt(6)
    v_mfma_f32_32x32x16_bf16 v[64:79], v[132:135], v[140:143], v[64:79]
    ds_read_b128 v[48:51], v21 offset:0
    ds_read_b64_tr_b16 v[56:57], v26 offset:4096
    ds_read_b64_tr_b16 v[58:59], v26 offset:5120
    ds_read_b128 v[52:55], v21 offset:4096
    ds_read_b64_tr_b16 v[60:61], v27 offset:4096
    ds_read_b64_tr_b16 v[62:63], v27 offset:5120
    v_mfma_f32_32x32x16_bf16 v[80:95], v[136:139], v[140:143], v[80:95]
    v_mfma_f32_32x32x16_bf16 v[96:111], v[132:135], v[144:147], v[96:111]
    v_mfma_f32_32x32x16_bf16 v[112:127], v[136:139], v[144:147], v[112:127]
    s_waitcnt lgkmcnt(6)
    v_mfma_f32_32x32x16_bf16 v[64:79], v[32:35], v[40:43], v[64:79]
    ds_read_b128 v[132:135], v22 offset:0
    ds_read_b64_tr_b16 v[140:141], v26 offset:8192
    ds_read_b64_tr_b16 v[142:143], v26 offset:9216
    ds_read_b128 v[136:139], v22 offset:4096
    ds_read_b64_tr_b16 v[144:145], v27 offset:8192
    ds_read_b64_tr_b16 v[146:147], v27 offset:9216
    v_mfma_f32_32x32x16_bf16 v[80:95], v[36:39], v[40:43], v[80:95]
    v_mfma_f32_32x32x16_bf16 v[96:111], v[32:35], v[44:47], v[96:111]
    v_mfma_f32_32x32x16_bf16 v[112:127], v[36:39], v[44:47], v[112:127]
    s_waitcnt lgkmcnt(6)
    v_mfma_f32_32x32x16_bf16 v[64:79], v[48:51], v[56:59], v[64:79]
    ds_read_b128 v[32:35], v23 offset:0
    ds_read_b64_tr_b16 v[40:41], v26 offset:12288
    ds_read_b64_tr_b16 v[42:43], v26 offset:13312
    ds_read_b128 v[36:39], v23 offset:4096
    ds_read_b64_tr_b16 v[44:45], v27 offset:12288
    ds_read_b64_tr_b16 v[46:47], v27 offset:13312
    v_mfma_f32_32x32x16_bf16 v[80:95], v[52:55], v[56:59], v[80:95]
    v_mfma_f32_32x32x16_bf16 v[96:111], v[48:51], v[60:63], v[96:111]
    v_mfma_f32_32x32x16_bf16 v[112:127], v[52:55], v[60:63], v[112:127]
    s_waitcnt lgkmcnt(0)
    s_barrier
    v_mfma_f32_32x32x16_bf16 v[64:79], v[132:135], v[140:143], v[64:79]
    ds_read_b128 v[48:51], v16 offset:0
    ds_read_b64_tr_b16 v[56:57], v24 offset:0
    ds_read_b64_tr_b16 v[58:59], v24 offset:1024
    ds_read_b128 v[52:55], v16 offset:4096
    ds_read_b64_tr_b16 v[60:61], v25 offset:0
    ds_read_b64_tr_b16 v[62:63], v25 offset:1024
    v_mfma_f32_32x32x16_bf16 v[80:95], v[136:139], v[140:143], v[80:95]
    v_mfma_f32_32x32x16_bf16 v[96:111], v[132:135], v[144:147], v[96:111]
    v_mfma_f32_32x32x16_bf16 v[112:127], v[136:139], v[144:147], v[112:127]
    s_waitcnt lgkmcnt(6)
    v_mfma_f32_32x32x16_bf16 v[64:79], v[32:35], v[40:43], v[64:79]
    ds_read_b128 v[132:135], v17 offset:0
    ds_read_b64_tr_b16 v[140:141], v24 offset:4096
    ds_read_b64_tr_b16 v[142:143], v24 offset:5120
    ds_read_b128 v[136:139], v17 offset:4096
    ds_read_b64_tr_b16 v[144:145], v25 offset:4096
    ds_read_b64_tr_b16 v[146:147], v25 offset:5120
    v_mfma_f32_32x32x16_bf16 v[80:95], v[36:39], v[40:43], v[80:95]
    v_mfma_f32_32x32x16_bf16 v[96:111], v[32:35], v[44:47], v[96:111]
    v_mfma_f32_32x32x16_bf16 v[112:127], v[36:39], v[44:47], v[112:127]
    s_waitcnt lgkmcnt(6)
    v_mfma_f32_32x32x16_bf16 v[64:79], v[48:51], v[56:59], v[64:79]
    ds_read_b128 v[32:35], v18 offset:0
    ds_read_b64_tr_b16 v[40:41], v24 offset:8192
    ds_read_b64_tr_b16 v[42:43], v24 offset:9216
    ds_read_b128 v[36:39], v18 offset:4096
    ds_read_b64_tr_b16 v[44:45], v25 offset:8192
    ds_read_b64_tr_b16 v[46:47], v25 offset:9216
    v_mfma_f32_32x32x16_bf16 v[80:95], v[52:55], v[56:59], v[80:95]
    v_mfma_f32_32x32x16_bf16 v[96:111], v[48:51], v[60:63], v[96:111]
    v_mfma_f32_32x32x16_bf16 v[112:127], v[52:55], v[60:63], v[112:127]
    s_waitcnt lgkmcnt(6)
    v_mfma_f32_32x32x16_bf16 v[64:79], v[132:135], v[140:143], v[64:79]
    ds_read_b128 v[48:51], v19 offset:0
    ds_read_b64_tr_b16 v[56:57], v24 offset:12288
    ds_read_b64_tr_b16 v[58:59], v24 offset:13312
    ds_read_b128 v[52:55], v19 offset:4096
    ds_read_b64_tr_b16 v[60:61], v25 offset:12288
    ds_read_b64_tr_b16 v[62:63], v25 offset:13312
    v_mfma_f32_32x32x16_bf16 v[80:95], v[136:139], v[140:143], v[80:95]
    v_mfma_f32_32x32x16_bf16 v[96:111], v[132:135], v[144:147], v[96:111]
    v_mfma_f32_32x32x16_bf16 v[112:127], v[136:139], v[144:147], v[112:127]
    s_waitcnt lgkmcnt(0)
    s_barrier
    v_mfma_f32_32x32x16_bf16 v[64:79], v[32:35], v[40:43], v[64:79]
    ds_read_b128 v[132:135], v16 offset:32768
    ds_read_b64_tr_b16 v[140:141], v24 offset:32768
    ds_read_b64_tr_b16 v[142:143], v24 offset:33792
    ds_read_b128 v[136:139], v16 offset:36864
    ds_read_b64_tr_b16 v[144:145], v25 offset:32768
    ds_read_b64_tr_b16 v[146:147], v25 offset:33792
    v_mfma_f32_32x32x16_bf16 v[80:95], v[36:39], v[40:43], v[80:95]
    v_mfma_f32_32x32x16_bf16 v[96:111], v[32:35], v[44:47], v[96:111]
    v_mfma_f32_32x32x16_bf16 v[112:127], v[36:39], v[44:47], v[112:127]
    s_waitcnt lgkmcnt(6)
    v_mfma_f32_32x32x16_bf16 v[64:79], v[48:51], v[56:59], v[64:79]
    ds_read_b128 v[32:35], v17 offset:32768
    ds_read_b64_tr_b16 v[40:41], v24 offset:36864
    ds_read_b64_tr_b16 v[42:43], v24 offset:37888
    ds_read_b128 v[36:39], v17 offset:36864
    ds_read_b64_tr_b16 v[44:45], v25 offset:36864
    ds_read_b64_tr_b16 v[46:47], v25 offset:37888
    v_mfma_f32_32x32x16_bf16 v[80:95], v[52:55], v[56:59], v[80:95]
    v_mfma_f32_32x32x16_bf16 v[96:111], v[48:51], v[60:63], v[96:111]
    v_mfma_f32_32x32x16_bf16 v[112:127], v[52:55], v[60:63], v[112:127]
    s_waitcnt lgkmcnt(6)
    v_mfma_f32_32x32x16_bf16 v[64:79], v[132:135], v[140:143], v[64:79]
    ds_read_b128 v[48:51], v18 offset:32768
    ds_read_b64_tr_b16 v[56:57], v24 offset:40960
    ds_read_b64_tr_b16 v[58:59], v24 offset:41984
    ds_read_b128 v[52:55], v18 offset:36864
    ds_read_b64_tr_b16 v[60:61], v25 offset:40960
    ds_read_b64_tr_b16 v[62:63], v25 offset:41984
    v_mfma_f32_32x32x16_bf16 v[80:95], v[136:139], v[140:143], v[80:95]
    v_mfma_f32_32x32x16_bf16 v[96:111], v[132:135], v[144:147], v[96:111]
    v_mfma_f32_32x32x16_bf16 v[112:127], v[136:139], v[144:147], v[112:127]
    s_waitcnt lgkmcnt(6)
    v_mfma_f32_32x32x16_bf16 v[64:79], v[32:35], v[40:43], v[64:79]
    ds_read_b128 v[132:135], v19 offset:32768
    ds_read_b64_tr_b16 v[140:141], v24 offset:45056
    ds_read_b64_tr_b16 v[142:143], v24 offset:46080
    ds_read_b128 v[136:139], v19 offset:36864
    ds_read_b64_tr_b16 v[144:145], v25 offset:45056
    ds_read_b64_tr_b16 v[146:147], v25 offset:46080
    v_mfma_f32_32x32x16_bf16 v[80:95], v[36:39], v[40:43], v[80:95]
    v_mfma_f32_32x32x16_bf16 v[96:111], v[32:35], v[44:47], v[96:111]
    v_mfma_f32_32x32x16_bf16 v[112:127], v[36:39], v[44:47], v[112:127]
    s_waitcnt lgkmcnt(0)
    s_barrier
    v_mfma_f32_32x32x16_bf16 v[64:79], v[48:51], v[56:59], v[64:79]
    ds_read_b128 v[32:35], v20 offset:0
    ds_read_b64_tr_b16 v[40:41], v26 offset:0
    ds_read_b64_tr_b16 v[42:43], v26 offset:1024
    ds_read_b128 v[36:39], v20 offset:4096
    ds_read_b64_tr_b16 v[44:45], v27 offset:0
    ds_read_b64_tr_b16 v[46:47], v27 offset:1024
    v_mfma_f32_32x32x16_bf16 v[80:95], v[52:55], v[56:59], v[80:95]
    v_mfma_f32_32x32x16_bf16 v[96:111], v[48:51], v[60:63], v[96:111]
    v_mfma_f32_32x32x16_bf16 v[112:127], v[52:55], v[60:63], v[112:127]
    s_waitcnt lgkmcnt(6)
    v_mfma_f32_32x32x16_bf16 v[64:79], v[132:135], v[140:143], v[64:79]
    ds_read_b128 v[48:51], v21 offset:0
    ds_read_b64_tr_b16 v[56:57], v26 offset:4096
    ds_read_b64_tr_b16 v[58:59], v26 offset:5120
    ds_read_b128 v[52:55], v21 offset:4096
    ds_read_b64_tr_b16 v[60:61], v27 offset:4096
    ds_read_b64_tr_b16 v[62:63], v27 offset:5120
    v_mfma_f32_32x32x16_bf16 v[80:95], v[136:139], v[140:143], v[80:95]
    v_mfma_f32_32x32x16_bf16 v[96:111], v[132:135], v[144:147], v[96:111]
    v_mfma_f32_32x32x16_bf16 v[112:127], v[136:139], v[144:147], v[112:127]
    s_waitcnt lgkmcnt(6)
    v_mfma_f32_32x32x16_bf16 v[64:79], v[32:35], v[40:43], v[64:79]
    ds_read_b128 v[132:135], v22 offset:0
    ds_read_b64_tr_b16 v[140:141], v26 offset:8192
    ds_read_b64_tr_b16 v[142:143], v26 offset:9216
    ds_read_b128 v[136:139], v22 offset:4096
    ds_read_b64_tr_b16 v[144:145], v27 offset:8192
    ds_read_b64_tr_b16 v[146:147], v27 offset:9216
    v_mfma_f32_32x32x16_bf16 v[80:95], v[36:39], v[40:43], v[80:95]
    v_mfma_f32_32x32x16_bf16 v[96:111], v[32:35], v[44:47], v[96:111]
    v_mfma_f32_32x32x16_bf16 v[112:127], v[36:39], v[44:47], v[112:127]
    s_waitcnt lgkmcnt(6)
    v_mfma_f32_32x32x16_bf16 v[64:79], v[48:51], v[56:59], v[64:79]
    ds_read_b128 v[32:35], v23 offset:0
    ds_read_b64_tr_b16 v[40:41], v26 offset:12288
    ds_read_b64_tr_b16 v[42:43], v26 offset:13312
    ds_read_b128 v[36:39], v23 offset:4096
    ds_read_b64_tr_b16 v[44:45], v27 offset:12288
    ds_read_b64_tr_b16 v[46:47], v27 offset:13312
    v_mfma_f32_32x32x16_bf16 v[80:95], v[52:55], v[56:59], v[80:95]
    v_mfma_f32_32x32x16_bf16 v[96:111], v[48:51], v[60:63], v[96:111]
    v_mfma_f32_32x32x16_bf16 v[112:127], v[52:55], v[60:63], v[112:127]
    s_waitcnt lgkmcnt(0)
    s_barrier
    v_mfma_f32_32x32x16_bf16 v[64:79], v[132:135], v[140:143], v[64:79]
    ds_read_b128 v[48:51], v16 offset:0
    ds_read_b64_tr_b16 v[56:57], v24 offset:0
    ds_read_b64_tr_b16 v[58:59], v24 offset:1024
    ds_read_b128 v[52:55], v16 offset:4096
    ds_read_b64_tr_b16 v[60:61], v25 offset:0
    ds_read_b64_tr_b16 v[62:63], v25 offset:1024
    v_mfma_f32_32x32x16_bf16 v[80:95], v[136:139], v[140:143], v[80:95]
    v_mfma_f32_32x32x16_bf16 v[96:111], v[132:135], v[144:147], v[96:111]
    v_mfma_f32_32x32x16_bf16 v[112:127], v[136:139], v[144:147], v[112:127]
    s_waitcnt lgkmcnt(6)
    v_mfma_f32_32x32x16_bf16 v[64:79], v[32:35], v[40:43], v[64:79]
    ds_read_b128 v[132:135], v17 offset:0
    ds_read_b64_tr_b16 v[140:141], v24 offset:4096
    ds_read_b64_tr_b16 v[142:143], v24 offset:5120
    ds_read_b128 v[136:139], v17 offset:4096
    ds_read_b64_tr_b16 v[144:145], v25 offset:4096
    ds_read_b64_tr_b16 v[146:147], v25 offset:5120
    v_mfma_f32_32x32x16_bf16 v[80:95], v[36:39], v[40:43], v[80:95]
    v_mfma_f32_32x32x16_bf16 v[96:111], v[32:35], v[44:47], v[96:111]
    v_mfma_f32_32x32x16_bf16 v[112:127], v[36:39], v[44:47], v[112:127]
    s_waitcnt lgkmcnt(6)
    v_mfma_f32_32x32x16_bf16 v[64:79], v[48:51], v[56:59], v[64:79]
    ds_read_b128 v[32:35], v18 offset:0
    ds_read_b64_tr_b16 v[40:41], v24 offset:8192
    ds_read_b64_tr_b16 v[42:43], v24 offset:9216
    ds_read_b128 v[36:39], v18 offset:4096
    ds_read_b64_tr_b16 v[44:45], v25 offset:8192
    ds_read_b64_tr_b16 v[46:47], v25 offset:9216
    v_mfma_f32_32x32x16_bf16 v[80:95], v[52:55], v[56:59], v[80:95]
    v_mfma_f32_32x32x16_bf16 v[96:111], v[48:51], v[60:63], v[96:111]
    v_mfma_f32_32x32x16_bf16 v[112:127], v[52:55], v[60:63], v[112:127]
    s_waitcnt lgkmcnt(6)
    v_mfma_f32_32x32x16_bf16 v[64:79], v[132:135], v[140:143], v[64:79]
    ds_read_b128 v[48:51], v19 offset:0
    ds_read_b64_tr_b16 v[56:57], v24 offset:12288
    ds_read_b64_tr_b16 v[58:59], v24 offset:13312
    ds_read_b128 v[52:55], v19 offset:4096
    ds_read_b64_tr_b16 v[60:61], v25 offset:12288
    ds_read_b64_tr_b16 v[62:63], v25 offset:13312
    v_mfma_f32_32x32x16_bf16 v[80:95], v[136:139], v[140:143], v[80:95]
    v_mfma_f32_32x32x16_bf16 v[96:111], v[132:135], v[144:147], v[96:111]
    v_mfma_f32_32x32x16_bf16 v[112:127], v[136:139], v[144:147], v[112:127]
    s_waitcnt lgkmcnt(0)
    s_barrier
    v_mfma_f32_32x32x16_bf16 v[64:79], v[32:35], v[40:43], v[64:79]
    ds_read_b128 v[132:135], v16 offset:32768
    ds_read_b64_tr_b16 v[140:141], v24 offset:32768
    ds_read_b64_tr_b16 v[142:143], v24 offset:33792
    ds_read_b128 v[136:139], v16 offset:36864
    ds_read_b64_tr_b16 v[144:145], v25 offset:32768
    ds_read_b64_tr_b16 v[146:147], v25 offset:33792
    v_mfma_f32_32x32x16_bf16 v[80:95], v[36:39], v[40:43], v[80:95]
    v_mfma_f32_32x32x16_bf16 v[96:111], v[32:35], v[44:47], v[96:111]
    v_mfma_f32_32x32x16_bf16 v[112:127], v[36:39], v[44:47], v[112:127]
    s_waitcnt lgkmcnt(6)
    v_mfma_f32_32x32x16_bf16 v[64:79], v[48:51], v[56:59], v[64:79]
    ds_read_b128 v[32:35], v17 offset:32768
    ds_read_b64_tr_b16 v[40:41], v24 offset:36864
    ds_read_b64_tr_b16 v[42:43], v24 offset:37888
    ds_read_b128 v[36:39], v17 offset:36864
    ds_read_b64_tr_b16 v[44:45], v25 offset:36864
    ds_read_b64_tr_b16 v[46:47], v25 offset:37888
    v_mfma_f32_32x32x16_bf16 v[80:95], v[52:55], v[56:59], v[80:95]
    v_mfma_f32_32x32x16_bf16 v[96:111], v[48:51], v[60:63], v[96:111]
    v_mfma_f32_32x32x16_bf16 v[112:127], v[52:55], v[60:63], v[112:127]
    s_waitcnt lgkmcnt(6)
    v_mfma_f32_32x32x16_bf16 v[64:79], v[132:135], v[140:143], v[64:79]
    ds_read_b128 v[48:51], v18 offset:32768
    ds_read_b64_tr_b16 v[56:57], v24 offset:40960
    ds_read_b64_tr_b16 v[58:59], v24 offset:41984
    ds_read_b128 v[52:55], v18 offset:36864
    ds_read_b64_tr_b16 v[60:61], v25 offset:40960
    ds_read_b64_tr_b16 v[62:63], v25 offset:41984
    v_mfma_f32_32x32x16_bf16 v[80:95], v[136:139], v[140:143], v[80:95]
    v_mfma_f32_32x32x16_bf16 v[96:111], v[132:135], v[144:147], v[96:111]
    v_mfma_f32_32x32x16_bf16 v[112:127], v[136:139], v[144:147], v[112:127]
    s_waitcnt lgkmcnt(6)
    v_mfma_f32_32x32x16_bf16 v[64:79], v[32:35], v[40:43], v[64:79]
    ds_read_b128 v[132:135], v19 offset:32768
    ds_read_b64_tr_b16 v[140:141], v24 offset:45056
    ds_read_b64_tr_b16 v[142:143], v24 offset:46080
    ds_read_b128 v[136:139], v19 offset:36864
    ds_read_b64_tr_b16 v[144:145], v25 offset:45056
    ds_read_b64_tr_b16 v[146:147], v25 offset:46080
    v_mfma_f32_32x32x16_bf16 v[80:95], v[36:39], v[40:43], v[80:95]
    v_mfma_f32_32x32x16_bf16 v[96:111], v[32:35], v[44:47], v[96:111]
    v_mfma_f32_32x32x16_bf16 v[112:127], v[36:39], v[44:47], v[112:127]
    s_waitcnt lgkmcnt(0)
    s_barrier
    v_mfma_f32_32x32x16_bf16 v[64:79], v[48:51], v[56:59], v[64:79]
    ds_read_b128 v[32:35], v20 offset:0
    ds_read_b64_tr_b16 v[40:41], v26 offset:0
    ds_read_b64_tr_b16 v[42:43], v26 offset:1024
    ds_read_b128 v[36:39], v20 offset:4096
    ds_read_b64_tr_b16 v[44:45], v27 offset:0
    ds_read_b64_tr_b16 v[46:47], v27 offset:1024
    v_mfma_f32_32x32x16_bf16 v[80:95], v[52:55], v[56:59], v[80:95]
    v_mfma_f32_32x32x16_bf16 v[96:111], v[48:51], v[60:63], v[96:111]
    v_mfma_f32_32x32x16_bf16 v[112:127], v[52:55], v[60:63], v[112:127]
    s_waitcnt lgkmcnt(6)
    v_mfma_f32_32x32x16_bf16 v[64:79], v[132:135], v[140:143], v[64:79]
    ds_read_b128 v[48:51], v21 offset:0
    ds_read_b64_tr_b16 v[56:57], v26 offset:4096
    ds_read_b64_tr_b16 v[58:59], v26 offset:5120
    ds_read_b128 v[52:55], v21 offset:4096
    ds_read_b64_tr_b16 v[60:61], v27 offset:4096
    ds_read_b64_tr_b16 v[62:63], v27 offset:5120
    v_mfma_f32_32x32x16_bf16 v[80:95], v[136:139], v[140:143], v[80:95]
    v_mfma_f32_32x32x16_bf16 v[96:111], v[132:135], v[144:147], v[96:111]
    v_mfma_f32_32x32x16_bf16 v[112:127], v[136:139], v[144:147], v[112:127]
    s_waitcnt lgkmcnt(6)
    v_mfma_f32_32x32x16_bf16 v[64:79], v[32:35], v[40:43], v[64:79]
    ds_read_b128 v[132:135], v22 offset:0
    ds_read_b64_tr_b16 v[140:141], v26 offset:8192
    ds_read_b64_tr_b16 v[142:143], v26 offset:9216
    ds_read_b128 v[136:139], v22 offset:4096
    ds_read_b64_tr_b16 v[144:145], v27 offset:8192
    ds_read_b64_tr_b16 v[146:147], v27 offset:9216
    v_mfma_f32_32x32x16_bf16 v[80:95], v[36:39], v[40:43], v[80:95]
    v_mfma_f32_32x32x16_bf16 v[96:111], v[32:35], v[44:47], v[96:111]
    v_mfma_f32_32x32x16_bf16 v[112:127], v[36:39], v[44:47], v[112:127]
    s_waitcnt lgkmcnt(6)
    v_mfma_f32_32x32x16_bf16 v[64:79], v[48:51], v[56:59], v[64:79]
    ds_read_b128 v[32:35], v23 offset:0
    ds_read_b64_tr_b16 v[40:41], v26 offset:12288
    ds_read_b64_tr_b16 v[42:43], v26 offset:13312
    ds_read_b128 v[36:39], v23 offset:4096
    ds_read_b64_tr_b16 v[44:45], v27 offset:12288
    ds_read_b64_tr_b16 v[46:47], v27 offset:13312
    v_mfma_f32_32x32x16_bf16 v[80:95], v[52:55], v[56:59], v[80:95]
    v_mfma_f32_32x32x16_bf16 v[96:111], v[48:51], v[60:63], v[96:111]
    v_mfma_f32_32x32x16_bf16 v[112:127], v[52:55], v[60:63], v[112:127]
    s_waitcnt lgkmcnt(6)
    v_mfma_f32_32x32x16_bf16 v[64:79], v[132:135], v[140:143], v[64:79]
    v_mfma_f32_32x32x16_bf16 v[80:95], v[136:139], v[140:143], v[80:95]
    v_mfma_f32_32x32x16_bf16 v[96:111], v[132:135], v[144:147], v[96:111]
    v_mfma_f32_32x32x16_bf16 v[112:127], v[136:139], v[144:147], v[112:127]
    s_waitcnt lgkmcnt(0)
    v_mfma_f32_32x32x16_bf16 v[64:79], v[32:35], v[40:43], v[64:79]
    v_mfma_f32_32x32x16_bf16 v[80:95], v[36:39], v[40:43], v[80:95]
    v_mfma_f32_32x32x16_bf16 v[96:111], v[32:35], v[44:47], v[96:111]
    v_mfma_f32_32x32x16_bf16 v[112:127], v[36:39], v[44:47], v[112:127]
    s_nop 15
    v_cvt_pk_bf16_f32 v64, v64, v65
    v_cvt_pk_bf16_f32 v65, v66, v67
    v_cvt_pk_bf16_f32 v66, v68, v69
    v_cvt_pk_bf16_f32 v67, v70, v71
    buffer_store_dwordx4 v[64:67], v128, s[28:31], s62 offen offset:0 sc1
    v_cvt_pk_bf16_f32 v72, v72, v73
    v_cvt_pk_bf16_f32 v73, v74, v75
    v_cvt_pk_bf16_f32 v74, v76, v77
    v_cvt_pk_bf16_f32 v75, v78, v79
    buffer_store_dwordx4 v[72:75], v128, s[28:31], s63 offen offset:0 sc1
    v_cvt_pk_bf16_f32 v80, v80, v81
    v_cvt_pk_bf16_f32 v81, v82, v83
    v_cvt_pk_bf16_f32 v82, v84, v85
    v_cvt_pk_bf16_f32 v83, v86, v87
    buffer_store_dwordx4 v[80:83], v128, s[28:31], s64 offen offset:0 sc1
    v_cvt_pk_bf16_f32 v88, v88, v89
    v_cvt_pk_bf16_f32 v89, v90, v91
    v_cvt_pk_bf16_f32 v90, v92, v93
    v_cvt_pk_bf16_f32 v91, v94, v95
    buffer_store_dwordx4 v[88:91], v128, s[28:31], s65 offen offset:0 sc1
    v_cvt_pk_bf16_f32 v96, v96, v97
    v_cvt_pk_bf16_f32 v97, v98, v99
    v_cvt_pk_bf16_f32 v98, v100, v101
    v_cvt_pk_bf16_f32 v99, v102, v103
    buffer_store_dwordx4 v[96:99], v128, s[28:31], s62 offen offset:1024 sc1
    v_cvt_pk_bf16_f32 v104, v104, v105
    v_cvt_pk_bf16_f32 v105, v106, v107
    v_cvt_pk_bf16_f32 v106, v108, v109
    v_cvt_pk_bf16_f32 v107, v110, v111
    buffer_store_dwordx4 v[104:107], v128, s[28:31], s63 offen offset:1024 sc1
    v_cvt_pk_bf16_f32 v112, v112, v113
    v_cvt_pk_bf16_f32 v113, v114, v115
    v_cvt_pk_bf16_f32 v114, v116, v117
    v_cvt_pk_bf16_f32 v115, v118, v119
    buffer_store_dwordx4 v[112:115], v128, s[28:31], s64 offen offset:1024 sc1
    v_cvt_pk_bf16_f32 v120, v120, v121
    v_cvt_pk_bf16_f32 v121, v122, v123
    v_cvt_pk_bf16_f32 v122, v124, v125
    v_cvt_pk_bf16_f32 v123, v126, v127
    buffer_store_dwordx4 v[120:123], v128, s[28:31], s65 offen offset:1024 sc1
    v_cmp_eq_u32 vcc, 0, v0
    v_mov_b32 v36, 0x3f803f80
    s_nop 0
    v_cndmask_b32 v32, 0, v36, vcc
    v_cndmask_b32 v33, 0, v36, vcc
    v_cndmask_b32 v34, 0, v36, vcc
    v_cndmask_b32 v35, 0, v36, vcc
    s_mov_b64 exec, 15
    buffer_store_dwordx4 v[32:35], v128, s[28:31], s58 offen sc1
    s_mov_b64 exec, -1
L_gsig_2:
    s_waitcnt vmcnt(0)
    v_mov_b32 v2, 162048
    v_mov_b32 v3, 1
    s_mov_b64 exec, 1
    ds_add_rtn_u32 v3, v2, v3
    s_waitcnt lgkmcnt(0)
    s_mov_b64 exec, -1
    v_readfirstlane_b32 s66, v3
    s_nop 3
    s_add_u32 s66, s66, 1
    s_cmp_lg_u32 s66, 4
    s_cbranch_scc1 L_qs_14
    v_mov_b32 v2, 162068
    s_mov_b32 s66, 3200000
L_lw_15:
    ds_read_b32 v3, v2
    s_waitcnt lgkmcnt(0)
    v_readfirstlane_b32 s67, v3
    s_nop 3
    s_cmp_ge_u32 s67, 1
    s_cbranch_scc1 L_lwd_16
    s_sleep 1
    s_sub_u32 s66, s66, 1
    s_cmp_lg_u32 s66, 0
    s_cbranch_scc1 L_lw_15
L_lwd_16:
    s_lshl_b32 s65, s48, 4
    s_add_u32 s65, s65, s43
    s_add_u32 s65, s65, 48
    s_lshl_b32 s66, s65, 7
    s_add_u32 s66, s66, 18874368
    v_mov_b32 v2, s66
    v_mov_b32 v3, 1
    s_mov_b64 exec, 1
    global_store_dword v2, v3, s[26:27] sc1
    s_mov_b64 exec, -1
L_qs_14:
    s_branch L_heads
L_nog:
    s_cmp_lg_u32 s2, 225
    s_cbranch_scc1 L_nz_17
    v_lshlrev_b32 v2, 4, v0
    v_add_u32 v2, 18874368, v2
    v_mov_b32 v4, 0
    v_mov_b32 v5, 0
    v_mov_b32 v6, 0
    v_mov_b32 v7, 0
    s_mul_i32 s54, s40, 5120
    buffer_store_dwordx4 v[4:7], v2, s[28:31], s54 offen sc1
    s_add_u32 s54, s54, 1024
    buffer_store_dwordx4 v[4:7], v2, s[28:31], s54 offen sc1
    s_add_u32 s54, s54, 1024
    buffer_store_dwordx4 v[4:7], v2, s[28:31], s54 offen sc1
    s_add_u32 s54, s54, 1024
    buffer_store_dwordx4 v[4:7], v2, s[28:31], s54 offen sc1
    s_add_u32 s54, s54, 1024
    buffer_store_dwordx4 v[4:7], v2, s[28:31], s54 offen sc1
    s_add_u32 s54, s54, 1024
    s_waitcnt vmcnt(0)
    v_mov_b32 v2, 162084
    v_mov_b32 v3, 1
    s_mov_b64 exec, 1
    ds_add_rtn_u32 v3, v2, v3
    s_waitcnt lgkmcnt(0)
    s_mov_b64 exec, -1
    v_readfirstlane_b32 s66, v3
    s_nop 3
    s_add_u32 s66, s66, 1
    s_cmp_lg_u32 s66, 8
    s_cbranch_scc1 L_nz_17
    v_mov_b32 v2, 0
    v_mov_b32 v3, 1
    s_mov_b64 exec, 1
    global_store_dword v2, v3, s[24:25] sc1
    s_mov_b64 exec, -1
L_nz_17:
    s_branch L_nogtask
L_nogdone:
    v_mov_b32 v2, 162048
    v_mov_b32 v3, 4
    ds_write_b32 v2, v3
L_heads:
    s_lshl_b32 s43, s41, 2
    s_lshr_b32 s44, s42, 3
    s_add_u32 s43, s43, s44
    s_and_b32 s44, s42, 7
    s_lshl_b32 s46, s44, 3
    s_add_u32 s46, s46, s40
    s_mov_b32 s47, 0x60060
    s_cmp_eq_u32 s43, 1
    s_cmov_b32 s47, 0x60808
    s_cmp_eq_u32 s43, 2
    s_cmov_b32 s47, 0xe1068
    s_cmp_eq_u32 s43, 3
    s_cmov_b32 s47, 0xe1828
    s_cmp_eq_u32 s43, 4
    s_cmov_b32 s47, 0x162070
    s_cmp_eq_u32 s43, 5
    s_cmov_b32 s47, 0x162848
    s_cmp_eq_u32 s43, 6
    s_cmov_b32 s47, 0x640f8
    s_cmp_eq_u32 s43, 7
    s_cmov_b32 s47, 0x64889
    s_cmp_eq_u32 s43, 8
    s_cmov_b32 s47, 0xe50e1
    s_cmp_eq_u32 s43, 9
    s_cmov_b32 s47, 0xe58a9
    s_cmp_eq_u32 s43, 10
    s_cmov_b32 s47, 0x1660e9
    s_cmp_eq_u32 s43, 11
    s_cmov_b32 s47, 0x1668c9
    s_cmp_eq_u32 s43, 12
    s_cmov_b32 s47, 0x6bcf1
    s_cmp_eq_u32 s43, 13
    s_cmov_b32 s47, 0x68502
    s_cmp_eq_u32 s43, 14
    s_cmov_b32 s47, 0xe9112
    s_cmp_eq_u32 s43, 15
    s_cmov_b32 s47, 0xe992a
    s_cmp_eq_u32 s43, 16
    s_cmov_b32 s47, 0x16a162
    s_cmp_eq_u32 s43, 17
    s_cmov_b32 s47, 0x16a94a
    s_cmp_eq_u32 s43, 18
    s_cmov_b32 s47, 0x1eb96a
    s_cmp_eq_u32 s43, 19
    s_cmov_b32 s47, 0x1ea1a3
    s_cmp_eq_u32 s43, 20
    s_cmov_b32 s47, 0x6c1e3
    s_cmp_eq_u32 s43, 21
    s_cmov_b32 s47, 0x6c98b
    s_cmp_eq_u32 s43, 22
    s_cmov_b32 s47, 0xee5eb
    s_cmp_eq_u32 s43, 23
    s_cmov_b32 s47, 0xed9ab
    s_cmp_eq_u32 s43, 24
    s_cmov_b32 s47, 0x16fdf3
    s_cmp_eq_u32 s43, 25
    s_cmov_b32 s47, 0x16e253
    s_cmp_eq_u32 s43, 26
    s_cmov_b32 s47, 0x70264
    s_cmp_eq_u32 s43, 27
    s_cmov_b32 s47, 0x70a0c
    s_cmp_eq_u32 s43, 28
    s_cmov_b32 s47, 0xf126c
    s_cmp_eq_u32 s43, 29
    s_cmov_b32 s47, 0xf1a2c
    s_cmp_eq_u32 s43, 30
    s_cmov_b32 s47, 0x173e74
    s_cmp_eq_u32 s43, 31
    s_cmov_b32 s47, 0x172a4c
    s_bfe_u32 s54, s47, 0x30000
    s_bfe_u32 s55, s47, 0x40003
    s_mul_i32 s54, s54, 532480
    s_lshl_b32 s55, s55, 9
    s_add_u32 s50, s54, s55
    s_bfe_u32 s54, s47, 0x30007
    s_bfe_u32 s55, s47, 0x4000a
    s_mul_i32 s54, s54, 532480
    s_lshl_b32 s55, s55, 9
    s_add_u32 s51, s54, s55
    s_bfe_u32 s54, s47, 0x3000e
    s_bfe_u32 s55, s47, 0x40011
    s_mul_i32 s54, s54, 532480
    s_lshl_b32 s55, s55, 9
    s_add_u32 s52, s54, s55
    v_and_b32 v3, 31, v0
    v_lshrrev_b32 v12, 5, v0
    v_lshlrev_b32 v13, 4, v3
    v_cmp_eq_u32 vcc, 0, v12
    v_mov_b32 v14, s50
    v_mov_b32 v15, s51
    v_cndmask_b32 v14, v15, v14, vcc
    v_add_u32 v129, v14, v13
    s_and_b32 s54, s43, 1
    s_lshl_b32 s54, s54, 3
    s_add_u32 s54, s54, s52
    v_add_u32 v130, s54, v13
    v_add_u32 v126, 2679040, v129
    s_mul_i32 s53, s43, 20
    s_add_u32 s45, s53, 19
    s_lshr_b32 s45, s45, 7
    s_add_u32 s45, s45, 10
    s_mul_i32 s45, s45, 532480
    s_add_u32 s45, s45, 8192
    v_cmp_gt_u32 vcc, 56, v0
    v_subrev_u32 v8, 32, v0
    v_subrev_u32 v9, 56, v0
    v_cndmask_b32 v8, v9, v8, vcc
    v_mov_b32 v9, 1
    v_mov_b32 v10, 0
    v_cndmask_b32 v9, v9, v10, vcc
    v_add_u32 v5, s53, v8
    v_lshrrev_b32 v6, 7, v5
    v_add_u32 v6, 10, v6
    v_mul_u32_u24 v6, 8320, v6
    v_lshlrev_b32 v6, 6, v6
    v_bfe_u32 v7, v5, 5, 2
    v_lshlrev_b32 v7, 10, v7
    v_add_u32 v6, v6, v7
    v_and_b32 v7, 31, v5
    v_lshl_add_u32 v6, v7, 4, v6
    v_lshrrev_b32 v7, 1, v9
    v_lshl_add_u32 v6, v7, 12, v6
    v_and_b32 v7, 1, v9
    v_lshl_add_u32 v6, v7, 9, v6
    v_subrev_u32 v7, 20, v8
    v_and_b32 v7, 3, v7
    v_lshlrev_b32 v7, 4, v7
    v_add_u32 v7, s45, v7
    v_cmp_gt_u32 vcc, 20, v8
    s_nop 1
    v_cndmask_b32 v11, v7, v6, vcc
    v_add_u32 v6, s52, v13
    v_add_u32 v6, 2679040, v6
    v_cmp_gt_u32 vcc, 32, v0
    s_nop 1
    v_cndmask_b32 v127, v11, v6, vcc
    v_cmp_gt_u32 vcc, 16, v0
    v_cmp_gt_u32 s[54:55], 40, v0
    v_subrev_u32 v8, 40, v0
    v_subrev_u32 v10, 16, v0
    v_cndmask_b32 v8, v8, v10, s[54:55]
    v_add_u32 v10, 8, v0
    v_cndmask_b32 v8, v8, v10, vcc
    v_mov_b32 v9, 3
    v_mov_b32 v10, 2
    v_cndmask_b32 v9, v9, v10, s[54:55]
    v_mov_b32 v10, 1
    v_cndmask_b32 v9, v9, v10, vcc
    v_add_u32 v5, s53, v8
    v_lshrrev_b32 v6, 7, v5
    v_add_u32 v6, 10, v6
    v_mul_u32_u24 v6, 8320, v6
    v_lshlrev_b32 v6, 6, v6
    v_bfe_u32 v7, v5, 5, 2
    v_lshlrev_b32 v7, 10, v7
    v_add_u32 v6, v6, v7
    v_and_b32 v7, 31, v5
    v_lshl_add_u32 v6, v7, 4, v6
    v_lshrrev_b32 v7, 1, v9
    v_lshl_add_u32 v6, v7, 12, v6
    v_and_b32 v7, 1, v9
    v_lshl_add_u32 v6, v7, 9, v6
    v_subrev_u32 v7, 20, v8
    v_and_b32 v7, 3, v7
    v_lshlrev_b32 v7, 4, v7
    v_add_u32 v7, s45, v7
    v_cmp_gt_u32 vcc, 20, v8
    s_nop 1
    v_cndmask_b32 v128, v7, v6, vcc
    v_mov_b32 v8, v3
    v_mov_b32 v9, v12
    v_add_u32 v5, s53, v8
    v_lshrrev_b32 v6, 7, v5
    v_add_u32 v6, 10, v6
    v_mul_u32_u24 v6, 8320, v6
    v_lshlrev_b32 v6, 6, v6
    v_bfe_u32 v7, v5, 5, 2
    v_lshlrev_b32 v7, 10, v7
    v_add_u32 v6, v6, v7
    v_and_b32 v7, 31, v5
    v_lshl_add_u32 v6, v7, 4, v6
    v_lshrrev_b32 v7, 1, v9
    v_lshl_add_u32 v6, v7, 12, v6
    v_and_b32 v7, 1, v9
    v_lshl_add_u32 v6, v7, 9, v6
    v_subrev_u32 v7, 20, v8
    v_and_b32 v7, 3, v7
    v_lshlrev_b32 v7, 4, v7
    v_add_u32 v7, s45, v7
    v_cmp_gt_u32 vcc, 20, v8
    s_nop 1
    v_cndmask_b32 v131, v7, v6, vcc
    s_mov_b32 s32, s8
    s_mov_b32 s33, s9
    s_mov_b32 s34, 0xc8000
    s_mov_b32 s35, 0x00020000
    s_and_b32 s52, s42, 7
    s_mul_i32 s52, s52, 160
    v_add_u32 v5, 0, v0
    v_mul_u32_u24 v6, 52429, v5
    v_lshrrev_b32 v6, 19, v6
    v_mul_u32_u24 v7, 10, v6
    v_sub_u32 v7, v5, v7
    v_mul_u32_u24 v6, 1280, v6
    v_lshl_add_u32 v6, v7, 4, v6
    v_add_u32 v120, s52, v6
    v_add_u32 v5, 64, v0
    v_mul_u32_u24 v6, 52429, v5
    v_lshrrev_b32 v6, 19, v6
    v_mul_u32_u24 v7, 10, v6
    v_sub_u32 v7, v5, v7
    v_mul_u32_u24 v6, 1280, v6
    v_lshl_add_u32 v6, v7, 4, v6
    v_add_u32 v121, s52, v6
    v_add_u32 v5, 128, v0
    v_mul_u32_u24 v6, 52429, v5
    v_lshrrev_b32 v6, 19, v6
    v_mul_u32_u24 v7, 10, v6
    v_sub_u32 v7, v5, v7
    v_mul_u32_u24 v6, 1280, v6
    v_lshl_add_u32 v6, v7, 4, v6
    v_add_u32 v122, s52, v6
    v_add_u32 v5, 192, v0
    v_mul_u32_u24 v6, 52429, v5
    v_lshrrev_b32 v6, 19, v6
    v_mul_u32_u24 v7, 10, v6
    v_sub_u32 v7, v5, v7
    v_mul_u32_u24 v6, 1280, v6
    v_lshl_add_u32 v6, v7, 4, v6
    v_add_u32 v123, s52, v6
    v_add_u32 v5, 256, v0
    v_mul_u32_u24 v6, 52429, v5
    v_lshrrev_b32 v6, 19, v6
    v_mul_u32_u24 v7, 10, v6
    v_sub_u32 v7, v5, v7
    v_mul_u32_u24 v6, 1280, v6
    v_lshl_add_u32 v6, v7, 4, v6
    v_add_u32 v124, s52, v6
    s_mul_i32 s53, s40, 5120
    s_mul_i32 s62, s40, 40960
    s_mov_b32 s60, 0
    v_lshlrev_b32 v2, 4, v0
    v_mul_u32_u24 v13, 384, v12
    v_lshl_add_u32 v13, v3, 4, v13
    v_add_u32 v98, 1536, v13
    v_mov_b32 v96, v2
    s_and_b32 s54, s43, 1
    s_lshl_b32 s54, s54, 3
    s_add_u32 s54, s54, 1024
    v_lshlrev_b32 v1, 4, v3
    v_add_u32 v97, s54, v1
    v_add_u32 v101, 49152, v98
    v_add_u32 v99, 49152, v96
    v_add_u32 v100, 49152, v97
    v_cmp_lt_u32 vcc, 20, v3
    v_mov_b32 v5, 0x30000
    v_mov_b32 v10, 0
    v_cndmask_b32 v98, v98, v5, vcc
    v_cndmask_b32 v101, v101, v5, vcc
    v_mov_b32 v11, 0
    v_mov_b32 v86, 0
    v_mov_b32 v87, 0
    v_mov_b32 v110, 0
    v_mov_b32 v111, 0
    v_mov_b32 v164, 0x7ff00000
    s_mul_i32 s45, s46, 8320
    s_mul_i32 s49, s40, 3072
    s_mul_i32 s50, s40, 8320
    s_cmp_lg_u32 s40, 0
    s_cbranch_scc1 L_gow_18
    v_mov_b32 v5, 162048
    s_mov_b32 s66, 3200000
L_lw_20:
    ds_read_b32 v6, v5
    s_waitcnt lgkmcnt(0)
    v_readfirstlane_b32 s67, v6
    s_nop 3
    s_cmp_ge_u32 s67, 4
    s_cbranch_scc1 L_lwd_21
    s_sleep 1
    s_sub_u32 s66, s66, 1
    s_cmp_lg_u32 s66, 0
    s_cbranch_scc1 L_lw_20
L_lwd_21:
    v_mov_b32 v5, 162068
    s_mov_b32 s66, 3200000
L_lw_22:
    ds_read_b32 v6, v5
    s_waitcnt lgkmcnt(0)
    v_readfirstlane_b32 s67, v6
    s_nop 3
    s_cmp_ge_u32 s67, 1
    s_cbranch_scc1 L_lwd_23
    s_sleep 1
    s_sub_u32 s66, s66, 1
    s_cmp_lg_u32 s66, 0
    s_cbranch_scc1 L_lw_22
L_lwd_23:
    s_mul_i32 s54, s43, 5
    s_add_u32 s55, s54, 4
    s_lshr_b32 s54, s54, 5
    s_lshr_b32 s55, s55, 5
    v_bfe_u32 v5, v0, 4, 1
    v_cmp_eq_u32 vcc, 1, v5
    v_mov_b32 v6, s54
    v_mov_b32 v7, s55
    v_cndmask_b32 v6, v6, v7, vcc
    v_lshrrev_b32 v5, 5, v0
    v_mul_u32_u24 v5, 5, v5
    v_add_u32 v5, v5, v6
    v_add_u32 v6, 10, v6
    v_and_b32 v7, 15, v0
    v_lshl_add_u32 v5, v5, 4, v7
    v_lshl_add_u32 v6, v6, 4, v7
    v_lshlrev_b32 v5, 7, v5
    v_lshlrev_b32 v6, 7, v6
    v_add_u32 v5, 18880512, v5
    v_add_u32 v6, 18880512, v6
    s_mov_b32 s66, 200000
L_poll2_24:
    global_load_dword v7, v5, s[26:27] sc1
    global_load_dword v8, v6, s[26:27] sc1
    s_waitcnt vmcnt(0)
    v_min_u32 v7, v7, v8
    v_cmp_le_u32 vcc, 1, v7
    s_nop 3
    s_cmp_eq_u64 vcc, -1
    s_cbranch_scc1 L_poll2d_25
    s_sleep 2
    s_sub_u32 s66, s66, 1
    s_cmp_lg_u32 s66, 0
    s_cbranch_scc1 L_poll2_24
L_poll2d_25:
    v_mov_b32 v5, 162072
    v_mov_b32 v6, 1
    ds_write_b32 v5, v6
    s_branch L_go_19
L_gow_18:
    v_mov_b32 v5, 162072
    s_mov_b32 s66, 3200000
L_lw_26:
    ds_read_b32 v6, v5
    s_waitcnt lgkmcnt(0)
    v_readfirstlane_b32 s67, v6
    s_nop 3
    s_cmp_ge_u32 s67, 1
    s_cbranch_scc1 L_lwd_27
    s_sleep 1
    s_sub_u32 s66, s66, 1
    s_cmp_lg_u32 s66, 0
    s_cbranch_scc1 L_lw_26
L_lwd_27:
L_go_19:
    buffer_load_dwordx4 v[4:7], v129, s[28:31], s45 offen sc1
    buffer_load_dwordx2 v[8:9], v130, s[28:31], s45 offen sc1
    s_mov_b32 s48, 2662400
    buffer_load_dwordx4 v[104:107], v129, s[28:31], s48 offen sc1
    buffer_load_dwordx2 v[108:109], v130, s[28:31], s48 offen sc1
    s_mov_b32 s48, 2670720
    buffer_load_dwordx4 v[80:83], v129, s[28:31], s48 offen sc1
    buffer_load_dwordx2 v[84:85], v130, s[28:31], s48 offen sc1
    s_add_u32 m0, s49, 0
    s_add_u32 s51, s50, 0
    buffer_load_dwordx4 v126, s[28:31], s51 offen sc1 lds
    s_add_u32 m0, s49, 1024
    s_add_u32 s51, s50, 0
    buffer_load_dwordx4 v127, s[28:31], s51 offen sc1 lds
    s_add_u32 m0, s49, 2048
    s_add_u32 s51, s50, 0
    buffer_load_dwordx4 v128, s[28:31], s51 offen sc1 lds
    s_add_u32 m0, s49, 24576
    s_add_u32 s51, s50, 66560
    buffer_load_dwordx4 v126, s[28:31], s51 offen sc1 lds
    s_add_u32 m0, s49, 25600
    s_add_u32 s51, s50, 66560
    buffer_load_dwordx4 v127, s[28:31], s51 offen sc1 lds
    s_add_u32 m0, s49, 26624
    s_add_u32 s51, s50, 66560
    buffer_load_dwordx4 v128, s[28:31], s51 offen sc1 lds
    v_cmp_gt_u32 vcc, 32, v0
    s_waitcnt vmcnt(0)
    s_nop 0
    v_cndmask_b32 v8, 0, v8, vcc
    v_cndmask_b32 v9, 0, v9, vcc
    v_mov_b32 v12, 162076
    v_mov_b32 v13, 1
    s_mov_b64 exec, 1
    ds_add_u32 v12, v13
    s_mov_b64 exec, -1
    v_mov_b32 v12, 162076
    s_mov_b32 s66, 3200000
L_lw_28:
    ds_read_b32 v13, v12
    s_waitcnt lgkmcnt(0)
    v_readfirstlane_b32 s67, v13
    s_nop 3
    s_cmp_ge_u32 s67, 8
    s_cbranch_scc1 L_lwd_29
    s_sleep 0
    s_sub_u32 s66, s66, 1
    s_cmp_lg_u32 s66, 0
    s_cbranch_scc1 L_lw_28
L_lwd_29:
    v_mfma_f32_32x32x16_bf16 v[32:47], v[104:107], v[4:7], 0
    v_mfma_f32_32x32x8bf16_1k v[32:47], v[108:109], v[8:9], v[32:47]
    s_nop 7
    s_nop 7
    s_setprio 3
    v_mfma_f32_32x32x16_bf16 v[48:63], v[80:83], v[4:7], 0
    ds_read_b128 v[80:83], v96 offset:0
    v_exp_f32 v32, v32
    v_exp_f32 v33, v33
    v_exp_f32 v34, v34
    v_exp_f32 v35, v35
    v_cvt_pk_bf16_f32 v64, v32, v33
    v_cvt_pk_bf16_f32 v65, v34, v35
    v_mfma_f32_32x32x8bf16_1k v[48:63], v[84:85], v[8:9], v[48:63]
    ds_read_b64 v[84:85], v97 offset:0
    v_exp_f32 v36, v36
    v_exp_f32 v37, v37
    v_exp_f32 v38, v38
    v_exp_f32 v39, v39
    v_cvt_pk_bf16_f32 v66, v36, v37
    v_cvt_pk_bf16_f32 v67, v38, v39
    ds_read_b128 v[88:91], v98 offset:0
    v_exp_f32 v40, v40
    v_exp_f32 v41, v41
    v_exp_f32 v42, v42
    v_exp_f32 v43, v43
    v_cvt_pk_bf16_f32 v68, v40, v41
    v_cvt_pk_bf16_f32 v69, v42, v43
    ds_read_b128 v[92:95], v98 offset:768
    s_add_u32 m0, s49, 49152
    s_add_u32 s51, s50, 133120
    buffer_load_dwordx4 v126, s[28:31], s51 offen sc1 lds
    v_exp_f32 v44, v44
    v_exp_f32 v45, v45
    v_exp_f32 v46, v46
    v_exp_f32 v47, v47
    v_cvt_pk_bf16_f32 v70, v44, v45
    v_cvt_pk_bf16_f32 v71, v46, v47
    s_waitcnt lgkmcnt(2)
    v_mfma_f32_32x32x16_bf16 v[32:47], v[80:83], v[4:7], 0
    ds_read_b128 v[80:83], v96 offset:3072
    v_exp_f32 v48, v48
    v_exp_f32 v49, v49
    v_exp_f32 v50, v50
    v_exp_f32 v51, v51
    v_cvt_pk_bf16_f32 v72, v48, v49
    v_cvt_pk_bf16_f32 v73, v50, v51
    v_mfma_f32_32x32x8bf16_1k v[32:47], v[84:85], v[8:9], v[32:47]
    ds_read_b64 v[84:85], v97 offset:3072
    v_exp_f32 v52, v52
    v_exp_f32 v53, v53
    v_exp_f32 v54, v54
    v_exp_f32 v55, v55
    v_cvt_pk_bf16_f32 v74, v52, v53
    v_cvt_pk_bf16_f32 v75, v54, v55
    s_waitcnt lgkmcnt(2)
    v_mfma_f32_32x32x16_bf16 v[16:31], v[88:91], v[64:67], 0
    ds_read_b128 v[88:91], v98 offset:3072
    v_exp_f32 v56, v56
    v_exp_f32 v57, v57
    v_exp_f32 v58, v58
    v_exp_f32 v59, v59
    v_cvt_pk_bf16_f32 v76, v56, v57
    v_cvt_pk_bf16_f32 v77, v58, v59
    v_mfma_f32_32x32x16_bf16 v[16:31], v[92:95], v[68:71], v[16:31]
    ds_read_b128 v[92:95], v98 offset:3840
    s_add_u32 m0, s49, 50176
    s_add_u32 s51, s50, 133120
    buffer_load_dwordx4 v127, s[28:31], s51 offen sc1 lds
    v_exp_f32 v60, v60
    v_exp_f32 v61, v61
    v_exp_f32 v62, v62
    v_exp_f32 v63, v63
    v_cvt_pk_bf16_f32 v78, v60, v61
    v_cvt_pk_bf16_f32 v79, v62, v63
    s_waitcnt lgkmcnt(2)
    v_mfma_f32_32x32x16_bf16 v[48:63], v[80:83], v[4:7], 0
    ds_read_b128 v[80:83], v96 offset:6144
    v_exp_f32 v32, v32
    v_exp_f32 v33, v33
    v_exp_f32 v34, v34
    v_exp_f32 v35, v35
    v_cvt_pk_bf16_f32 v64, v32, v33
    v_cvt_pk_bf16_f32 v65, v34, v35
    v_mfma_f32_32x32x8bf16_1k v[48:63], v[84:85], v[8:9], v[48:63]
    ds_read_b64 v[84:85], v97 offset:6144
    v_exp_f32 v36, v36
    v_exp_f32 v37, v37
    v_exp_f32 v38, v38
    v_exp_f32 v39, v39
    v_cvt_pk_bf16_f32 v66, v36, v37
    v_cvt_pk_bf16_f32 v67, v38, v39
    s_waitcnt lgkmcnt(2)
    v_mfma_f32_32x32x16_bf16 v[16:31], v[88:91], v[72:75], v[16:31]
    ds_read_b128 v[88:91], v98 offset:6144
    v_exp_f32 v40, v40
    v_exp_f32 v41, v41
    v_exp_f32 v42, v42
    v_exp_f32 v43, v43
    v_cvt_pk_bf16_f32 v68, v40, v41
    v_cvt_pk_bf16_f32 v69, v42, v43
    v_mfma_f32_32x32x16_bf16 v[16:31], v[92:95], v[76:79], v[16:31]
    ds_read_b128 v[92:95], v98 offset:6912
    s_add_u32 m0, s49, 51200
    s_add_u32 s51, s50, 133120
    buffer_load_dwordx4 v128, s[28:31], s51 offen sc1 lds
    v_exp_f32 v44, v44
    v_exp_f32 v45, v45
    v_exp_f32 v46, v46
    v_exp_f32 v47, v47
    v_cvt_pk_bf16_f32 v70, v44, v45
    v_cvt_pk_bf16_f32 v71, v46, v47
    s_waitcnt lgkmcnt(2)
    v_mfma_f32_32x32x16_bf16 v[32:47], v[80:83], v[4:7], 0
    ds_read_b128 v[80:83], v96 offset:9216
    v_exp_f32 v48, v48
    v_exp_f32 v49, v49
    v_exp_f32 v50, v50
    v_exp_f32 v51, v51
    v_cvt_pk_bf16_f32 v72, v48, v49
    v_cvt_pk_bf16_f32 v73, v50, v51
    v_mfma_f32_32x32x8bf16_1k v[32:47], v[84:85], v[8:9], v[32:47]
    ds_read_b64 v[84:85], v97 offset:9216
    v_exp_f32 v52, v52
    v_exp_f32 v53, v53
    v_exp_f32 v54, v54
    v_exp_f32 v55, v55
    v_cvt_pk_bf16_f32 v74, v52, v53
    v_cvt_pk_bf16_f32 v75, v54, v55
    s_waitcnt lgkmcnt(2)
    v_mfma_f32_32x32x16_bf16 v[16:31], v[88:91], v[64:67], v[16:31]
    ds_read_b128 v[88:91], v98 offset:9216
    v_exp_f32 v56, v56
    v_exp_f32 v57, v57
    v_exp_f32 v58, v58
    v_exp_f32 v59, v59
    v_cvt_pk_bf16_f32 v76, v56, v57
    v_cvt_pk_bf16_f32 v77, v58, v59
    v_mfma_f32_32x32x16_bf16 v[16:31], v[92:95], v[68:71], v[16:31]
    ds_read_b128 v[92:95], v98 offset:9984
    s_add_u32 m0, s49, 73728
    s_add_u32 s51, s50, 199680
    buffer_load_dwordx4 v126, s[28:31], s51 offen sc1 lds
    v_exp_f32 v60, v60
    v_exp_f32 v61, v61
    v_exp_f32 v62, v62
    v_exp_f32 v63, v63
    v_cvt_pk_bf16_f32 v78, v60, v61
    v_cvt_pk_bf16_f32 v79, v62, v63
    s_waitcnt lgkmcnt(2)
    v_mfma_f32_32x32x16_bf16 v[48:63], v[80:83], v[4:7], 0
    ds_read_b128 v[80:83], v96 offset:12288
    v_exp_f32 v32, v32
    v_exp_f32 v33, v33
    v_exp_f32 v34, v34
    v_exp_f32 v35, v35
    v_cvt_pk_bf16_f32 v64, v32, v33
    v_cvt_pk_bf16_f32 v65, v34, v35
    v_mfma_f32_32x32x8bf16_1k v[48:63], v[84:85], v[8:9], v[48:63]
    ds_read_b64 v[84:85], v97 offset:12288
    v_exp_f32 v36, v36
    v_exp_f32 v37, v37
    v_exp_f32 v38, v38
    v_exp_f32 v39, v39
    v_cvt_pk_bf16_f32 v66, v36, v37
    v_cvt_pk_bf16_f32 v67, v38, v39
    s_waitcnt lgkmcnt(2)
    v_mfma_f32_32x32x16_bf16 v[16:31], v[88:91], v[72:75], v[16:31]
    ds_read_b128 v[88:91], v98 offset:12288
    v_exp_f32 v40, v40
    v_exp_f32 v41, v41
    v_exp_f32 v42, v42
    v_exp_f32 v43, v43
    v_cvt_pk_bf16_f32 v68, v40, v41
    v_cvt_pk_bf16_f32 v69, v42, v43
    v_mfma_f32_32x32x16_bf16 v[16:31], v[92:95], v[76:79], v[16:31]
    ds_read_b128 v[92:95], v98 offset:13056
    s_add_u32 m0, s49, 74752
    s_add_u32 s51, s50, 199680
    buffer_load_dwordx4 v127, s[28:31], s51 offen sc1 lds
    v_exp_f32 v44, v44
    v_exp_f32 v45, v45
    v_exp_f32 v46, v46
    v_exp_f32 v47, v47
    v_cvt_pk_bf16_f32 v70, v44, v45
    v_cvt_pk_bf16_f32 v71, v46, v47
    s_waitcnt lgkmcnt(2)
    v_mfma_f32_32x32x16_bf16 v[32:47], v[80:83], v[4:7], 0
    ds_read_b128 v[80:83], v96 offset:15360
    v_exp_f32 v48, v48
    v_exp_f32 v49, v49
    v_exp_f32 v50, v50
    v_exp_f32 v51, v51
    v_cvt_pk_bf16_f32 v72, v48, v49
    v_cvt_pk_bf16_f32 v73, v50, v51
    v_mfma_f32_32x32x8bf16_1k v[32:47], v[84:85], v[8:9], v[32:47]
    ds_read_b64 v[84:85], v97 offset:15360
    v_exp_f32 v52, v52
    v_exp_f32 v53, v53
    v_exp_f32 v54, v54
    v_exp_f32 v55, v55
    v_cvt_pk_bf16_f32 v74, v52, v53
    v_cvt_pk_bf16_f32 v75, v54, v55
    s_waitcnt lgkmcnt(2)
    v_mfma_f32_32x32x16_bf16 v[16:31], v[88:91], v[64:67], v[16:31]
    ds_read_b128 v[88:91], v98 offset:15360
    v_exp_f32 v56, v56
    v_exp_f32 v57, v57
    v_exp_f32 v58, v58
    v_exp_f32 v59, v59
    v_cvt_pk_bf16_f32 v76, v56, v57
    v_cvt_pk_bf16_f32 v77, v58, v59
    v_mfma_f32_32x32x16_bf16 v[16:31], v[92:95], v[68:71], v[16:31]
    ds_read_b128 v[92:95], v98 offset:16128
    s_add_u32 m0, s49, 75776
    s_add_u32 s51, s50, 199680
    buffer_load_dwordx4 v128, s[28:31], s51 offen sc1 lds
    v_exp_f32 v60, v60
    v_exp_f32 v61, v61
    v_exp_f32 v62, v62
    v_exp_f32 v63, v63
    v_cvt_pk_bf16_f32 v78, v60, v61
    v_cvt_pk_bf16_f32 v79, v62, v63
    s_waitcnt lgkmcnt(2)
    v_mfma_f32_32x32x16_bf16 v[48:63], v[80:83], v[4:7], 0
    ds_read_b128 v[80:83], v96 offset:18432
    v_exp_f32 v32, v32
    v_exp_f32 v33, v33
    v_exp_f32 v34, v34
    v_exp_f32 v35, v35
    v_cvt_pk_bf16_f32 v64, v32, v33
    v_cvt_pk_bf16_f32 v65, v34, v35
    v_mfma_f32_32x32x8bf16_1k v[48:63], v[84:85], v[8:9], v[48:63]
    ds_read_b64 v[84:85], v97 offset:18432
    v_exp_f32 v36, v36
    v_exp_f32 v37, v37
    v_exp_f32 v38, v38
    v_exp_f32 v39, v39
    v_cvt_pk_bf16_f32 v66, v36, v37
    v_cvt_pk_bf16_f32 v67, v38, v39
    s_waitcnt lgkmcnt(2)
    v_mfma_f32_32x32x16_bf16 v[16:31], v[88:91], v[72:75], v[16:31]
    ds_read_b128 v[88:91], v98 offset:18432
    v_exp_f32 v40, v40
    v_exp_f32 v41, v41
    v_exp_f32 v42, v42
    v_exp_f32 v43, v43
    v_cvt_pk_bf16_f32 v68, v40, v41
    v_cvt_pk_bf16_f32 v69, v42, v43
    v_mfma_f32_32x32x16_bf16 v[16:31], v[92:95], v[76:79], v[16:31]
    ds_read_b128 v[92:95], v98 offset:19200
    v_exp_f32 v44, v44
    v_exp_f32 v45, v45
    v_exp_f32 v46, v46
    v_exp_f32 v47, v47
    v_cvt_pk_bf16_f32 v70, v44, v45
    v_cvt_pk_bf16_f32 v71, v46, v47
    s_waitcnt lgkmcnt(2)
    v_mfma_f32_32x32x16_bf16 v[32:47], v[80:83], v[4:7], 0
    ds_read_b128 v[80:83], v96 offset:21504
    v_exp_f32 v48, v48
    v_exp_f32 v49, v49
    v_exp_f32 v50, v50
    v_exp_f32 v51, v51
    v_cvt_pk_bf16_f32 v72, v48, v49
    v_cvt_pk_bf16_f32 v73, v50, v51
    v_mfma_f32_32x32x8bf16_1k v[32:47], v[84:85], v[8:9], v[32:47]
    ds_read_b64 v[84:85], v97 offset:21504
    v_exp_f32 v52, v52
    v_exp_f32 v53, v53
    v_exp_f32 v54, v54
    v_exp_f32 v55, v55
    v_cvt_pk_bf16_f32 v74, v52, v53
    v_cvt_pk_bf16_f32 v75, v54, v55
    s_waitcnt lgkmcnt(2)
    v_mfma_f32_32x32x16_bf16 v[16:31], v[88:91], v[64:67], v[16:31]
    ds_read_b128 v[88:91], v98 offset:21504
    v_exp_f32 v56, v56
    v_exp_f32 v57, v57
    v_exp_f32 v58, v58
    v_exp_f32 v59, v59
    v_cvt_pk_bf16_f32 v76, v56, v57
    v_cvt_pk_bf16_f32 v77, v58, v59
    v_mfma_f32_32x32x16_bf16 v[16:31], v[92:95], v[68:71], v[16:31]
    ds_read_b128 v[92:95], v98 offset:22272
    v_exp_f32 v60, v60
    v_exp_f32 v61, v61
    v_exp_f32 v62, v62
    v_exp_f32 v63, v63
    v_cvt_pk_bf16_f32 v78, v60, v61
    v_cvt_pk_bf16_f32 v79, v62, v63
    s_waitcnt lgkmcnt(2)
    v_mfma_f32_32x32x16_bf16 v[48:63], v[80:83], v[4:7], 0
    ds_read_b128 v[80:83], v96 offset:24576
    v_exp_f32 v32, v32
    v_exp_f32 v33, v33
    v_exp_f32 v34, v34
    v_exp_f32 v35, v35
    v_cvt_pk_bf16_f32 v64, v32, v33
    v_cvt_pk_bf16_f32 v65, v34, v35
    v_mfma_f32_32x32x8bf16_1k v[48:63], v[84:85], v[8:9], v[48:63]
    ds_read_b64 v[84:85], v97 offset:24576
    v_exp_f32 v36, v36
    v_exp_f32 v37, v37
    v_exp_f32 v38, v38
    v_exp_f32 v39, v39
    v_cvt_pk_bf16_f32 v66, v36, v37
    v_cvt_pk_bf16_f32 v67, v38, v39
    s_waitcnt lgkmcnt(2)
    v_mfma_f32_32x32x16_bf16 v[16:31], v[88:91], v[72:75], v[16:31]
    ds_read_b128 v[88:91], v98 offset:24576
    v_exp_f32 v40, v40
    v_exp_f32 v41, v41
    v_exp_f32 v42, v42
    v_exp_f32 v43, v43
    v_cvt_pk_bf16_f32 v68, v40, v41
    v_cvt_pk_bf16_f32 v69, v42, v43
    v_mfma_f32_32x32x16_bf16 v[16:31], v[92:95], v[76:79], v[16:31]
    ds_read_b128 v[92:95], v98 offset:25344
    v_exp_f32 v44, v44
    v_exp_f32 v45, v45
    v_exp_f32 v46, v46
    v_exp_f32 v47, v47
    v_cvt_pk_bf16_f32 v70, v44, v45
    v_cvt_pk_bf16_f32 v71, v46, v47
    s_setprio 2
    s_waitcnt lgkmcnt(2)
    v_mfma_f32_32x32x16_bf16 v[32:47], v[80:83], v[4:7], 0
    ds_read_b128 v[80:83], v96 offset:27648
    v_exp_f32 v48, v48
    v_exp_f32 v49, v49
    v_exp_f32 v50, v50
    v_exp_f32 v51, v51
    v_cvt_pk_bf16_f32 v72, v48, v49
    v_cvt_pk_bf16_f32 v73, v50, v51
    v_mfma_f32_32x32x8bf16_1k v[32:47], v[84:85], v[8:9], v[32:47]
    ds_read_b64 v[84:85], v97 offset:27648
    v_exp_f32 v52, v52
    v_exp_f32 v53, v53
    v_exp_f32 v54, v54
    v_exp_f32 v55, v55
    v_cvt_pk_bf16_f32 v74, v52, v53
    v_cvt_pk_bf16_f32 v75, v54, v55
    s_waitcnt lgkmcnt(2)
    v_mfma_f32_32x32x16_bf16 v[16:31], v[88:91], v[64:67], v[16:31]
    ds_read_b128 v[88:91], v98 offset:27648
    v_exp_f32 v56, v56
    v_exp_f32 v57, v57
    v_exp_f32 v58, v58
    v_exp_f32 v59, v59
    v_cvt_pk_bf16_f32 v76, v56, v57
    v_cvt_pk_bf16_f32 v77, v58, v59
    v_mfma_f32_32x32x16_bf16 v[16:31], v[92:95], v[68:71], v[16:31]
    ds_read_b128 v[92:95], v98 offset:28416
    v_exp_f32 v60, v60
    v_exp_f32 v61, v61
    v_exp_f32 v62, v62
    v_exp_f32 v63, v63
    v_cvt_pk_bf16_f32 v78, v60, v61
    v_cvt_pk_bf16_f32 v79, v62, v63
    s_waitcnt lgkmcnt(2)
    v_mfma_f32_32x32x16_bf16 v[48:63], v[80:83], v[4:7], 0
    ds_read_b128 v[80:83], v96 offset:30720
    v_exp_f32 v32, v32
    v_exp_f32 v33, v33
    v_exp_f32 v34, v34
    v_exp_f32 v35, v35
    v_cvt_pk_bf16_f32 v64, v32, v33
    v_cvt_pk_bf16_f32 v65, v34, v35
    v_mfma_f32_32x32x8bf16_1k v[48:63], v[84:85], v[8:9], v[48:63]
    ds_read_b64 v[84:85], v97 offset:30720
    v_exp_f32 v36, v36
    v_exp_f32 v37, v37
    v_exp_f32 v38, v38
    v_exp_f32 v39, v39
    v_cvt_pk_bf16_f32 v66, v36, v37
    v_cvt_pk_bf16_f32 v67, v38, v39
    s_waitcnt lgkmcnt(2)
    v_mfma_f32_32x32x16_bf16 v[16:31], v[88:91], v[72:75], v[16:31]
    ds_read_b128 v[88:91], v98 offset:30720
    v_exp_f32 v40, v40
    v_exp_f32 v41, v41
    v_exp_f32 v42, v42
    v_exp_f32 v43, v43
    v_cvt_pk_bf16_f32 v68, v40, v41
    v_cvt_pk_bf16_f32 v69, v42, v43
    v_mfma_f32_32x32x16_bf16 v[16:31], v[92:95], v[76:79], v[16:31]
    ds_read_b128 v[92:95], v98 offset:31488
    v_exp_f32 v44, v44
    v_exp_f32 v45, v45
    v_exp_f32 v46, v46
    v_exp_f32 v47, v47
    v_cvt_pk_bf16_f32 v70, v44, v45
    v_cvt_pk_bf16_f32 v71, v46, v47
    s_waitcnt lgkmcnt(2)
    v_mfma_f32_32x32x16_bf16 v[32:47], v[80:83], v[4:7], 0
    ds_read_b128 v[80:83], v96 offset:33792
    v_exp_f32 v48, v48
    v_exp_f32 v49, v49
    v_exp_f32 v50, v50
    v_exp_f32 v51, v51
    v_cvt_pk_bf16_f32 v72, v48, v49
    v_cvt_pk_bf16_f32 v73, v50, v51
    v_mfma_f32_32x32x8bf16_1k v[32:47], v[84:85], v[8:9], v[32:47]
    ds_read_b64 v[84:85], v97 offset:33792
    v_exp_f32 v52, v52
    v_exp_f32 v53, v53
    v_exp_f32 v54, v54
    v_exp_f32 v55, v55
    v_cvt_pk_bf16_f32 v74, v52, v53
    v_cvt_pk_bf16_f32 v75, v54, v55
    s_waitcnt lgkmcnt(2)
    v_mfma_f32_32x32x16_bf16 v[16:31], v[88:91], v[64:67], v[16:31]
    ds_read_b128 v[88:91], v98 offset:33792
    v_exp_f32 v56, v56
    v_exp_f32 v57, v57
    v_exp_f32 v58, v58
    v_exp_f32 v59, v59
    v_cvt_pk_bf16_f32 v76, v56, v57
    v_cvt_pk_bf16_f32 v77, v58, v59
    v_mfma_f32_32x32x16_bf16 v[16:31], v[92:95], v[68:71], v[16:31]
    ds_read_b128 v[92:95], v98 offset:34560
    v_exp_f32 v60, v60
    v_exp_f32 v61, v61
    v_exp_f32 v62, v62
    v_exp_f32 v63, v63
    v_cvt_pk_bf16_f32 v78, v60, v61
    v_cvt_pk_bf16_f32 v79, v62, v63
    s_waitcnt lgkmcnt(2)
    v_mfma_f32_32x32x16_bf16 v[48:63], v[80:83], v[4:7], 0
    ds_read_b128 v[80:83], v96 offset:36864
    v_exp_f32 v32, v32
    v_exp_f32 v33, v33
    v_exp_f32 v34, v34
    v_exp_f32 v35, v35
    v_cvt_pk_bf16_f32 v64, v32, v33
    v_cvt_pk_bf16_f32 v65, v34, v35
    v_mfma_f32_32x32x8bf16_1k v[48:63], v[84:85], v[8:9], v[48:63]
    ds_read_b64 v[84:85], v97 offset:36864
    v_exp_f32 v36, v36
    v_exp_f32 v37, v37
    v_exp_f32 v38, v38
    v_exp_f32 v39, v39
    v_cvt_pk_bf16_f32 v66, v36, v37
    v_cvt_pk_bf16_f32 v67, v38, v39
    s_waitcnt lgkmcnt(2)
    v_mfma_f32_32x32x16_bf16 v[16:31], v[88:91], v[72:75], v[16:31]
    ds_read_b128 v[88:91], v98 offset:36864
    v_exp_f32 v40, v40
    v_exp_f32 v41, v41
    v_exp_f32 v42, v42
    v_exp_f32 v43, v43
    v_cvt_pk_bf16_f32 v68, v40, v41
    v_cvt_pk_bf16_f32 v69, v42, v43
    v_mfma_f32_32x32x16_bf16 v[16:31], v[92:95], v[76:79], v[16:31]
    ds_read_b128 v[92:95], v98 offset:37632
    v_exp_f32 v44, v44
    v_exp_f32 v45, v45
    v_exp_f32 v46, v46
    v_exp_f32 v47, v47
    v_cvt_pk_bf16_f32 v70, v44, v45
    v_cvt_pk_bf16_f32 v71, v46, v47
    s_setprio 1
    s_waitcnt lgkmcnt(2)
    v_mfma_f32_32x32x16_bf16 v[32:47], v[80:83], v[4:7], 0
    ds_read_b128 v[80:83], v96 offset:39936
    v_exp_f32 v48, v48
    v_exp_f32 v49, v49
    v_exp_f32 v50, v50
    v_exp_f32 v51, v51
    v_cvt_pk_bf16_f32 v72, v48, v49
    v_cvt_pk_bf16_f32 v73, v50, v51
    v_mfma_f32_32x32x8bf16_1k v[32:47], v[84:85], v[8:9], v[32:47]
    ds_read_b64 v[84:85], v97 offset:39936
    v_exp_f32 v52, v52
    v_exp_f32 v53, v53
    v_exp_f32 v54, v54
    v_exp_f32 v55, v55
    v_cvt_pk_bf16_f32 v74, v52, v53
    v_cvt_pk_bf16_f32 v75, v54, v55
    s_waitcnt lgkmcnt(2)
    v_mfma_f32_32x32x16_bf16 v[16:31], v[88:91], v[64:67], v[16:31]
    ds_read_b128 v[88:91], v98 offset:39936
    v_exp_f32 v56, v56
    v_exp_f32 v57, v57
    v_exp_f32 v58, v58
    v_exp_f32 v59, v59
    v_cvt_pk_bf16_f32 v76, v56, v57
    v_cvt_pk_bf16_f32 v77, v58, v59
    v_mfma_f32_32x32x16_bf16 v[16:31], v[92:95], v[68:71], v[16:31]
    ds_read_b128 v[92:95], v98 offset:40704
    v_exp_f32 v60, v60
    v_exp_f32 v61, v61
    v_exp_f32 v62, v62
    v_exp_f32 v63, v63
    v_cvt_pk_bf16_f32 v78, v60, v61
    v_cvt_pk_bf16_f32 v79, v62, v63
    s_waitcnt lgkmcnt(2)
    v_mfma_f32_32x32x16_bf16 v[48:63], v[80:83], v[4:7], 0
    ds_read_b128 v[80:83], v96 offset:43008
    v_exp_f32 v32, v32
    v_exp_f32 v33, v33
    v_exp_f32 v34, v34
    v_exp_f32 v35, v35
    v_cvt_pk_bf16_f32 v64, v32, v33
    v_cvt_pk_bf16_f32 v65, v34, v35
    v_mfma_f32_32x32x8bf16_1k v[48:63], v[84:85], v[8:9], v[48:63]
    ds_read_b64 v[84:85], v97 offset:43008
    v_exp_f32 v36, v36
    v_exp_f32 v37, v37
    v_exp_f32 v38, v38
    v_exp_f32 v39, v39
    v_cvt_pk_bf16_f32 v66, v36, v37
    v_cvt_pk_bf16_f32 v67, v38, v39
    s_waitcnt lgkmcnt(2)
    v_mfma_f32_32x32x16_bf16 v[16:31], v[88:91], v[72:75], v[16:31]
    ds_read_b128 v[88:91], v98 offset:43008
    v_exp_f32 v40, v40
    v_exp_f32 v41, v41
    v_exp_f32 v42, v42
    v_exp_f32 v43, v43
    v_cvt_pk_bf16_f32 v68, v40, v41
    v_cvt_pk_bf16_f32 v69, v42, v43
    v_mfma_f32_32x32x16_bf16 v[16:31], v[92:95], v[76:79], v[16:31]
    ds_read_b128 v[92:95], v98 offset:43776
    v_exp_f32 v44, v44
    v_exp_f32 v45, v45
    v_exp_f32 v46, v46
    v_exp_f32 v47, v47
    v_cvt_pk_bf16_f32 v70, v44, v45
    v_cvt_pk_bf16_f32 v71, v46, v47
    s_setprio 0
    s_waitcnt lgkmcnt(2)
    v_mfma_f32_32x32x16_bf16 v[32:47], v[80:83], v[4:7], 0
    ds_read_b128 v[80:83], v96 offset:46080
    v_exp_f32 v48, v48
    v_exp_f32 v49, v49
    v_exp_f32 v50, v50
    v_exp_f32 v51, v51
    v_cvt_pk_bf16_f32 v72, v48, v49
    v_cvt_pk_bf16_f32 v73, v50, v51
    v_mfma_f32_32x32x8bf16_1k v[32:47], v[84:85], v[8:9], v[32:47]
    ds_read_b64 v[84:85], v97 offset:46080
    v_exp_f32 v52, v52
    v_exp_f32 v53, v53
    v_exp_f32 v54, v54
    v_exp_f32 v55, v55
    v_cvt_pk_bf16_f32 v74, v52, v53
    v_cvt_pk_bf16_f32 v75, v54, v55
    s_waitcnt lgkmcnt(2)
    v_mfma_f32_32x32x16_bf16 v[16:31], v[88:91], v[64:67], v[16:31]
    ds_read_b128 v[88:91], v98 offset:46080
    v_exp_f32 v56, v56
    v_exp_f32 v57, v57
    v_exp_f32 v58, v58
    v_exp_f32 v59, v59
    v_cvt_pk_bf16_f32 v76, v56, v57
    v_cvt_pk_bf16_f32 v77, v58, v59
    v_mfma_f32_32x32x16_bf16 v[16:31], v[92:95], v[68:71], v[16:31]
    ds_read_b128 v[92:95], v98 offset:46848
    v_exp_f32 v60, v60
    v_exp_f32 v61, v61
    v_exp_f32 v62, v62
    v_exp_f32 v63, v63
    v_cvt_pk_bf16_f32 v78, v60, v61
    v_cvt_pk_bf16_f32 v79, v62, v63
    s_waitcnt vmcnt(0) lgkmcnt(0)
    s_barrier
    s_setprio 3
    v_mfma_f32_32x32x16_bf16 v[48:63], v[80:83], v[4:7], 0
    ds_read_b128 v[80:83], v99 offset:0
    v_exp_f32 v32, v32
    v_exp_f32 v33, v33
    v_exp_f32 v34, v34
    v_exp_f32 v35, v35
    v_cvt_pk_bf16_f32 v64, v32, v33
    v_cvt_pk_bf16_f32 v65, v34, v35
    v_mfma_f32_32x32x8bf16_1k v[48:63], v[84:85], v[8:9], v[48:63]
    ds_read_b64 v[84:85], v100 offset:0
    v_exp_f32 v36, v36
    v_exp_f32 v37, v37
    v_exp_f32 v38, v38
    v_exp_f32 v39, v39
    v_cvt_pk_bf16_f32 v66, v36, v37
    v_cvt_pk_bf16_f32 v67, v38, v39
    s_waitcnt lgkmcnt(2)
    v_mfma_f32_32x32x16_bf16 v[16:31], v[88:91], v[72:75], v[16:31]
    ds_read_b128 v[88:91], v101 offset:0
    v_exp_f32 v40, v40
    v_exp_f32 v41, v41
    v_exp_f32 v42, v42
    v_exp_f32 v43, v43
    v_cvt_pk_bf16_f32 v68, v40, v41
    v_cvt_pk_bf16_f32 v69, v42, v43
    v_mfma_f32_32x32x16_bf16 v[16:31], v[92:95], v[76:79], v[16:31]
    ds_read_b128 v[92:95], v101 offset:768
    v_exp_f32 v44, v44
    v_exp_f32 v45, v45
    v_exp_f32 v46, v46
    v_exp_f32 v47, v47
    v_cvt_pk_bf16_f32 v70, v44, v45
    v_cvt_pk_bf16_f32 v71, v46, v47
    s_waitcnt lgkmcnt(2)
    v_mfma_f32_32x32x16_bf16 v[32:47], v[80:83], v[4:7], 0
    ds_read_b128 v[80:83], v99 offset:3072
    v_exp_f32 v48, v48
    v_exp_f32 v49, v49
    v_exp_f32 v50, v50
    v_exp_f32 v51, v51
    v_cvt_pk_bf16_f32 v72, v48, v49
    v_cvt_pk_bf16_f32 v73, v50, v51
    v_mfma_f32_32x32x8bf16_1k v[32:47], v[84:85], v[8:9], v[32:47]
    ds_read_b64 v[84:85], v100 offset:3072
    v_exp_f32 v52, v52
    v_exp_f32 v53, v53
    v_exp_f32 v54, v54
    v_exp_f32 v55, v55
    v_cvt_pk_bf16_f32 v74, v52, v53
    v_cvt_pk_bf16_f32 v75, v54, v55
    s_waitcnt lgkmcnt(2)
    v_mfma_f32_32x32x16_bf16 v[16:31], v[88:91], v[64:67], v[16:31]
    ds_read_b128 v[88:91], v101 offset:3072
    v_exp_f32 v56, v56
    v_exp_f32 v57, v57
    v_exp_f32 v58, v58
    v_exp_f32 v59, v59
    v_cvt_pk_bf16_f32 v76, v56, v57
    v_cvt_pk_bf16_f32 v77, v58, v59
    v_mfma_f32_32x32x16_bf16 v[16:31], v[92:95], v[68:71], v[16:31]
    ds_read_b128 v[92:95], v101 offset:3840
    v_exp_f32 v60, v60
    v_exp_f32 v61, v61
    v_exp_f32 v62, v62
    v_exp_f32 v63, v63
    v_cvt_pk_bf16_f32 v78, v60, v61
    v_cvt_pk_bf16_f32 v79, v62, v63
    s_waitcnt lgkmcnt(2)
    v_mfma_f32_32x32x16_bf16 v[48:63], v[80:83], v[4:7], 0
    ds_read_b128 v[80:83], v99 offset:6144
    v_exp_f32 v32, v32
    v_exp_f32 v33, v33
    v_exp_f32 v34, v34
    v_exp_f32 v35, v35
    v_cvt_pk_bf16_f32 v64, v32, v33
    v_cvt_pk_bf16_f32 v65, v34, v35
    v_mfma_f32_32x32x8bf16_1k v[48:63], v[84:85], v[8:9], v[48:63]
    ds_read_b64 v[84:85], v100 offset:6144
    v_exp_f32 v36, v36
    v_exp_f32 v37, v37
    v_exp_f32 v38, v38
    v_exp_f32 v39, v39
    v_cvt_pk_bf16_f32 v66, v36, v37
    v_cvt_pk_bf16_f32 v67, v38, v39
    s_waitcnt lgkmcnt(2)
    v_mfma_f32_32x32x16_bf16 v[16:31], v[88:91], v[72:75], v[16:31]
    ds_read_b128 v[88:91], v101 offset:6144
    v_exp_f32 v40, v40
    v_exp_f32 v41, v41
    v_exp_f32 v42, v42
    v_exp_f32 v43, v43
    v_cvt_pk_bf16_f32 v68, v40, v41
    v_cvt_pk_bf16_f32 v69, v42, v43
    v_mfma_f32_32x32x16_bf16 v[16:31], v[92:95], v[76:79], v[16:31]
    ds_read_b128 v[92:95], v101 offset:6912
    v_exp_f32 v44, v44
    v_exp_f32 v45, v45
    v_exp_f32 v46, v46
    v_exp_f32 v47, v47
    v_cvt_pk_bf16_f32 v70, v44, v45
    v_cvt_pk_bf16_f32 v71, v46, v47
    s_waitcnt lgkmcnt(2)
    v_mfma_f32_32x32x16_bf16 v[32:47], v[80:83], v[4:7], 0
    ds_read_b128 v[80:83], v99 offset:9216
    v_exp_f32 v48, v48
    v_exp_f32 v49, v49
    v_exp_f32 v50, v50
    v_exp_f32 v51, v51
    v_cvt_pk_bf16_f32 v72, v48, v49
    v_cvt_pk_bf16_f32 v73, v50, v51
    v_mfma_f32_32x32x8bf16_1k v[32:47], v[84:85], v[8:9], v[32:47]
    ds_read_b64 v[84:85], v100 offset:9216
    v_exp_f32 v52, v52
    v_exp_f32 v53, v53
    v_exp_f32 v54, v54
    v_exp_f32 v55, v55
    v_cvt_pk_bf16_f32 v74, v52, v53
    v_cvt_pk_bf16_f32 v75, v54, v55
    s_waitcnt lgkmcnt(2)
    v_mfma_f32_32x32x16_bf16 v[16:31], v[88:91], v[64:67], v[16:31]
    ds_read_b128 v[88:91], v101 offset:9216
    v_exp_f32 v56, v56
    v_exp_f32 v57, v57
    v_exp_f32 v58, v58
    v_exp_f32 v59, v59
    v_cvt_pk_bf16_f32 v76, v56, v57
    v_cvt_pk_bf16_f32 v77, v58, v59
    v_mfma_f32_32x32x16_bf16 v[16:31], v[92:95], v[68:71], v[16:31]
    ds_read_b128 v[92:95], v101 offset:9984
    v_exp_f32 v60, v60
    v_exp_f32 v61, v61
    v_exp_f32 v62, v62
    v_exp_f32 v63, v63
    v_cvt_pk_bf16_f32 v78, v60, v61
    v_cvt_pk_bf16_f32 v79, v62, v63
    s_waitcnt lgkmcnt(2)
    v_mfma_f32_32x32x16_bf16 v[48:63], v[80:83], v[4:7], 0
    ds_read_b128 v[80:83], v99 offset:12288
    v_exp_f32 v32, v32
    v_exp_f32 v33, v33
    v_exp_f32 v34, v34
    v_exp_f32 v35, v35
    v_cvt_pk_bf16_f32 v64, v32, v33
    v_cvt_pk_bf16_f32 v65, v34, v35
    v_mfma_f32_32x32x8bf16_1k v[48:63], v[84:85], v[8:9], v[48:63]
    ds_read_b64 v[84:85], v100 offset:12288
    v_exp_f32 v36, v36
    v_exp_f32 v37, v37
    v_exp_f32 v38, v38
    v_exp_f32 v39, v39
    v_cvt_pk_bf16_f32 v66, v36, v37
    v_cvt_pk_bf16_f32 v67, v38, v39
    s_waitcnt lgkmcnt(2)
    v_mfma_f32_32x32x16_bf16 v[16:31], v[88:91], v[72:75], v[16:31]
    ds_read_b128 v[88:91], v101 offset:12288
    v_exp_f32 v40, v40
    v_exp_f32 v41, v41
    v_exp_f32 v42, v42
    v_exp_f32 v43, v43
    v_cvt_pk_bf16_f32 v68, v40, v41
    v_cvt_pk_bf16_f32 v69, v42, v43
    v_mfma_f32_32x32x16_bf16 v[16:31], v[92:95], v[76:79], v[16:31]
    ds_read_b128 v[92:95], v101 offset:13056
    v_exp_f32 v44, v44
    v_exp_f32 v45, v45
    v_exp_f32 v46, v46
    v_exp_f32 v47, v47
    v_cvt_pk_bf16_f32 v70, v44, v45
    v_cvt_pk_bf16_f32 v71, v46, v47
    s_waitcnt lgkmcnt(2)
    v_mfma_f32_32x32x16_bf16 v[32:47], v[80:83], v[4:7], 0
    ds_read_b128 v[80:83], v99 offset:15360
    v_exp_f32 v48, v48
    v_exp_f32 v49, v49
    v_exp_f32 v50, v50
    v_exp_f32 v51, v51
    v_cvt_pk_bf16_f32 v72, v48, v49
    v_cvt_pk_bf16_f32 v73, v50, v51
    v_mfma_f32_32x32x8bf16_1k v[32:47], v[84:85], v[8:9], v[32:47]
    ds_read_b64 v[84:85], v100 offset:15360
    v_exp_f32 v52, v52
    v_exp_f32 v53, v53
    v_exp_f32 v54, v54
    v_exp_f32 v55, v55
    v_cvt_pk_bf16_f32 v74, v52, v53
    v_cvt_pk_bf16_f32 v75, v54, v55
    s_waitcnt lgkmcnt(2)
    v_mfma_f32_32x32x16_bf16 v[16:31], v[88:91], v[64:67], v[16:31]
    ds_read_b128 v[88:91], v101 offset:15360
    v_exp_f32 v56, v56
    v_exp_f32 v57, v57
    v_exp_f32 v58, v58
    v_exp_f32 v59, v59
    v_cvt_pk_bf16_f32 v76, v56, v57
    v_cvt_pk_bf16_f32 v77, v58, v59
    v_mfma_f32_32x32x16_bf16 v[16:31], v[92:95], v[68:71], v[16:31]
    ds_read_b128 v[92:95], v101 offset:16128
    v_exp_f32 v60, v60
    v_exp_f32 v61, v61
    v_exp_f32 v62, v62
    v_exp_f32 v63, v63
    v_cvt_pk_bf16_f32 v78, v60, v61
    v_cvt_pk_bf16_f32 v79, v62, v63
    s_waitcnt lgkmcnt(2)
    v_mfma_f32_32x32x16_bf16 v[48:63], v[80:83], v[4:7], 0
    ds_read_b128 v[80:83], v99 offset:18432
    v_exp_f32 v32, v32
    v_exp_f32 v33, v33
    v_exp_f32 v34, v34
    v_exp_f32 v35, v35
    v_cvt_pk_bf16_f32 v64, v32, v33
    v_cvt_pk_bf16_f32 v65, v34, v35
    v_mfma_f32_32x32x8bf16_1k v[48:63], v[84:85], v[8:9], v[48:63]
    ds_read_b64 v[84:85], v100 offset:18432
    v_exp_f32 v36, v36
    v_exp_f32 v37, v37
    v_exp_f32 v38, v38
    v_exp_f32 v39, v39
    v_cvt_pk_bf16_f32 v66, v36, v37
    v_cvt_pk_bf16_f32 v67, v38, v39
    s_waitcnt lgkmcnt(2)
    v_mfma_f32_32x32x16_bf16 v[16:31], v[88:91], v[72:75], v[16:31]
    ds_read_b128 v[88:91], v101 offset:18432
    v_exp_f32 v40, v40
    v_exp_f32 v41, v41
    v_exp_f32 v42, v42
    v_exp_f32 v43, v43
    v_cvt_pk_bf16_f32 v68, v40, v41
    v_cvt_pk_bf16_f32 v69, v42, v43
    v_mfma_f32_32x32x16_bf16 v[16:31], v[92:95], v[76:79], v[16:31]
    ds_read_b128 v[92:95], v101 offset:19200
    v_exp_f32 v44, v44
    v_exp_f32 v45, v45
    v_exp_f32 v46, v46
    v_exp_f32 v47, v47
    v_cvt_pk_bf16_f32 v70, v44, v45
    v_cvt_pk_bf16_f32 v71, v46, v47
    s_waitcnt lgkmcnt(2)
    v_mfma_f32_32x32x16_bf16 v[32:47], v[80:83], v[4:7], 0
    ds_read_b128 v[80:83], v99 offset:21504
    v_exp_f32 v48, v48
    v_exp_f32 v49, v49
    v_exp_f32 v50, v50
    v_exp_f32 v51, v51
    v_cvt_pk_bf16_f32 v72, v48, v49
    v_cvt_pk_bf16_f32 v73, v50, v51
    v_mfma_f32_32x32x8bf16_1k v[32:47], v[84:85], v[8:9], v[32:47]
    ds_read_b64 v[84:85], v100 offset:21504
    v_exp_f32 v52, v52
    v_exp_f32 v53, v53
    v_exp_f32 v54, v54
    v_exp_f32 v55, v55
    v_cvt_pk_bf16_f32 v74, v52, v53
    v_cvt_pk_bf16_f32 v75, v54, v55
    s_waitcnt lgkmcnt(2)
    v_mfma_f32_32x32x16_bf16 v[16:31], v[88:91], v[64:67], v[16:31]
    ds_read_b128 v[88:91], v101 offset:21504
    v_exp_f32 v56, v56
    v_exp_f32 v57, v57
    v_exp_f32 v58, v58
    v_exp_f32 v59, v59
    v_cvt_pk_bf16_f32 v76, v56, v57
    v_cvt_pk_bf16_f32 v77, v58, v59
    v_mfma_f32_32x32x16_bf16 v[16:31], v[92:95], v[68:71], v[16:31]
    ds_read_b128 v[92:95], v101 offset:22272
    v_exp_f32 v60, v60
    v_exp_f32 v61, v61
    v_exp_f32 v62, v62
    v_exp_f32 v63, v63
    v_cvt_pk_bf16_f32 v78, v60, v61
    v_cvt_pk_bf16_f32 v79, v62, v63
    s_waitcnt lgkmcnt(2)
    v_mfma_f32_32x32x16_bf16 v[48:63], v[80:83], v[4:7], 0
    ds_read_b128 v[80:83], v99 offset:24576
    v_exp_f32 v32, v32
    v_exp_f32 v33, v33
    v_exp_f32 v34, v34
    v_exp_f32 v35, v35
    v_cvt_pk_bf16_f32 v64, v32, v33
    v_cvt_pk_bf16_f32 v65, v34, v35
    v_mfma_f32_32x32x8bf16_1k v[48:63], v[84:85], v[8:9], v[48:63]
    ds_read_b64 v[84:85], v100 offset:24576
    v_exp_f32 v36, v36
    v_exp_f32 v37, v37
    v_exp_f32 v38, v38
    v_exp_f32 v39, v39
    v_cvt_pk_bf16_f32 v66, v36, v37
    v_cvt_pk_bf16_f32 v67, v38, v39
    s_waitcnt lgkmcnt(2)
    v_mfma_f32_32x32x16_bf16 v[16:31], v[88:91], v[72:75], v[16:31]
    ds_read_b128 v[88:91], v101 offset:24576
    v_exp_f32 v40, v40
    v_exp_f32 v41, v41
    v_exp_f32 v42, v42
    v_exp_f32 v43, v43
    v_cvt_pk_bf16_f32 v68, v40, v41
    v_cvt_pk_bf16_f32 v69, v42, v43
    v_mfma_f32_32x32x16_bf16 v[16:31], v[92:95], v[76:79], v[16:31]
    ds_read_b128 v[92:95], v101 offset:25344
    v_exp_f32 v44, v44
    v_exp_f32 v45, v45
    v_exp_f32 v46, v46
    v_exp_f32 v47, v47
    v_cvt_pk_bf16_f32 v70, v44, v45
    v_cvt_pk_bf16_f32 v71, v46, v47
    s_setprio 2
    s_waitcnt lgkmcnt(2)
    v_mfma_f32_32x32x16_bf16 v[32:47], v[80:83], v[4:7], 0
    ds_read_b128 v[80:83], v99 offset:27648
    v_exp_f32 v48, v48
    v_exp_f32 v49, v49
    v_exp_f32 v50, v50
    v_exp_f32 v51, v51
    v_cvt_pk_bf16_f32 v72, v48, v49
    v_cvt_pk_bf16_f32 v73, v50, v51
    v_mfma_f32_32x32x8bf16_1k v[32:47], v[84:85], v[8:9], v[32:47]
    ds_read_b64 v[84:85], v100 offset:27648
    v_exp_f32 v52, v52
    v_exp_f32 v53, v53
    v_exp_f32 v54, v54
    v_exp_f32 v55, v55
    v_cvt_pk_bf16_f32 v74, v52, v53
    v_cvt_pk_bf16_f32 v75, v54, v55
    s_waitcnt lgkmcnt(2)
    v_mfma_f32_32x32x16_bf16 v[16:31], v[88:91], v[64:67], v[16:31]
    ds_read_b128 v[88:91], v101 offset:27648
    v_exp_f32 v56, v56
    v_exp_f32 v57, v57
    v_exp_f32 v58, v58
    v_exp_f32 v59, v59
    v_cvt_pk_bf16_f32 v76, v56, v57
    v_cvt_pk_bf16_f32 v77, v58, v59
    v_mfma_f32_32x32x16_bf16 v[16:31], v[92:95], v[68:71], v[16:31]
    ds_read_b128 v[92:95], v101 offset:28416
    v_exp_f32 v60, v60
    v_exp_f32 v61, v61
    v_exp_f32 v62, v62
    v_exp_f32 v63, v63
    v_cvt_pk_bf16_f32 v78, v60, v61
    v_cvt_pk_bf16_f32 v79, v62, v63
    s_waitcnt lgkmcnt(2)
    v_mfma_f32_32x32x16_bf16 v[48:63], v[80:83], v[4:7], 0
    ds_read_b128 v[80:83], v99 offset:30720
    v_exp_f32 v32, v32
    v_exp_f32 v33, v33
    v_exp_f32 v34, v34
    v_exp_f32 v35, v35
    v_cvt_pk_bf16_f32 v64, v32, v33
    v_cvt_pk_bf16_f32 v65, v34, v35
    v_mfma_f32_32x32x8bf16_1k v[48:63], v[84:85], v[8:9], v[48:63]
    ds_read_b64 v[84:85], v100 offset:30720
    v_exp_f32 v36, v36
    v_exp_f32 v37, v37
    v_exp_f32 v38, v38
    v_exp_f32 v39, v39
    v_cvt_pk_bf16_f32 v66, v36, v37
    v_cvt_pk_bf16_f32 v67, v38, v39
    s_waitcnt lgkmcnt(2)
    v_mfma_f32_32x32x16_bf16 v[16:31], v[88:91], v[72:75], v[16:31]
    ds_read_b128 v[88:91], v101 offset:30720
    v_exp_f32 v40, v40
    v_exp_f32 v41, v41
    v_exp_f32 v42, v42
    v_exp_f32 v43, v43
    v_cvt_pk_bf16_f32 v68, v40, v41
    v_cvt_pk_bf16_f32 v69, v42, v43
    v_mfma_f32_32x32x16_bf16 v[16:31], v[92:95], v[76:79], v[16:31]
    ds_read_b128 v[92:95], v101 offset:31488
    v_exp_f32 v44, v44
    v_exp_f32 v45, v45
    v_exp_f32 v46, v46
    v_exp_f32 v47, v47
    v_cvt_pk_bf16_f32 v70, v44, v45
    v_cvt_pk_bf16_f32 v71, v46, v47
    s_waitcnt lgkmcnt(2)
    v_mfma_f32_32x32x16_bf16 v[32:47], v[80:83], v[4:7], 0
    ds_read_b128 v[80:83], v99 offset:33792
    v_exp_f32 v48, v48
    v_exp_f32 v49, v49
    v_exp_f32 v50, v50
    v_exp_f32 v51, v51
    v_cvt_pk_bf16_f32 v72, v48, v49
    v_cvt_pk_bf16_f32 v73, v50, v51
    v_mfma_f32_32x32x8bf16_1k v[32:47], v[84:85], v[8:9], v[32:47]
    ds_read_b64 v[84:85], v100 offset:33792
    v_exp_f32 v52, v52
    v_exp_f32 v53, v53
    v_exp_f32 v54, v54
    v_exp_f32 v55, v55
    v_cvt_pk_bf16_f32 v74, v52, v53
    v_cvt_pk_bf16_f32 v75, v54, v55
    s_waitcnt lgkmcnt(2)
    v_mfma_f32_32x32x16_bf16 v[16:31], v[88:91], v[64:67], v[16:31]
    ds_read_b128 v[88:91], v101 offset:33792
    v_exp_f32 v56, v56
    v_exp_f32 v57, v57
    v_exp_f32 v58, v58
    v_exp_f32 v59, v59
    v_cvt_pk_bf16_f32 v76, v56, v57
    v_cvt_pk_bf16_f32 v77, v58, v59
    v_mfma_f32_32x32x16_bf16 v[16:31], v[92:95], v[68:71], v[16:31]
    ds_read_b128 v[92:95], v101 offset:34560
    v_exp_f32 v60, v60
    v_exp_f32 v61, v61
    v_exp_f32 v62, v62
    v_exp_f32 v63, v63
    v_cvt_pk_bf16_f32 v78, v60, v61
    v_cvt_pk_bf16_f32 v79, v62, v63
    s_waitcnt lgkmcnt(2)
    v_mfma_f32_32x32x16_bf16 v[48:63], v[80:83], v[4:7], 0
    ds_read_b128 v[80:83], v99 offset:36864
    v_exp_f32 v32, v32
    v_exp_f32 v33, v33
    v_exp_f32 v34, v34
    v_exp_f32 v35, v35
    v_cvt_pk_bf16_f32 v64, v32, v33
    v_cvt_pk_bf16_f32 v65, v34, v35
    v_mfma_f32_32x32x8bf16_1k v[48:63], v[84:85], v[8:9], v[48:63]
    ds_read_b64 v[84:85], v100 offset:36864
    v_exp_f32 v36, v36
    v_exp_f32 v37, v37
    v_exp_f32 v38, v38
    v_exp_f32 v39, v39
    v_cvt_pk_bf16_f32 v66, v36, v37
    v_cvt_pk_bf16_f32 v67, v38, v39
    s_waitcnt lgkmcnt(2)
    v_mfma_f32_32x32x16_bf16 v[16:31], v[88:91], v[72:75], v[16:31]
    ds_read_b128 v[88:91], v101 offset:36864
    v_exp_f32 v40, v40
    v_exp_f32 v41, v41
    v_exp_f32 v42, v42
    v_exp_f32 v43, v43
    v_cvt_pk_bf16_f32 v68, v40, v41
    v_cvt_pk_bf16_f32 v69, v42, v43
    v_mfma_f32_32x32x16_bf16 v[16:31], v[92:95], v[76:79], v[16:31]
    ds_read_b128 v[92:95], v101 offset:37632
    v_exp_f32 v44, v44
    v_exp_f32 v45, v45
    v_exp_f32 v46, v46
    v_exp_f32 v47, v47
    v_cvt_pk_bf16_f32 v70, v44, v45
    v_cvt_pk_bf16_f32 v71, v46, v47
    s_setprio 1
    s_waitcnt lgkmcnt(2)
    v_mfma_f32_32x32x16_bf16 v[32:47], v[80:83], v[4:7], 0
    ds_read_b128 v[80:83], v99 offset:39936
    v_exp_f32 v48, v48
    v_exp_f32 v49, v49
    v_exp_f32 v50, v50
    v_exp_f32 v51, v51
    v_cvt_pk_bf16_f32 v72, v48, v49
    v_cvt_pk_bf16_f32 v73, v50, v51
    v_mfma_f32_32x32x8bf16_1k v[32:47], v[84:85], v[8:9], v[32:47]
    ds_read_b64 v[84:85], v100 offset:39936
    v_exp_f32 v52, v52
    v_exp_f32 v53, v53
    v_exp_f32 v54, v54
    v_exp_f32 v55, v55
    v_cvt_pk_bf16_f32 v74, v52, v53
    v_cvt_pk_bf16_f32 v75, v54, v55
    s_waitcnt lgkmcnt(2)
    v_mfma_f32_32x32x16_bf16 v[16:31], v[88:91], v[64:67], v[16:31]
    ds_read_b128 v[88:91], v101 offset:39936
    v_exp_f32 v56, v56
    v_exp_f32 v57, v57
    v_exp_f32 v58, v58
    v_exp_f32 v59, v59
    v_cvt_pk_bf16_f32 v76, v56, v57
    v_cvt_pk_bf16_f32 v77, v58, v59
    v_mfma_f32_32x32x16_bf16 v[16:31], v[92:95], v[68:71], v[16:31]
    ds_read_b128 v[92:95], v101 offset:40704
    v_exp_f32 v60, v60
    v_exp_f32 v61, v61
    v_exp_f32 v62, v62
    v_exp_f32 v63, v63
    v_cvt_pk_bf16_f32 v78, v60, v61
    v_cvt_pk_bf16_f32 v79, v62, v63
    s_waitcnt lgkmcnt(2)
    v_mfma_f32_32x32x16_bf16 v[48:63], v[80:83], v[4:7], 0
    ds_read_b128 v[80:83], v99 offset:43008
    v_exp_f32 v32, v32
    v_exp_f32 v33, v33
    v_exp_f32 v34, v34
    v_exp_f32 v35, v35
    v_cvt_pk_bf16_f32 v64, v32, v33
    v_cvt_pk_bf16_f32 v65, v34, v35
    v_mfma_f32_32x32x8bf16_1k v[48:63], v[84:85], v[8:9], v[48:63]
    ds_read_b64 v[84:85], v100 offset:43008
    v_exp_f32 v36, v36
    v_exp_f32 v37, v37
    v_exp_f32 v38, v38
    v_exp_f32 v39, v39
    v_cvt_pk_bf16_f32 v66, v36, v37
    v_cvt_pk_bf16_f32 v67, v38, v39
    s_waitcnt lgkmcnt(2)
    v_mfma_f32_32x32x16_bf16 v[16:31], v[88:91], v[72:75], v[16:31]
    ds_read_b128 v[88:91], v101 offset:43008
    v_exp_f32 v40, v40
    v_exp_f32 v41, v41
    v_exp_f32 v42, v42
    v_exp_f32 v43, v43
    v_cvt_pk_bf16_f32 v68, v40, v41
    v_cvt_pk_bf16_f32 v69, v42, v43
    v_mfma_f32_32x32x16_bf16 v[16:31], v[92:95], v[76:79], v[16:31]
    ds_read_b128 v[92:95], v101 offset:43776
    v_exp_f32 v44, v44
    v_exp_f32 v45, v45
    v_exp_f32 v46, v46
    v_exp_f32 v47, v47
    v_cvt_pk_bf16_f32 v70, v44, v45
    v_cvt_pk_bf16_f32 v71, v46, v47
    s_setprio 0
    s_waitcnt lgkmcnt(2)
    v_mfma_f32_32x32x16_bf16 v[32:47], v[80:83], v[4:7], 0
    ds_read_b128 v[80:83], v99 offset:46080
    v_exp_f32 v48, v48
    v_exp_f32 v49, v49
    v_exp_f32 v50, v50
    v_exp_f32 v51, v51
    v_cvt_pk_bf16_f32 v72, v48, v49
    v_cvt_pk_bf16_f32 v73, v50, v51
    v_mfma_f32_32x32x8bf16_1k v[32:47], v[84:85], v[8:9], v[32:47]
    ds_read_b64 v[84:85], v100 offset:46080
    v_exp_f32 v52, v52
    v_exp_f32 v53, v53
    v_exp_f32 v54, v54
    v_exp_f32 v55, v55
    v_cvt_pk_bf16_f32 v74, v52, v53
    v_cvt_pk_bf16_f32 v75, v54, v55
    s_waitcnt lgkmcnt(2)
    v_mfma_f32_32x32x16_bf16 v[16:31], v[88:91], v[64:67], v[16:31]
    ds_read_b128 v[88:91], v101 offset:46080
    v_exp_f32 v56, v56
    v_exp_f32 v57, v57
    v_exp_f32 v58, v58
    v_exp_f32 v59, v59
    v_cvt_pk_bf16_f32 v76, v56, v57
    v_cvt_pk_bf16_f32 v77, v58, v59
    v_mfma_f32_32x32x16_bf16 v[16:31], v[92:95], v[68:71], v[16:31]
    ds_read_b128 v[92:95], v101 offset:46848
    v_exp_f32 v60, v60
    v_exp_f32 v61, v61
    v_exp_f32 v62, v62
    v_exp_f32 v63, v63
    v_cvt_pk_bf16_f32 v78, v60, v61
    v_cvt_pk_bf16_f32 v79, v62, v63
    s_waitcnt vmcnt(0) lgkmcnt(0)
    s_barrier
    s_setprio 3
    v_mfma_f32_32x32x16_bf16 v[48:63], v[80:83], v[4:7], 0
    ds_read_b128 v[80:83], v96 offset:0
    v_exp_f32 v32, v32
    v_exp_f32 v33, v33
    v_exp_f32 v34, v34
    v_exp_f32 v35, v35
    v_cvt_pk_bf16_f32 v64, v32, v33
    v_cvt_pk_bf16_f32 v65, v34, v35
    v_mfma_f32_32x32x8bf16_1k v[48:63], v[84:85], v[8:9], v[48:63]
    ds_read_b64 v[84:85], v97 offset:0
    v_exp_f32 v36, v36
    v_exp_f32 v37, v37
    v_exp_f32 v38, v38
    v_exp_f32 v39, v39
    v_cvt_pk_bf16_f32 v66, v36, v37
    v_cvt_pk_bf16_f32 v67, v38, v39
    s_waitcnt lgkmcnt(2)
    v_mfma_f32_32x32x16_bf16 v[16:31], v[88:91], v[72:75], v[16:31]
    ds_read_b128 v[88:91], v98 offset:0
    v_exp_f32 v40, v40
    v_exp_f32 v41, v41
    v_exp_f32 v42, v42
    v_exp_f32 v43, v43
    v_cvt_pk_bf16_f32 v68, v40, v41
    v_cvt_pk_bf16_f32 v69, v42, v43
    v_mfma_f32_32x32x16_bf16 v[16:31], v[92:95], v[76:79], v[16:31]
    ds_read_b128 v[92:95], v98 offset:768
    v_exp_f32 v44, v44
    v_exp_f32 v45, v45
    v_exp_f32 v46, v46
    v_exp_f32 v47, v47
    v_cvt_pk_bf16_f32 v70, v44, v45
    v_cvt_pk_bf16_f32 v71, v46, v47
    s_waitcnt lgkmcnt(2)
    v_mfma_f32_32x32x16_bf16 v[32:47], v[80:83], v[4:7], 0
    ds_read_b128 v[80:83], v96 offset:3072
    v_exp_f32 v48, v48
    v_exp_f32 v49, v49
    v_exp_f32 v50, v50
    v_exp_f32 v51, v51
    v_cvt_pk_bf16_f32 v72, v48, v49
    v_cvt_pk_bf16_f32 v73, v50, v51
    v_mfma_f32_32x32x8bf16_1k v[32:47], v[84:85], v[8:9], v[32:47]
    ds_read_b64 v[84:85], v97 offset:3072
    v_exp_f32 v52, v52
    v_exp_f32 v53, v53
    v_exp_f32 v54, v54
    v_exp_f32 v55, v55
    v_cvt_pk_bf16_f32 v74, v52, v53
    v_cvt_pk_bf16_f32 v75, v54, v55
    s_waitcnt lgkmcnt(2)
    v_mfma_f32_32x32x16_bf16 v[16:31], v[88:91], v[64:67], v[16:31]
    ds_read_b128 v[88:91], v98 offset:3072
    v_exp_f32 v56, v56
    v_exp_f32 v57, v57
    v_exp_f32 v58, v58
    v_exp_f32 v59, v59
    v_cvt_pk_bf16_f32 v76, v56, v57
    v_cvt_pk_bf16_f32 v77, v58, v59
    v_mfma_f32_32x32x16_bf16 v[16:31], v[92:95], v[68:71], v[16:31]
    ds_read_b128 v[92:95], v98 offset:3840
    v_exp_f32 v60, v60
    v_exp_f32 v61, v61
    v_exp_f32 v62, v62
    v_exp_f32 v63, v63
    v_cvt_pk_bf16_f32 v78, v60, v61
    v_cvt_pk_bf16_f32 v79, v62, v63
    s_waitcnt lgkmcnt(2)
    v_mfma_f32_32x32x16_bf16 v[48:63], v[80:83], v[4:7], 0
    ds_read_b128 v[80:83], v96 offset:6144
    v_exp_f32 v32, v32
    v_exp_f32 v33, v33
    v_exp_f32 v34, v34
    v_exp_f32 v35, v35
    v_cvt_pk_bf16_f32 v64, v32, v33
    v_cvt_pk_bf16_f32 v65, v34, v35
    v_mfma_f32_32x32x8bf16_1k v[48:63], v[84:85], v[8:9], v[48:63]
    ds_read_b64 v[84:85], v97 offset:6144
    v_exp_f32 v36, v36
    v_exp_f32 v37, v37
    v_exp_f32 v38, v38
    v_exp_f32 v39, v39
    v_cvt_pk_bf16_f32 v66, v36, v37
    v_cvt_pk_bf16_f32 v67, v38, v39
    s_waitcnt lgkmcnt(2)
    v_mfma_f32_32x32x16_bf16 v[16:31], v[88:91], v[72:75], v[16:31]
    ds_read_b128 v[88:91], v98 offset:6144
    v_exp_f32 v40, v40
    v_exp_f32 v41, v41
    v_exp_f32 v42, v42
    v_exp_f32 v43, v43
    v_cvt_pk_bf16_f32 v68, v40, v41
    v_cvt_pk_bf16_f32 v69, v42, v43
    v_mfma_f32_32x32x16_bf16 v[16:31], v[92:95], v[76:79], v[16:31]
    ds_read_b128 v[92:95], v98 offset:6912
    v_exp_f32 v44, v44
    v_exp_f32 v45, v45
    v_exp_f32 v46, v46
    v_exp_f32 v47, v47
    v_cvt_pk_bf16_f32 v70, v44, v45
    v_cvt_pk_bf16_f32 v71, v46, v47
    s_waitcnt lgkmcnt(2)
    v_mfma_f32_32x32x16_bf16 v[32:47], v[80:83], v[4:7], 0
    ds_read_b128 v[80:83], v96 offset:9216
    v_exp_f32 v48, v48
    v_exp_f32 v49, v49
    v_exp_f32 v50, v50
    v_exp_f32 v51, v51
    v_cvt_pk_bf16_f32 v72, v48, v49
    v_cvt_pk_bf16_f32 v73, v50, v51
    v_mfma_f32_32x32x8bf16_1k v[32:47], v[84:85], v[8:9], v[32:47]
    ds_read_b64 v[84:85], v97 offset:9216
    v_exp_f32 v52, v52
    v_exp_f32 v53, v53
    v_exp_f32 v54, v54
    v_exp_f32 v55, v55
    v_cvt_pk_bf16_f32 v74, v52, v53
    v_cvt_pk_bf16_f32 v75, v54, v55
    s_waitcnt lgkmcnt(2)
    v_mfma_f32_32x32x16_bf16 v[16:31], v[88:91], v[64:67], v[16:31]
    ds_read_b128 v[88:91], v98 offset:9216
    v_exp_f32 v56, v56
    v_exp_f32 v57, v57
    v_exp_f32 v58, v58
    v_exp_f32 v59, v59
    v_cvt_pk_bf16_f32 v76, v56, v57
    v_cvt_pk_bf16_f32 v77, v58, v59
    v_mfma_f32_32x32x16_bf16 v[16:31], v[92:95], v[68:71], v[16:31]
    ds_read_b128 v[92:95], v98 offset:9984
    v_exp_f32 v60, v60
    v_exp_f32 v61, v61
    v_exp_f32 v62, v62
    v_exp_f32 v63, v63
    v_cvt_pk_bf16_f32 v78, v60, v61
    v_cvt_pk_bf16_f32 v79, v62, v63
    s_waitcnt lgkmcnt(2)
    v_mfma_f32_32x32x16_bf16 v[48:63], v[80:83], v[4:7], 0
    ds_read_b128 v[80:83], v96 offset:12288
    v_exp_f32 v32, v32
    v_exp_f32 v33, v33
    v_exp_f32 v34, v34
    v_exp_f32 v35, v35
    v_cvt_pk_bf16_f32 v64, v32, v33
    v_cvt_pk_bf16_f32 v65, v34, v35
    v_mfma_f32_32x32x8bf16_1k v[48:63], v[84:85], v[8:9], v[48:63]
    ds_read_b64 v[84:85], v97 offset:12288
    v_exp_f32 v36, v36
    v_exp_f32 v37, v37
    v_exp_f32 v38, v38
    v_exp_f32 v39, v39
    v_cvt_pk_bf16_f32 v66, v36, v37
    v_cvt_pk_bf16_f32 v67, v38, v39
    s_waitcnt lgkmcnt(2)
    v_mfma_f32_32x32x16_bf16 v[16:31], v[88:91], v[72:75], v[16:31]
    ds_read_b128 v[88:91], v98 offset:12288
    v_exp_f32 v40, v40
    v_exp_f32 v41, v41
    v_exp_f32 v42, v42
    v_exp_f32 v43, v43
    v_cvt_pk_bf16_f32 v68, v40, v41
    v_cvt_pk_bf16_f32 v69, v42, v43
    v_mfma_f32_32x32x16_bf16 v[16:31], v[92:95], v[76:79], v[16:31]
    ds_read_b128 v[92:95], v98 offset:13056
    v_exp_f32 v44, v44
    v_exp_f32 v45, v45
    v_exp_f32 v46, v46
    v_exp_f32 v47, v47
    v_cvt_pk_bf16_f32 v70, v44, v45
    v_cvt_pk_bf16_f32 v71, v46, v47
    s_waitcnt lgkmcnt(2)
    v_mfma_f32_32x32x16_bf16 v[32:47], v[80:83], v[4:7], 0
    ds_read_b128 v[80:83], v96 offset:15360
    v_exp_f32 v48, v48
    v_exp_f32 v49, v49
    v_exp_f32 v50, v50
    v_exp_f32 v51, v51
    v_cvt_pk_bf16_f32 v72, v48, v49
    v_cvt_pk_bf16_f32 v73, v50, v51
    v_mfma_f32_32x32x8bf16_1k v[32:47], v[84:85], v[8:9], v[32:47]
    ds_read_b64 v[84:85], v97 offset:15360
    v_exp_f32 v52, v52
    v_exp_f32 v53, v53
    v_exp_f32 v54, v54
    v_exp_f32 v55, v55
    v_cvt_pk_bf16_f32 v74, v52, v53
    v_cvt_pk_bf16_f32 v75, v54, v55
    s_waitcnt lgkmcnt(2)
    v_mfma_f32_32x32x16_bf16 v[16:31], v[88:91], v[64:67], v[16:31]
    ds_read_b128 v[88:91], v98 offset:15360
    v_exp_f32 v56, v56
    v_exp_f32 v57, v57
    v_exp_f32 v58, v58
    v_exp_f32 v59, v59
    v_cvt_pk_bf16_f32 v76, v56, v57
    v_cvt_pk_bf16_f32 v77, v58, v59
    v_mfma_f32_32x32x16_bf16 v[16:31], v[92:95], v[68:71], v[16:31]
    ds_read_b128 v[92:95], v98 offset:16128
    v_exp_f32 v60, v60
    v_exp_f32 v61, v61
    v_exp_f32 v62, v62
    v_exp_f32 v63, v63
    v_cvt_pk_bf16_f32 v78, v60, v61
    v_cvt_pk_bf16_f32 v79, v62, v63
    s_waitcnt lgkmcnt(2)
    v_mfma_f32_32x32x16_bf16 v[48:63], v[80:83], v[4:7], 0
    ds_read_b128 v[80:83], v96 offset:18432
    v_exp_f32 v32, v32
    v_exp_f32 v33, v33
    v_exp_f32 v34, v34
    v_exp_f32 v35, v35
    v_cvt_pk_bf16_f32 v64, v32, v33
    v_cvt_pk_bf16_f32 v65, v34, v35
    v_mfma_f32_32x32x8bf16_1k v[48:63], v[84:85], v[8:9], v[48:63]
    ds_read_b64 v[84:85], v97 offset:18432
    v_exp_f32 v36, v36
    v_exp_f32 v37, v37
    v_exp_f32 v38, v38
    v_exp_f32 v39, v39
    v_cvt_pk_bf16_f32 v66, v36, v37
    v_cvt_pk_bf16_f32 v67, v38, v39
    s_waitcnt lgkmcnt(2)
    v_mfma_f32_32x32x16_bf16 v[16:31], v[88:91], v[72:75], v[16:31]
    ds_read_b128 v[88:91], v98 offset:18432
    v_exp_f32 v40, v40
    v_exp_f32 v41, v41
    v_exp_f32 v42, v42
    v_exp_f32 v43, v43
    v_cvt_pk_bf16_f32 v68, v40, v41
    v_cvt_pk_bf16_f32 v69, v42, v43
    v_mfma_f32_32x32x16_bf16 v[16:31], v[92:95], v[76:79], v[16:31]
    ds_read_b128 v[92:95], v98 offset:19200
    v_exp_f32 v44, v44
    v_exp_f32 v45, v45
    v_exp_f32 v46, v46
    v_exp_f32 v47, v47
    v_cvt_pk_bf16_f32 v70, v44, v45
    v_cvt_pk_bf16_f32 v71, v46, v47
    s_waitcnt lgkmcnt(2)
    v_mfma_f32_32x32x16_bf16 v[32:47], v[80:83], v[4:7], 0
    ds_read_b128 v[80:83], v96 offset:21504
    v_exp_f32 v48, v48
    v_exp_f32 v49, v49
    v_exp_f32 v50, v50
    v_exp_f32 v51, v51
    v_cvt_pk_bf16_f32 v72, v48, v49
    v_cvt_pk_bf16_f32 v73, v50, v51
    v_mfma_f32_32x32x8bf16_1k v[32:47], v[84:85], v[8:9], v[32:47]
    ds_read_b64 v[84:85], v97 offset:21504
    v_exp_f32 v52, v52
    v_exp_f32 v53, v53
    v_exp_f32 v54, v54
    v_exp_f32 v55, v55
    v_cvt_pk_bf16_f32 v74, v52, v53
    v_cvt_pk_bf16_f32 v75, v54, v55
    s_waitcnt lgkmcnt(2)
    v_mfma_f32_32x32x16_bf16 v[16:31], v[88:91], v[64:67], v[16:31]
    ds_read_b128 v[88:91], v98 offset:21504
    v_exp_f32 v56, v56
    v_exp_f32 v57, v57
    v_exp_f32 v58, v58
    v_exp_f32 v59, v59
    v_cvt_pk_bf16_f32 v76, v56, v57
    v_cvt_pk_bf16_f32 v77, v58, v59
    v_mfma_f32_32x32x16_bf16 v[16:31], v[92:95], v[68:71], v[16:31]
    ds_read_b128 v[92:95], v98 offset:22272
    v_exp_f32 v60, v60
    v_exp_f32 v61, v61
    v_exp_f32 v62, v62
    v_exp_f32 v63, v63
    v_cvt_pk_bf16_f32 v78, v60, v61
    v_cvt_pk_bf16_f32 v79, v62, v63
    s_waitcnt lgkmcnt(2)
    v_mfma_f32_32x32x16_bf16 v[48:63], v[80:83], v[4:7], 0
    ds_read_b128 v[80:83], v96 offset:24576
    v_exp_f32 v32, v32
    v_exp_f32 v33, v33
    v_exp_f32 v34, v34
    v_exp_f32 v35, v35
    v_cvt_pk_bf16_f32 v64, v32, v33
    v_cvt_pk_bf16_f32 v65, v34, v35
    v_mfma_f32_32x32x8bf16_1k v[48:63], v[84:85], v[8:9], v[48:63]
    ds_read_b64 v[84:85], v97 offset:24576
    v_exp_f32 v36, v36
    v_exp_f32 v37, v37
    v_exp_f32 v38, v38
    v_exp_f32 v39, v39
    v_cvt_pk_bf16_f32 v66, v36, v37
    v_cvt_pk_bf16_f32 v67, v38, v39
    s_waitcnt lgkmcnt(2)
    v_mfma_f32_32x32x16_bf16 v[16:31], v[88:91], v[72:75], v[16:31]
    ds_read_b128 v[88:91], v98 offset:24576
    v_exp_f32 v40, v40
    v_exp_f32 v41, v41
    v_exp_f32 v42, v42
    v_exp_f32 v43, v43
    v_cvt_pk_bf16_f32 v68, v40, v41
    v_cvt_pk_bf16_f32 v69, v42, v43
    v_mfma_f32_32x32x16_bf16 v[16:31], v[92:95], v[76:79], v[16:31]
    ds_read_b128 v[92:95], v98 offset:25344
    v_exp_f32 v44, v44
    v_exp_f32 v45, v45
    v_exp_f32 v46, v46
    v_exp_f32 v47, v47
    v_cvt_pk_bf16_f32 v70, v44, v45
    v_cvt_pk_bf16_f32 v71, v46, v47
    s_setprio 2
    s_waitcnt lgkmcnt(2)
    v_mfma_f32_32x32x16_bf16 v[32:47], v[80:83], v[4:7], 0
    ds_read_b128 v[80:83], v96 offset:27648
    v_exp_f32 v48, v48
    v_exp_f32 v49, v49
    v_exp_f32 v50, v50
    v_exp_f32 v51, v51
    v_cvt_pk_bf16_f32 v72, v48, v49
    v_cvt_pk_bf16_f32 v73, v50, v51
    v_mfma_f32_32x32x8bf16_1k v[32:47], v[84:85], v[8:9], v[32:47]
    ds_read_b64 v[84:85], v97 offset:27648
    v_exp_f32 v52, v52
    v_exp_f32 v53, v53
    v_exp_f32 v54, v54
    v_exp_f32 v55, v55
    v_cvt_pk_bf16_f32 v74, v52, v53
    v_cvt_pk_bf16_f32 v75, v54, v55
    s_waitcnt lgkmcnt(2)
    v_mfma_f32_32x32x16_bf16 v[16:31], v[88:91], v[64:67], v[16:31]
    ds_read_b128 v[88:91], v98 offset:27648
    v_exp_f32 v56, v56
    v_exp_f32 v57, v57
    v_exp_f32 v58, v58
    v_exp_f32 v59, v59
    v_cvt_pk_bf16_f32 v76, v56, v57
    v_cvt_pk_bf16_f32 v77, v58, v59
    v_mfma_f32_32x32x16_bf16 v[16:31], v[92:95], v[68:71], v[16:31]
    ds_read_b128 v[92:95], v98 offset:28416
    v_exp_f32 v60, v60
    v_exp_f32 v61, v61
    v_exp_f32 v62, v62
    v_exp_f32 v63, v63
    v_cvt_pk_bf16_f32 v78, v60, v61
    v_cvt_pk_bf16_f32 v79, v62, v63
    s_waitcnt lgkmcnt(2)
    v_mfma_f32_32x32x16_bf16 v[48:63], v[80:83], v[4:7], 0
    ds_read_b128 v[80:83], v96 offset:30720
    v_exp_f32 v32, v32
    v_exp_f32 v33, v33
    v_exp_f32 v34, v34
    v_exp_f32 v35, v35
    v_cvt_pk_bf16_f32 v64, v32, v33
    v_cvt_pk_bf16_f32 v65, v34, v35
    v_mfma_f32_32x32x8bf16_1k v[48:63], v[84:85], v[8:9], v[48:63]
    ds_read_b64 v[84:85], v97 offset:30720
    v_exp_f32 v36, v36
    v_exp_f32 v37, v37
    v_exp_f32 v38, v38
    v_exp_f32 v39, v39
    v_cvt_pk_bf16_f32 v66, v36, v37
    v_cvt_pk_bf16_f32 v67, v38, v39
    s_waitcnt lgkmcnt(2)
    v_mfma_f32_32x32x16_bf16 v[16:31], v[88:91], v[72:75], v[16:31]
    ds_read_b128 v[88:91], v98 offset:30720
    v_exp_f32 v40, v40
    v_exp_f32 v41, v41
    v_exp_f32 v42, v42
    v_exp_f32 v43, v43
    v_cvt_pk_bf16_f32 v68, v40, v41
    v_cvt_pk_bf16_f32 v69, v42, v43
    v_mfma_f32_32x32x16_bf16 v[16:31], v[92:95], v[76:79], v[16:31]
    ds_read_b128 v[92:95], v98 offset:31488
    v_exp_f32 v44, v44
    v_exp_f32 v45, v45
    v_exp_f32 v46, v46
    v_exp_f32 v47, v47
    v_cvt_pk_bf16_f32 v70, v44, v45
    v_cvt_pk_bf16_f32 v71, v46, v47
    s_waitcnt lgkmcnt(2)
    v_mfma_f32_32x32x16_bf16 v[32:47], v[80:83], v[4:7], 0
    ds_read_b128 v[80:83], v96 offset:33792
    v_exp_f32 v48, v48
    v_exp_f32 v49, v49
    v_exp_f32 v50, v50
    v_exp_f32 v51, v51
    v_cvt_pk_bf16_f32 v72, v48, v49
    v_cvt_pk_bf16_f32 v73, v50, v51
    v_mfma_f32_32x32x8bf16_1k v[32:47], v[84:85], v[8:9], v[32:47]
    ds_read_b64 v[84:85], v97 offset:33792
    v_exp_f32 v52, v52
    v_exp_f32 v53, v53
    v_exp_f32 v54, v54
    v_exp_f32 v55, v55
    v_cvt_pk_bf16_f32 v74, v52, v53
    v_cvt_pk_bf16_f32 v75, v54, v55
    s_waitcnt lgkmcnt(2)
    v_mfma_f32_32x32x16_bf16 v[16:31], v[88:91], v[64:67], v[16:31]
    ds_read_b128 v[88:91], v98 offset:33792
    v_exp_f32 v56, v56
    v_exp_f32 v57, v57
    v_exp_f32 v58, v58
    v_exp_f32 v59, v59
    v_cvt_pk_bf16_f32 v76, v56, v57
    v_cvt_pk_bf16_f32 v77, v58, v59
    v_mfma_f32_32x32x16_bf16 v[16:31], v[92:95], v[68:71], v[16:31]
    ds_read_b128 v[92:95], v98 offset:34560
    v_exp_f32 v60, v60
    v_exp_f32 v61, v61
    v_exp_f32 v62, v62
    v_exp_f32 v63, v63
    v_cvt_pk_bf16_f32 v78, v60, v61
    v_cvt_pk_bf16_f32 v79, v62, v63
    s_waitcnt lgkmcnt(2)
    v_mfma_f32_32x32x16_bf16 v[48:63], v[80:83], v[4:7], 0
    ds_read_b128 v[80:83], v96 offset:36864
    v_exp_f32 v32, v32
    v_exp_f32 v33, v33
    v_exp_f32 v34, v34
    v_exp_f32 v35, v35
    v_cvt_pk_bf16_f32 v64, v32, v33
    v_cvt_pk_bf16_f32 v65, v34, v35
    v_mfma_f32_32x32x8bf16_1k v[48:63], v[84:85], v[8:9], v[48:63]
    ds_read_b64 v[84:85], v97 offset:36864
    v_exp_f32 v36, v36
    v_exp_f32 v37, v37
    v_exp_f32 v38, v38
    v_exp_f32 v39, v39
    v_cvt_pk_bf16_f32 v66, v36, v37
    v_cvt_pk_bf16_f32 v67, v38, v39
    s_waitcnt lgkmcnt(2)
    v_mfma_f32_32x32x16_bf16 v[16:31], v[88:91], v[72:75], v[16:31]
    ds_read_b128 v[88:91], v98 offset:36864
    v_exp_f32 v40, v40
    v_exp_f32 v41, v41
    v_exp_f32 v42, v42
    v_exp_f32 v43, v43
    v_cvt_pk_bf16_f32 v68, v40, v41
    v_cvt_pk_bf16_f32 v69, v42, v43
    v_mfma_f32_32x32x16_bf16 v[16:31], v[92:95], v[76:79], v[16:31]
    ds_read_b128 v[92:95], v98 offset:37632
    v_exp_f32 v44, v44
    v_exp_f32 v45, v45
    v_exp_f32 v46, v46
    v_exp_f32 v47, v47
    v_cvt_pk_bf16_f32 v70, v44, v45
    v_cvt_pk_bf16_f32 v71, v46, v47
    s_setprio 1
    s_waitcnt lgkmcnt(2)
    v_mfma_f32_32x32x16_bf16 v[32:47], v[80:83], v[4:7], 0
    ds_read_b128 v[80:83], v96 offset:39936
    v_exp_f32 v48, v48
    v_exp_f32 v49, v49
    v_exp_f32 v50, v50
    v_exp_f32 v51, v51
    v_cvt_pk_bf16_f32 v72, v48, v49
    v_cvt_pk_bf16_f32 v73, v50, v51
    v_mfma_f32_32x32x8bf16_1k v[32:47], v[84:85], v[8:9], v[32:47]
    ds_read_b64 v[84:85], v97 offset:39936
    v_exp_f32 v52, v52
    v_exp_f32 v53, v53
    v_exp_f32 v54, v54
    v_exp_f32 v55, v55
    v_cvt_pk_bf16_f32 v74, v52, v53
    v_cvt_pk_bf16_f32 v75, v54, v55
    s_waitcnt lgkmcnt(2)
    v_mfma_f32_32x32x16_bf16 v[16:31], v[88:91], v[64:67], v[16:31]
    ds_read_b128 v[88:91], v98 offset:39936
    v_exp_f32 v56, v56
    v_exp_f32 v57, v57
    v_exp_f32 v58, v58
    v_exp_f32 v59, v59
    v_cvt_pk_bf16_f32 v76, v56, v57
    v_cvt_pk_bf16_f32 v77, v58, v59
    v_mfma_f32_32x32x16_bf16 v[16:31], v[92:95], v[68:71], v[16:31]
    ds_read_b128 v[92:95], v98 offset:40704
    v_exp_f32 v60, v60
    v_exp_f32 v61, v61
    v_exp_f32 v62, v62
    v_exp_f32 v63, v63
    v_cvt_pk_bf16_f32 v78, v60, v61
    v_cvt_pk_bf16_f32 v79, v62, v63
    s_waitcnt lgkmcnt(2)
    v_mfma_f32_32x32x16_bf16 v[48:63], v[80:83], v[4:7], 0
    ds_read_b128 v[80:83], v96 offset:43008
    v_exp_f32 v32, v32
    v_exp_f32 v33, v33
    v_exp_f32 v34, v34
    v_exp_f32 v35, v35
    v_cvt_pk_bf16_f32 v64, v32, v33
    v_cvt_pk_bf16_f32 v65, v34, v35
    v_mfma_f32_32x32x8bf16_1k v[48:63], v[84:85], v[8:9], v[48:63]
    ds_read_b64 v[84:85], v97 offset:43008
    v_exp_f32 v36, v36
    v_exp_f32 v37, v37
    v_exp_f32 v38, v38
    v_exp_f32 v39, v39
    v_cvt_pk_bf16_f32 v66, v36, v37
    v_cvt_pk_bf16_f32 v67, v38, v39
    s_waitcnt lgkmcnt(2)
    v_mfma_f32_32x32x16_bf16 v[16:31], v[88:91], v[72:75], v[16:31]
    ds_read_b128 v[88:91], v98 offset:43008
    v_exp_f32 v40, v40
    v_exp_f32 v41, v41
    v_exp_f32 v42, v42
    v_exp_f32 v43, v43
    v_cvt_pk_bf16_f32 v68, v40, v41
    v_cvt_pk_bf16_f32 v69, v42, v43
    v_mfma_f32_32x32x16_bf16 v[16:31], v[92:95], v[76:79], v[16:31]
    ds_read_b128 v[92:95], v98 offset:43776
    v_exp_f32 v44, v44
    v_exp_f32 v45, v45
    v_exp_f32 v46, v46
    v_exp_f32 v47, v47
    v_cvt_pk_bf16_f32 v70, v44, v45
    v_cvt_pk_bf16_f32 v71, v46, v47
    s_setprio 0
    s_waitcnt lgkmcnt(2)
    v_mfma_f32_32x32x16_bf16 v[32:47], v[80:83], v[4:7], 0
    ds_read_b128 v[80:83], v96 offset:46080
    v_exp_f32 v48, v48
    v_exp_f32 v49, v49
    v_exp_f32 v50, v50
    v_exp_f32 v51, v51
    v_cvt_pk_bf16_f32 v72, v48, v49
    v_cvt_pk_bf16_f32 v73, v50, v51
    v_mfma_f32_32x32x8bf16_1k v[32:47], v[84:85], v[8:9], v[32:47]
    ds_read_b64 v[84:85], v97 offset:46080
    v_exp_f32 v52, v52
    v_exp_f32 v53, v53
    v_exp_f32 v54, v54
    v_exp_f32 v55, v55
    v_cvt_pk_bf16_f32 v74, v52, v53
    v_cvt_pk_bf16_f32 v75, v54, v55
    s_waitcnt lgkmcnt(2)
    v_mfma_f32_32x32x16_bf16 v[16:31], v[88:91], v[64:67], v[16:31]
    ds_read_b128 v[88:91], v98 offset:46080
    v_exp_f32 v56, v56
    v_exp_f32 v57, v57
    v_exp_f32 v58, v58
    v_exp_f32 v59, v59
    v_cvt_pk_bf16_f32 v76, v56, v57
    v_cvt_pk_bf16_f32 v77, v58, v59
    v_mfma_f32_32x32x16_bf16 v[16:31], v[92:95], v[68:71], v[16:31]
    ds_read_b128 v[92:95], v98 offset:46848
    v_exp_f32 v60, v60
    v_exp_f32 v61, v61
    v_exp_f32 v62, v62
    v_exp_f32 v63, v63
    v_cvt_pk_bf16_f32 v78, v60, v61
    v_cvt_pk_bf16_f32 v79, v62, v63
    v_min_u32 v12, 7, v0
    v_lshlrev_b32 v12, 7, v12
    v_add_u32 v12, 18876416, v12
    global_load_dword v166, v12, s[26:27] sc1
    s_waitcnt vmcnt(0) lgkmcnt(0)
    s_barrier
    s_cmp_eq_u32 s40, 0
    s_cbranch_scc1 L_pps_30
    s_cmp_ge_u32 s40, 4
    s_cbranch_scc1 L_pps_30
    s_cmp_eq_u32 s40, 3
    s_cbranch_scc1 L_t3_32
    s_lshl_b32 s56, s2, 1
    s_sub_u32 s57, s40, 1
    s_add_u32 s56, s56, s57
    s_branch L_tgo_33
L_t3_32:
    s_cmp_ge_u32 s2, 128
    s_cbranch_scc1 L_pps_30
    s_add_u32 s56, s2, 512
L_tgo_33:
    v_cmp_le_u32 vcc, 1, v166
    s_mul_i32 s57, s56, 52429
    s_lshr_b32 s57, s57, 19
    s_mul_i32 s58, s57, 10
    s_sub_u32 s58, s56, s58
    s_cmp_eq_u64 vcc, -1
    s_cbranch_scc1 L_ppok_31
    v_lshlrev_b32 v12, 7, v0
    v_add_u32 v12, 18876416, v12
    v_cmp_gt_u32 vcc, 8, v0
    v_mov_b32 v14, 1
    s_nop 0
    v_cndmask_b32 v13, 0, v14, vcc
    v_cmp_ne_u32 vcc, 0, v13
    s_mov_b32 s66, 200000
    s_nop 1
    s_mov_b64 exec, vcc
L_poll_34:
    global_load_dword v14, v12, s[26:27] sc1
    s_waitcnt vmcnt(0)
    v_cmp_ge_u32 vcc, v14, v13
    s_nop 3
    s_cmp_eq_u64 vcc, exec
    s_cbranch_scc1 L_polld_35
    s_sleep 4
    s_sub_u32 s66, s66, 1
    s_cmp_lg_u32 s66, 0
    s_cbranch_scc1 L_poll_34
L_polld_35:
    s_mov_b64 exec, -1
L_ppok_31:
    s_mov_b32 s36, s10
    s_mov_b32 s37, s11
    s_mov_b32 s38, 0x280000
    s_mov_b32 s39, 0x00020000
    v_and_b32 v12, 7, v0
    v_lshrrev_b32 v13, 3, v0
    s_lshl_b32 s54, s58, 6
    v_lshl_add_u32 v12, v12, 3, s54
    s_lshl_b32 s55, s57, 5
    v_lshl_add_u32 v13, v13, 2, s55
    v_mul_u32_u24 v14, 1280, v13
    v_lshl_add_u32 v14, v12, 1, v14
    v_mul_u32_u24 v15, 2560, v13
    v_lshl_add_u32 v15, v12, 1, v15
    v_add_u32 v164, 1280, v15
    v_lshlrev_b32 v15, 12, v12
    v_lshl_add_u32 v15, v13, 1, v15
    v_add_u32 v165, 11534336, v15
    buffer_load_dwordx4 v[148:151], v14, s[36:39], 0 offen offset:0
    buffer_load_dwordx4 v[152:155], v14, s[36:39], 0 offen offset:1280
    buffer_load_dwordx4 v[156:159], v14, s[36:39], 0 offen offset:2560
    buffer_load_dwordx4 v[160:163], v14, s[36:39], 0 offen offset:3840
    s_mov_b32 s54, 0
    buffer_load_dwordx2 v[132:133], v165, s[28:31], s54 offen sc1
    s_mov_b32 s54, 4096
    buffer_load_dwordx2 v[134:135], v165, s[28:31], s54 offen sc1
    s_mov_b32 s54, 8192
    buffer_load_dwordx2 v[136:137], v165, s[28:31], s54 offen sc1
    s_mov_b32 s54, 12288
    buffer_load_dwordx2 v[138:139], v165, s[28:31], s54 offen sc1
    s_mov_b32 s54, 16384
    buffer_load_dwordx2 v[140:141], v165, s[28:31], s54 offen sc1
    s_mov_b32 s54, 20480
    buffer_load_dwordx2 v[142:143], v165, s[28:31], s54 offen sc1
    s_mov_b32 s54, 24576
    buffer_load_dwordx2 v[144:145], v165, s[28:31], s54 offen sc1
    s_mov_b32 s54, 28672
    buffer_load_dwordx2 v[146:147], v165, s[28:31], s54 offen sc1
L_pps_30:
    s_setprio 3
    v_mfma_f32_32x32x16_bf16 v[48:63], v[80:83], v[4:7], 0
    ds_read_b128 v[80:83], v99 offset:0
    v_exp_f32 v32, v32
    v_exp_f32 v33, v33
    v_exp_f32 v34, v34
    v_exp_f32 v35, v35
    v_cvt_pk_bf16_f32 v64, v32, v33
    v_cvt_pk_bf16_f32 v65, v34, v35
    v_mfma_f32_32x32x8bf16_1k v[48:63], v[84:85], v[8:9], v[48:63]
    ds_read_b64 v[84:85], v100 offset:0
    v_exp_f32 v36, v36
    v_exp_f32 v37, v37
    v_exp_f32 v38, v38
    v_exp_f32 v39, v39
    v_cvt_pk_bf16_f32 v66, v36, v37
    v_cvt_pk_bf16_f32 v67, v38, v39
    s_waitcnt lgkmcnt(2)
    v_mfma_f32_32x32x16_bf16 v[16:31], v[88:91], v[72:75], v[16:31]
    ds_read_b128 v[88:91], v101 offset:0
    v_exp_f32 v40, v40
    v_exp_f32 v41, v41
    v_exp_f32 v42, v42
    v_exp_f32 v43, v43
    v_cvt_pk_bf16_f32 v68, v40, v41
    v_cvt_pk_bf16_f32 v69, v42, v43
    v_mfma_f32_32x32x16_bf16 v[16:31], v[92:95], v[76:79], v[16:31]
    ds_read_b128 v[92:95], v101 offset:768
    v_exp_f32 v44, v44
    v_exp_f32 v45, v45
    v_exp_f32 v46, v46
    v_exp_f32 v47, v47
    v_cvt_pk_bf16_f32 v70, v44, v45
    v_cvt_pk_bf16_f32 v71, v46, v47
    s_waitcnt lgkmcnt(2)
    v_mfma_f32_32x32x16_bf16 v[32:47], v[80:83], v[4:7], 0
    ds_read_b128 v[80:83], v99 offset:3072
    v_exp_f32 v48, v48
    v_exp_f32 v49, v49
    v_exp_f32 v50, v50
    v_exp_f32 v51, v51
    v_cvt_pk_bf16_f32 v72, v48, v49
    v_cvt_pk_bf16_f32 v73, v50, v51
    v_mfma_f32_32x32x8bf16_1k v[32:47], v[84:85], v[8:9], v[32:47]
    ds_read_b64 v[84:85], v100 offset:3072
    v_exp_f32 v52, v52
    v_exp_f32 v53, v53
    v_exp_f32 v54, v54
    v_exp_f32 v55, v55
    v_cvt_pk_bf16_f32 v74, v52, v53
    v_cvt_pk_bf16_f32 v75, v54, v55
    s_waitcnt lgkmcnt(2)
    v_mfma_f32_32x32x16_bf16 v[16:31], v[88:91], v[64:67], v[16:31]
    ds_read_b128 v[88:91], v101 offset:3072
    v_exp_f32 v56, v56
    v_exp_f32 v57, v57
    v_exp_f32 v58, v58
    v_exp_f32 v59, v59
    v_cvt_pk_bf16_f32 v76, v56, v57
    v_cvt_pk_bf16_f32 v77, v58, v59
    v_mfma_f32_32x32x16_bf16 v[16:31], v[92:95], v[68:71], v[16:31]
    ds_read_b128 v[92:95], v101 offset:3840
    v_exp_f32 v60, v60
    v_exp_f32 v61, v61
    v_exp_f32 v62, v62
    v_exp_f32 v63, v63
    v_cvt_pk_bf16_f32 v78, v60, v61
    v_cvt_pk_bf16_f32 v79, v62, v63
    s_waitcnt lgkmcnt(2)
    v_mfma_f32_32x32x16_bf16 v[48:63], v[80:83], v[4:7], 0
    ds_read_b128 v[80:83], v99 offset:6144
    v_exp_f32 v32, v32
    v_exp_f32 v33, v33
    v_exp_f32 v34, v34
    v_exp_f32 v35, v35
    v_cvt_pk_bf16_f32 v64, v32, v33
    v_cvt_pk_bf16_f32 v65, v34, v35
    v_mfma_f32_32x32x8bf16_1k v[48:63], v[84:85], v[8:9], v[48:63]
    ds_read_b64 v[84:85], v100 offset:6144
    v_exp_f32 v36, v36
    v_exp_f32 v37, v37
    v_exp_f32 v38, v38
    v_exp_f32 v39, v39
    v_cvt_pk_bf16_f32 v66, v36, v37
    v_cvt_pk_bf16_f32 v67, v38, v39
    s_waitcnt lgkmcnt(2)
    v_mfma_f32_32x32x16_bf16 v[16:31], v[88:91], v[72:75], v[16:31]
    ds_read_b128 v[88:91], v101 offset:6144
    v_exp_f32 v40, v40
    v_exp_f32 v41, v41
    v_exp_f32 v42, v42
    v_exp_f32 v43, v43
    v_cvt_pk_bf16_f32 v68, v40, v41
    v_cvt_pk_bf16_f32 v69, v42, v43
    v_mfma_f32_32x32x16_bf16 v[16:31], v[92:95], v[76:79], v[16:31]
    ds_read_b128 v[92:95], v101 offset:6912
    v_exp_f32 v44, v44
    v_exp_f32 v45, v45
    v_exp_f32 v46, v46
    v_exp_f32 v47, v47
    v_cvt_pk_bf16_f32 v70, v44, v45
    v_cvt_pk_bf16_f32 v71, v46, v47
    s_waitcnt lgkmcnt(2)
    v_mfma_f32_32x32x16_bf16 v[32:47], v[80:83], v[4:7], 0
    ds_read_b128 v[80:83], v99 offset:9216
    v_exp_f32 v48, v48
    v_exp_f32 v49, v49
    v_exp_f32 v50, v50
    v_exp_f32 v51, v51
    v_cvt_pk_bf16_f32 v72, v48, v49
    v_cvt_pk_bf16_f32 v73, v50, v51
    v_mfma_f32_32x32x8bf16_1k v[32:47], v[84:85], v[8:9], v[32:47]
    ds_read_b64 v[84:85], v100 offset:9216
    v_exp_f32 v52, v52
    v_exp_f32 v53, v53
    v_exp_f32 v54, v54
    v_exp_f32 v55, v55
    v_cvt_pk_bf16_f32 v74, v52, v53
    v_cvt_pk_bf16_f32 v75, v54, v55
    s_waitcnt lgkmcnt(2)
    v_mfma_f32_32x32x16_bf16 v[16:31], v[88:91], v[64:67], v[16:31]
    ds_read_b128 v[88:91], v101 offset:9216
    v_exp_f32 v56, v56
    v_exp_f32 v57, v57
    v_exp_f32 v58, v58
    v_exp_f32 v59, v59
    v_cvt_pk_bf16_f32 v76, v56, v57
    v_cvt_pk_bf16_f32 v77, v58, v59
    v_mfma_f32_32x32x16_bf16 v[16:31], v[92:95], v[68:71], v[16:31]
    ds_read_b128 v[92:95], v101 offset:9984
    v_exp_f32 v60, v60
    v_exp_f32 v61, v61
    v_exp_f32 v62, v62
    v_exp_f32 v63, v63
    v_cvt_pk_bf16_f32 v78, v60, v61
    v_cvt_pk_bf16_f32 v79, v62, v63
    s_waitcnt lgkmcnt(2)
    v_mfma_f32_32x32x16_bf16 v[48:63], v[80:83], v[4:7], 0
    ds_read_b128 v[80:83], v99 offset:12288
    v_exp_f32 v32, v32
    v_exp_f32 v33, v33
    v_exp_f32 v34, v34
    v_exp_f32 v35, v35
    v_cvt_pk_bf16_f32 v64, v32, v33
    v_cvt_pk_bf16_f32 v65, v34, v35
    v_mfma_f32_32x32x8bf16_1k v[48:63], v[84:85], v[8:9], v[48:63]
    ds_read_b64 v[84:85], v100 offset:12288
    v_exp_f32 v36, v36
    v_exp_f32 v37, v37
    v_exp_f32 v38, v38
    v_exp_f32 v39, v39
    v_cvt_pk_bf16_f32 v66, v36, v37
    v_cvt_pk_bf16_f32 v67, v38, v39
    s_waitcnt lgkmcnt(2)
    v_mfma_f32_32x32x16_bf16 v[16:31], v[88:91], v[72:75], v[16:31]
    ds_read_b128 v[88:91], v101 offset:12288
    v_exp_f32 v40, v40
    v_exp_f32 v41, v41
    v_exp_f32 v42, v42
    v_exp_f32 v43, v43
    v_cvt_pk_bf16_f32 v68, v40, v41
    v_cvt_pk_bf16_f32 v69, v42, v43
    v_mfma_f32_32x32x16_bf16 v[16:31], v[92:95], v[76:79], v[16:31]
    ds_read_b128 v[92:95], v101 offset:13056
    v_exp_f32 v44, v44
    v_exp_f32 v45, v45
    v_exp_f32 v46, v46
    v_exp_f32 v47, v47
    v_cvt_pk_bf16_f32 v70, v44, v45
    v_cvt_pk_bf16_f32 v71, v46, v47
    s_waitcnt lgkmcnt(2)
    v_mfma_f32_32x32x16_bf16 v[32:47], v[80:83], v[4:7], 0
    ds_read_b128 v[80:83], v99 offset:15360
    v_exp_f32 v48, v48
    v_exp_f32 v49, v49
    v_exp_f32 v50, v50
    v_exp_f32 v51, v51
    v_cvt_pk_bf16_f32 v72, v48, v49
    v_cvt_pk_bf16_f32 v73, v50, v51
    v_mfma_f32_32x32x8bf16_1k v[32:47], v[84:85], v[8:9], v[32:47]
    ds_read_b64 v[84:85], v100 offset:15360
    v_exp_f32 v52, v52
    v_exp_f32 v53, v53
    v_exp_f32 v54, v54
    v_exp_f32 v55, v55
    v_cvt_pk_bf16_f32 v74, v52, v53
    v_cvt_pk_bf16_f32 v75, v54, v55
    s_waitcnt lgkmcnt(2)
    v_mfma_f32_32x32x16_bf16 v[16:31], v[88:91], v[64:67], v[16:31]
    ds_read_b128 v[88:91], v101 offset:15360
    v_exp_f32 v56, v56
    v_exp_f32 v57, v57
    v_exp_f32 v58, v58
    v_exp_f32 v59, v59
    v_cvt_pk_bf16_f32 v76, v56, v57
    v_cvt_pk_bf16_f32 v77, v58, v59
    v_mfma_f32_32x32x16_bf16 v[16:31], v[92:95], v[68:71], v[16:31]
    ds_read_b128 v[92:95], v101 offset:16128
    v_exp_f32 v60, v60
    v_exp_f32 v61, v61
    v_exp_f32 v62, v62
    v_exp_f32 v63, v63
    v_cvt_pk_bf16_f32 v78, v60, v61
    v_cvt_pk_bf16_f32 v79, v62, v63
    s_waitcnt lgkmcnt(2)
    v_mfma_f32_32x32x16_bf16 v[48:63], v[80:83], v[4:7], 0
    ds_read_b128 v[80:83], v99 offset:18432
    v_exp_f32 v32, v32
    v_exp_f32 v33, v33
    v_exp_f32 v34, v34
    v_exp_f32 v35, v35
    v_cvt_pk_bf16_f32 v64, v32, v33
    v_cvt_pk_bf16_f32 v65, v34, v35
    v_mfma_f32_32x32x8bf16_1k v[48:63], v[84:85], v[8:9], v[48:63]
    ds_read_b64 v[84:85], v100 offset:18432
    v_exp_f32 v36, v36
    v_exp_f32 v37, v37
    v_exp_f32 v38, v38
    v_exp_f32 v39, v39
    v_cvt_pk_bf16_f32 v66, v36, v37
    v_cvt_pk_bf16_f32 v67, v38, v39
    s_waitcnt lgkmcnt(2)
    v_mfma_f32_32x32x16_bf16 v[16:31], v[88:91], v[72:75], v[16:31]
    ds_read_b128 v[88:91], v101 offset:18432
    v_exp_f32 v40, v40
    v_exp_f32 v41, v41
    v_exp_f32 v42, v42
    v_exp_f32 v43, v43
    v_cvt_pk_bf16_f32 v68, v40, v41
    v_cvt_pk_bf16_f32 v69, v42, v43
    v_mfma_f32_32x32x16_bf16 v[16:31], v[92:95], v[76:79], v[16:31]
    ds_read_b128 v[92:95], v101 offset:19200
    v_exp_f32 v44, v44
    v_exp_f32 v45, v45
    v_exp_f32 v46, v46
    v_exp_f32 v47, v47
    v_cvt_pk_bf16_f32 v70, v44, v45
    v_cvt_pk_bf16_f32 v71, v46, v47
    s_waitcnt lgkmcnt(2)
    v_mfma_f32_32x32x16_bf16 v[32:47], v[80:83], v[4:7], 0
    ds_read_b128 v[80:83], v99 offset:21504
    v_exp_f32 v48, v48
    v_exp_f32 v49, v49
    v_exp_f32 v50, v50
    v_exp_f32 v51, v51
    v_cvt_pk_bf16_f32 v72, v48, v49
    v_cvt_pk_bf16_f32 v73, v50, v51
    v_mfma_f32_32x32x8bf16_1k v[32:47], v[84:85], v[8:9], v[32:47]
    ds_read_b64 v[84:85], v100 offset:21504
    v_exp_f32 v52, v52
    v_exp_f32 v53, v53
    v_exp_f32 v54, v54
    v_exp_f32 v55, v55
    v_cvt_pk_bf16_f32 v74, v52, v53
    v_cvt_pk_bf16_f32 v75, v54, v55
    s_waitcnt lgkmcnt(2)
    v_mfma_f32_32x32x16_bf16 v[16:31], v[88:91], v[64:67], v[16:31]
    ds_read_b128 v[88:91], v101 offset:21504
    v_exp_f32 v56, v56
    v_exp_f32 v57, v57
    v_exp_f32 v58, v58
    v_exp_f32 v59, v59
    v_cvt_pk_bf16_f32 v76, v56, v57
    v_cvt_pk_bf16_f32 v77, v58, v59
    v_mfma_f32_32x32x16_bf16 v[16:31], v[92:95], v[68:71], v[16:31]
    ds_read_b128 v[92:95], v101 offset:22272
    v_exp_f32 v60, v60
    v_exp_f32 v61, v61
    v_exp_f32 v62, v62
    v_exp_f32 v63, v63
    v_cvt_pk_bf16_f32 v78, v60, v61
    v_cvt_pk_bf16_f32 v79, v62, v63
    s_waitcnt lgkmcnt(2)
    v_mfma_f32_32x32x16_bf16 v[48:63], v[80:83], v[4:7], 0
    ds_read_b128 v[80:83], v99 offset:24576
    v_exp_f32 v32, v32
    v_exp_f32 v33, v33
    v_exp_f32 v34, v34
    v_exp_f32 v35, v35
    v_cvt_pk_bf16_f32 v64, v32, v33
    v_cvt_pk_bf16_f32 v65, v34, v35
    v_mfma_f32_32x32x8bf16_1k v[48:63], v[84:85], v[8:9], v[48:63]
    ds_read_b64 v[84:85], v100 offset:24576
    v_exp_f32 v36, v36
    v_exp_f32 v37, v37
    v_exp_f32 v38, v38
    v_exp_f32 v39, v39
    v_cvt_pk_bf16_f32 v66, v36, v37
    v_cvt_pk_bf16_f32 v67, v38, v39
    s_waitcnt lgkmcnt(2)
    v_mfma_f32_32x32x16_bf16 v[16:31], v[88:91], v[72:75], v[16:31]
    ds_read_b128 v[88:91], v101 offset:24576
    v_exp_f32 v40, v40
    v_exp_f32 v41, v41
    v_exp_f32 v42, v42
    v_exp_f32 v43, v43
    v_cvt_pk_bf16_f32 v68, v40, v41
    v_cvt_pk_bf16_f32 v69, v42, v43
    v_mfma_f32_32x32x16_bf16 v[16:31], v[92:95], v[76:79], v[16:31]
    ds_read_b128 v[92:95], v101 offset:25344
    v_exp_f32 v44, v44
    v_exp_f32 v45, v45
    v_exp_f32 v46, v46
    v_exp_f32 v47, v47
    v_cvt_pk_bf16_f32 v70, v44, v45
    v_cvt_pk_bf16_f32 v71, v46, v47
    s_setprio 2
    s_waitcnt lgkmcnt(2)
    v_mfma_f32_32x32x16_bf16 v[32:47], v[80:83], v[4:7], 0
    ds_read_b128 v[80:83], v99 offset:27648
    v_exp_f32 v48, v48
    v_exp_f32 v49, v49
    v_exp_f32 v50, v50
    v_exp_f32 v51, v51
    v_cvt_pk_bf16_f32 v72, v48, v49
    v_cvt_pk_bf16_f32 v73, v50, v51
    v_mfma_f32_32x32x8bf16_1k v[32:47], v[84:85], v[8:9], v[32:47]
    ds_read_b64 v[84:85], v100 offset:27648
    v_exp_f32 v52, v52
    v_exp_f32 v53, v53
    v_exp_f32 v54, v54
    v_exp_f32 v55, v55
    v_cvt_pk_bf16_f32 v74, v52, v53
    v_cvt_pk_bf16_f32 v75, v54, v55
    s_waitcnt lgkmcnt(2)
    v_mfma_f32_32x32x16_bf16 v[16:31], v[88:91], v[64:67], v[16:31]
    ds_read_b128 v[88:91], v101 offset:27648
    v_exp_f32 v56, v56
    v_exp_f32 v57, v57
    v_exp_f32 v58, v58
    v_exp_f32 v59, v59
    v_cvt_pk_bf16_f32 v76, v56, v57
    v_cvt_pk_bf16_f32 v77, v58, v59
    v_mfma_f32_32x32x16_bf16 v[16:31], v[92:95], v[68:71], v[16:31]
    ds_read_b128 v[92:95], v101 offset:28416
    v_exp_f32 v60, v60
    v_exp_f32 v61, v61
    v_exp_f32 v62, v62
    v_exp_f32 v63, v63
    v_cvt_pk_bf16_f32 v78, v60, v61
    v_cvt_pk_bf16_f32 v79, v62, v63
    s_waitcnt lgkmcnt(2)
    v_mfma_f32_32x32x16_bf16 v[48:63], v[80:83], v[4:7], 0
    ds_read_b128 v[80:83], v99 offset:30720
    v_exp_f32 v32, v32
    v_exp_f32 v33, v33
    v_exp_f32 v34, v34
    v_exp_f32 v35, v35
    v_cvt_pk_bf16_f32 v64, v32, v33
    v_cvt_pk_bf16_f32 v65, v34, v35
    v_mfma_f32_32x32x8bf16_1k v[48:63], v[84:85], v[8:9], v[48:63]
    ds_read_b64 v[84:85], v100 offset:30720
    v_exp_f32 v36, v36
    v_exp_f32 v37, v37
    v_exp_f32 v38, v38
    v_exp_f32 v39, v39
    v_cvt_pk_bf16_f32 v66, v36, v37
    v_cvt_pk_bf16_f32 v67, v38, v39
    s_waitcnt lgkmcnt(2)
    v_mfma_f32_32x32x16_bf16 v[16:31], v[88:91], v[72:75], v[16:31]
    ds_read_b128 v[88:91], v101 offset:30720
    v_exp_f32 v40, v40
    v_exp_f32 v41, v41
    v_exp_f32 v42, v42
    v_exp_f32 v43, v43
    v_cvt_pk_bf16_f32 v68, v40, v41
    v_cvt_pk_bf16_f32 v69, v42, v43
    v_mfma_f32_32x32x16_bf16 v[16:31], v[92:95], v[76:79], v[16:31]
    ds_read_b128 v[92:95], v101 offset:31488
    v_exp_f32 v44, v44
    v_exp_f32 v45, v45
    v_exp_f32 v46, v46
    v_exp_f32 v47, v47
    v_cvt_pk_bf16_f32 v70, v44, v45
    v_cvt_pk_bf16_f32 v71, v46, v47
    s_waitcnt lgkmcnt(2)
    v_mfma_f32_32x32x16_bf16 v[32:47], v[80:83], v[4:7], 0
    ds_read_b128 v[80:83], v99 offset:33792
    v_exp_f32 v48, v48
    v_exp_f32 v49, v49
    v_exp_f32 v50, v50
    v_exp_f32 v51, v51
    v_cvt_pk_bf16_f32 v72, v48, v49
    v_cvt_pk_bf16_f32 v73, v50, v51
    v_mfma_f32_32x32x8bf16_1k v[32:47], v[84:85], v[8:9], v[32:47]
    ds_read_b64 v[84:85], v100 offset:33792
    v_exp_f32 v52, v52
    v_exp_f32 v53, v53
    v_exp_f32 v54, v54
    v_exp_f32 v55, v55
    v_cvt_pk_bf16_f32 v74, v52, v53
    v_cvt_pk_bf16_f32 v75, v54, v55
    s_waitcnt lgkmcnt(2)
    v_mfma_f32_32x32x16_bf16 v[16:31], v[88:91], v[64:67], v[16:31]
    ds_read_b128 v[88:91], v101 offset:33792
    v_exp_f32 v56, v56
    v_exp_f32 v57, v57
    v_exp_f32 v58, v58
    v_exp_f32 v59, v59
    v_cvt_pk_bf16_f32 v76, v56, v57
    v_cvt_pk_bf16_f32 v77, v58, v59
    v_mfma_f32_32x32x16_bf16 v[16:31], v[92:95], v[68:71], v[16:31]
    ds_read_b128 v[92:95], v101 offset:34560
    v_exp_f32 v60, v60
    v_exp_f32 v61, v61
    v_exp_f32 v62, v62
    v_exp_f32 v63, v63
    v_cvt_pk_bf16_f32 v78, v60, v61
    v_cvt_pk_bf16_f32 v79, v62, v63
    s_waitcnt lgkmcnt(2)
    v_mfma_f32_32x32x16_bf16 v[48:63], v[80:83], v[4:7], 0
    ds_read_b128 v[80:83], v99 offset:36864
    v_exp_f32 v32, v32
    v_exp_f32 v33, v33
    v_exp_f32 v34, v34
    v_exp_f32 v35, v35
    v_cvt_pk_bf16_f32 v64, v32, v33
    v_cvt_pk_bf16_f32 v65, v34, v35
    v_mfma_f32_32x32x8bf16_1k v[48:63], v[84:85], v[8:9], v[48:63]
    ds_read_b64 v[84:85], v100 offset:36864
    v_exp_f32 v36, v36
    v_exp_f32 v37, v37
    v_exp_f32 v38, v38
    v_exp_f32 v39, v39
    v_cvt_pk_bf16_f32 v66, v36, v37
    v_cvt_pk_bf16_f32 v67, v38, v39
    s_waitcnt lgkmcnt(2)
    v_mfma_f32_32x32x16_bf16 v[16:31], v[88:91], v[72:75], v[16:31]
    ds_read_b128 v[88:91], v101 offset:36864
    v_exp_f32 v40, v40
    v_exp_f32 v41, v41
    v_exp_f32 v42, v42
    v_exp_f32 v43, v43
    v_cvt_pk_bf16_f32 v68, v40, v41
    v_cvt_pk_bf16_f32 v69, v42, v43
    v_mfma_f32_32x32x16_bf16 v[16:31], v[92:95], v[76:79], v[16:31]
    ds_read_b128 v[92:95], v101 offset:37632
    v_exp_f32 v44, v44
    v_exp_f32 v45, v45
    v_exp_f32 v46, v46
    v_exp_f32 v47, v47
    v_cvt_pk_bf16_f32 v70, v44, v45
    v_cvt_pk_bf16_f32 v71, v46, v47
    s_setprio 1
    s_waitcnt lgkmcnt(2)
    v_mfma_f32_32x32x16_bf16 v[32:47], v[80:83], v[4:7], 0
    ds_read_b128 v[80:83], v99 offset:39936
    v_exp_f32 v48, v48
    v_exp_f32 v49, v49
    v_exp_f32 v50, v50
    v_exp_f32 v51, v51
    v_cvt_pk_bf16_f32 v72, v48, v49
    v_cvt_pk_bf16_f32 v73, v50, v51
    v_mfma_f32_32x32x8bf16_1k v[32:47], v[84:85], v[8:9], v[32:47]
    ds_read_b64 v[84:85], v100 offset:39936
    v_exp_f32 v52, v52
    v_exp_f32 v53, v53
    v_exp_f32 v54, v54
    v_exp_f32 v55, v55
    v_cvt_pk_bf16_f32 v74, v52, v53
    v_cvt_pk_bf16_f32 v75, v54, v55
    s_waitcnt lgkmcnt(2)
    v_mfma_f32_32x32x16_bf16 v[16:31], v[88:91], v[64:67], v[16:31]
    ds_read_b128 v[88:91], v101 offset:39936
    v_exp_f32 v56, v56
    v_exp_f32 v57, v57
    v_exp_f32 v58, v58
    v_exp_f32 v59, v59
    v_cvt_pk_bf16_f32 v76, v56, v57
    v_cvt_pk_bf16_f32 v77, v58, v59
    v_mfma_f32_32x32x16_bf16 v[16:31], v[92:95], v[68:71], v[16:31]
    ds_read_b128 v[92:95], v101 offset:40704
    v_exp_f32 v60, v60
    v_exp_f32 v61, v61
    v_exp_f32 v62, v62
    v_exp_f32 v63, v63
    v_cvt_pk_bf16_f32 v78, v60, v61
    v_cvt_pk_bf16_f32 v79, v62, v63
    s_waitcnt lgkmcnt(2)
    v_mfma_f32_32x32x16_bf16 v[48:63], v[80:83], v[4:7], 0
    v_exp_f32 v32, v32
    v_exp_f32 v33, v33
    v_exp_f32 v34, v34
    v_exp_f32 v35, v35
    v_cvt_pk_bf16_f32 v64, v32, v33
    v_cvt_pk_bf16_f32 v65, v34, v35
    v_mfma_f32_32x32x8bf16_1k v[48:63], v[84:85], v[8:9], v[48:63]
    v_exp_f32 v36, v36
    v_exp_f32 v37, v37
    v_exp_f32 v38, v38
    v_exp_f32 v39, v39
    v_cvt_pk_bf16_f32 v66, v36, v37
    v_cvt_pk_bf16_f32 v67, v38, v39
    s_waitcnt lgkmcnt(0)
    v_mfma_f32_32x32x16_bf16 v[16:31], v[88:91], v[72:75], v[16:31]
    ds_read_b128 v[88:91], v101 offset:43008
    v_exp_f32 v40, v40
    v_exp_f32 v41, v41
    v_exp_f32 v42, v42
    v_exp_f32 v43, v43
    v_cvt_pk_bf16_f32 v68, v40, v41
    v_cvt_pk_bf16_f32 v69, v42, v43
    v_mfma_f32_32x32x16_bf16 v[16:31], v[92:95], v[76:79], v[16:31]
    ds_read_b128 v[92:95], v101 offset:43776
    v_exp_f32 v44, v44
    v_exp_f32 v45, v45
    v_exp_f32 v46, v46
    v_exp_f32 v47, v47
    v_cvt_pk_bf16_f32 v70, v44, v45
    v_cvt_pk_bf16_f32 v71, v46, v47
    s_setprio 0
    s_waitcnt lgkmcnt(2)
    v_exp_f32 v48, v48
    v_exp_f32 v49, v49
    v_exp_f32 v50, v50
    v_exp_f32 v51, v51
    v_cvt_pk_bf16_f32 v72, v48, v49
    v_cvt_pk_bf16_f32 v73, v50, v51
    v_exp_f32 v52, v52
    v_exp_f32 v53, v53
    v_exp_f32 v54, v54
    v_exp_f32 v55, v55
    v_cvt_pk_bf16_f32 v74, v52, v53
    v_cvt_pk_bf16_f32 v75, v54, v55
    s_waitcnt lgkmcnt(0)
    v_mfma_f32_32x32x16_bf16 v[16:31], v[88:91], v[64:67], v[16:31]
    ds_read_b128 v[88:91], v101 offset:46080
    v_exp_f32 v56, v56
    v_exp_f32 v57, v57
    v_exp_f32 v58, v58
    v_exp_f32 v59, v59
    v_cvt_pk_bf16_f32 v76, v56, v57
    v_cvt_pk_bf16_f32 v77, v58, v59
    v_mfma_f32_32x32x16_bf16 v[16:31], v[92:95], v[68:71], v[16:31]
    ds_read_b128 v[92:95], v101 offset:46848
    v_exp_f32 v60, v60
    v_exp_f32 v61, v61
    v_exp_f32 v62, v62
    v_exp_f32 v63, v63
    v_cvt_pk_bf16_f32 v78, v60, v61
    v_cvt_pk_bf16_f32 v79, v62, v63
    s_waitcnt lgkmcnt(0)
    v_mfma_f32_32x32x16_bf16 v[16:31], v[88:91], v[72:75], v[16:31]
    v_mfma_f32_32x32x16_bf16 v[16:31], v[92:95], v[76:79], v[16:31]
    s_setprio 0
    s_lshl_b32 s52, s43, 6
    s_add_u32 s52, s52, s46
    s_mul_i32 s52, s52, 1536
    s_add_u32 s52, s52, 14680064
    v_lshlrev_b32 v104, 4, v0
    s_nop 7
L_fin_36:
    s_nop 7
    v_mov_b32 v110, v24
    v_mov_b32 v111, v24
    s_nop 1
    v_permlane32_swap_b32 v110, v111
    s_nop 1
    v_rcp_f32 v112, v111
    s_nop 0
    v_pk_mul_f32 v[16:17], v[16:17], v[112:113] op_sel_hi:[1,0]
    v_pk_mul_f32 v[18:19], v[18:19], v[112:113] op_sel_hi:[1,0]
    v_pk_mul_f32 v[20:21], v[20:21], v[112:113] op_sel_hi:[1,0]
    v_pk_mul_f32 v[22:23], v[22:23], v[112:113] op_sel_hi:[1,0]
    v_pk_mul_f32 v[24:25], v[24:25], v[112:113] op_sel_hi:[1,0]
    v_pk_mul_f32 v[26:27], v[26:27], v[112:113] op_sel_hi:[1,0]
    v_add_f32 v113, abs(v16), abs(v17)
    v_add_f32 v114, abs(v24), abs(v25)
    v_add_f32 v113, v113, abs(v18)
    v_add_f32 v113, v113, abs(v19)
    v_add_f32 v113, v113, abs(v20)
    v_add_f32 v113, v113, abs(v21)
    v_add_f32 v113, v113, abs(v22)
    v_add_f32 v113, v113, abs(v23)
    v_add_f32 v114, v114, abs(v26)
    v_add_f32 v114, v114, abs(v27)
    v_cmp_gt_u32 vcc, 32, v0
    v_mov_b32 v115, 0x21800000
    v_mov_b32 v116, 0x5d800000
    v_cndmask_b32 v114, 0, v114, vcc
    v_add_f32 v113, v113, v114
    v_mov_b32 v114, 0x7f800000
    v_cmp_nlt_f32 s[54:55], v113, v114
    v_cmp_ngt_f32 s[56:57], v111, v115
    v_cmp_nlt_f32 vcc, v111, v116
    s_nop 1
    s_or_b64 s[54:55], s[54:55], s[56:57]
    s_or_b64 s[54:55], s[54:55], vcc
    s_cmp_lg_u64 s[54:55], 0
    s_cselect_b32 s61, 1, 0
    s_andn2_b32 s61, s61, s60
    s_cmp_lg_u32 s61, 0
    s_cbranch_scc1 L_slow_37
    v_cvt_pk_bf16_f32 v16, v16, v17
    v_cvt_pk_bf16_f32 v17, v18, v19
    v_cvt_pk_bf16_f32 v18, v20, v21
    v_cvt_pk_bf16_f32 v19, v22, v23
    v_cvt_pk_bf16_f32 v24, v24, v25
    v_cvt_pk_bf16_f32 v25, v26, v27
    v_mov_b32 v26, 0
    v_mov_b32 v27, 0
    buffer_store_dwordx4 v[16:19], v104, s[28:31], s52 offen sc1
    s_mov_b32 exec_hi, 0
    buffer_store_dwordx4 v[24:27], v104, s[28:31], s52 offen offset:1024 sc1
    s_mov_b64 exec, -1
    s_branch L_odone_38
L_slow_37:
    s_mov_b32 s60, 1
    v_mov_b32 v110, 0xff800000
    s_mov_b32 s52, 0
L_p1_39:
    s_mul_i32 s63, s52, 8320
    s_add_u32 s63, s63, 2662400
    buffer_load_dwordx4 v[80:83], v129, s[28:31], s63 offen sc1
    buffer_load_dwordx2 v[84:85], v130, s[28:31], s63 offen sc1
    s_waitcnt vmcnt(0)
    v_mfma_f32_32x32x16_bf16 v[32:47], v[80:83], v[4:7], 0
    v_mfma_f32_32x32x16_bf16 v[32:47], v[84:87], v[8:11], v[32:47]
    s_nop 7
    s_nop 7
    v_max3_f32 v110, v110, v32, v33
    v_max3_f32 v110, v110, v34, v35
    v_max3_f32 v110, v110, v36, v37
    v_max3_f32 v110, v110, v38, v39
    v_max3_f32 v110, v110, v40, v41
    v_max3_f32 v110, v110, v42, v43
    v_max3_f32 v110, v110, v44, v45
    v_max3_f32 v110, v110, v46, v47
    s_add_u32 s52, s52, 1
    s_cmp_lt_u32 s52, 64
    s_cbranch_scc1 L_p1_39
    v_mov_b32 v108, v110
    v_mov_b32 v109, v110
    s_nop 1
    v_permlane32_swap_b32 v108, v109
    s_nop 1
    v_max_f32 v110, v108, v109
    v_and_b32 v3, 31, v0
    v_cmp_gt_u32 vcc, 20, v3
    v_add_u32 v108, 4096, v131
    s_nop 0
    v_cndmask_b32 v109, v131, v108, vcc
    v_mov_b32 v16, 0
    v_mov_b32 v17, 0
    v_mov_b32 v18, 0
    v_mov_b32 v19, 0
    v_mov_b32 v20, 0
    v_mov_b32 v21, 0
    v_mov_b32 v22, 0
    v_mov_b32 v23, 0
    v_mov_b32 v24, 0
    v_mov_b32 v25, 0
    v_mov_b32 v26, 0
    v_mov_b32 v27, 0
    v_mov_b32 v28, 0
    v_mov_b32 v29, 0
    v_mov_b32 v30, 0
    v_mov_b32 v31, 0
    s_mov_b32 s52, 0
L_p2_40:
    s_mul_i32 s54, s52, 8320
    s_add_u32 s63, s54, 2662400
    buffer_load_dwordx4 v[80:83], v129, s[28:31], s63 offen sc1
    buffer_load_dwordx2 v[84:85], v130, s[28:31], s63 offen sc1
    buffer_load_dwordx4 v[88:91], v131, s[28:31], s54 offen sc1
    buffer_load_dwordx4 v[92:95], v109, s[28:31], s54 offen sc1
    s_waitcnt vmcnt(0)
    v_mfma_f32_32x32x16_bf16 v[32:47], v[80:83], v[4:7], 0
    v_mfma_f32_32x32x16_bf16 v[32:47], v[84:87], v[8:11], v[32:47]
    s_nop 7
    s_nop 7
    v_sub_f32 v32, v32, v110
    v_sub_f32 v33, v33, v110
    v_sub_f32 v34, v34, v110
    v_sub_f32 v35, v35, v110
    v_sub_f32 v36, v36, v110
    v_sub_f32 v37, v37, v110
    v_sub_f32 v38, v38, v110
    v_sub_f32 v39, v39, v110
    v_sub_f32 v40, v40, v110
    v_sub_f32 v41, v41, v110
    v_sub_f32 v42, v42, v110
    v_sub_f32 v43, v43, v110
    v_sub_f32 v44, v44, v110
    v_sub_f32 v45, v45, v110
    v_sub_f32 v46, v46, v110
    v_sub_f32 v47, v47, v110
    v_exp_f32 v32, v32
    v_exp_f32 v33, v33
    v_exp_f32 v34, v34
    v_exp_f32 v35, v35
    v_exp_f32 v36, v36
    v_exp_f32 v37, v37
    v_exp_f32 v38, v38
    v_exp_f32 v39, v39
    v_exp_f32 v40, v40
    v_exp_f32 v41, v41
    v_exp_f32 v42, v42
    v_exp_f32 v43, v43
    v_exp_f32 v44, v44
    v_exp_f32 v45, v45
    v_exp_f32 v46, v46
    v_exp_f32 v47, v47
    s_nop 0
    v_cvt_pk_bf16_f32 v64, v32, v33
    v_cvt_pk_bf16_f32 v65, v34, v35
    v_cvt_pk_bf16_f32 v66, v36, v37
    v_cvt_pk_bf16_f32 v67, v38, v39
    v_cvt_pk_bf16_f32 v68, v40, v41
    v_cvt_pk_bf16_f32 v69, v42, v43
    v_cvt_pk_bf16_f32 v70, v44, v45
    v_cvt_pk_bf16_f32 v71, v46, v47
    s_nop 1
    v_mfma_f32_32x32x16_bf16 v[16:31], v[88:91], v[64:67], v[16:31]
    v_mfma_f32_32x32x16_bf16 v[16:31], v[92:95], v[68:71], v[16:31]
    s_add_u32 s52, s52, 1
    s_cmp_lt_u32 s52, 64
    s_cbranch_scc1 L_p2_40
    s_nop 7
    s_lshl_b32 s52, s43, 6
    s_add_u32 s52, s52, s46
    s_mul_i32 s52, s52, 1536
    s_add_u32 s52, s52, 14680064
    v_lshlrev_b32 v104, 4, v0
    s_branch L_fin_36
L_odone_38:
    s_lshl_b32 s54, s41, 2
    s_lshr_b32 s55, s42, 3
    s_add_u32 s54, s54, s55
    s_lshl_b32 s54, s54, 2
    s_and_b32 s55, s40, 3
    s_add_u32 s54, s54, s55
    s_lshr_b32 s45, s54, 1
    s_mul_i32 s45, s45, 1536
    s_and_b32 s57, s54, 1
    s_lshl_b32 s57, s57, 8
    s_add_u32 s45, s45, s57
    s_add_u32 s45, s45, 14680064
    s_lshr_b32 s57, s40, 2
    s_mul_i32 s57, s57, 1572864
    s_add_u32 s62, s45, s57
    v_lshrrev_b32 v5, 4, v0
    v_and_b32 v6, 15, v0
    v_lshlrev_b32 v6, 4, v6
    v_add_u32 v8, 0, v5
    v_mul_u32_u24 v9, 21846, v8
    v_lshrrev_b32 v9, 16, v9
    v_mul_u32_u24 v10, 3, v9
    v_sub_u32 v10, v8, v10
    v_mul_u32_u24 v9, 1536, v9
    v_lshlrev_b32 v9, 6, v9
    v_lshl_add_u32 v9, v10, 9, v9
    v_add_u32 v88, v9, v6
    v_add_u32 v8, 4, v5
    v_mul_u32_u24 v9, 21846, v8
    v_lshrrev_b32 v9, 16, v9
    v_mul_u32_u24 v10, 3, v9
    v_sub_u32 v10, v8, v10
    v_mul_u32_u24 v9, 1536, v9
    v_lshlrev_b32 v9, 6, v9
    v_lshl_add_u32 v9, v10, 9, v9
    v_add_u32 v89, v9, v6
    v_add_u32 v8, 8, v5
    v_mul_u32_u24 v9, 21846, v8
    v_lshrrev_b32 v9, 16, v9
    v_mul_u32_u24 v10, 3, v9
    v_sub_u32 v10, v8, v10
    v_mul_u32_u24 v9, 1536, v9
    v_lshlrev_b32 v9, 6, v9
    v_lshl_add_u32 v9, v10, 9, v9
    v_add_u32 v90, v9, v6
    v_and_b32 v3, 15, v0
    s_lshl_b32 s55, s54, 4
    v_add_u32 v3, s55, v3
    v_mul_u32_u24 v3, 2560, v3
    v_lshrrev_b32 v4, 4, v0
    v_lshl_add_u32 v3, v4, 3, v3
    s_and_b32 s55, s42, 7
    s_mul_i32 s55, s55, 160
    v_add_u32 v91, s55, v3
    v_lshlrev_b32 v3, 4, v0
    s_and_b32 s55, s40, 3
    s_mul_i32 s55, s55, 5120
    s_add_u32 s55, s55, 49152
    v_add_u32 v92, s55, v3
    v_bfe_u32 v6, v0, 2, 2
    v_and_b32 v7, 3, v0
    v_lshlrev_b32 v7, 3, v7
    s_mov_b32 s59, 98304
    s_waitcnt vmcnt(0)
    v_mov_b32 v2, 162060
    v_mov_b32 v3, 1
    s_mov_b64 exec, 1
    ds_add_rtn_u32 v3, v2, v3
    s_waitcnt lgkmcnt(0)
    s_mov_b64 exec, -1
    v_readfirstlane_b32 s66, v3
    s_nop 3
    s_add_u32 s66, s66, 1
    s_cmp_lg_u32 s66, 8
    s_cbranch_scc1 L_os_43
    s_add_u32 s65, s44, 24
    s_lshl_b32 s66, s65, 7
    s_add_u32 s66, s66, 18874368
    v_mov_b32 v2, s66
    v_mov_b32 v3, 1
    s_mov_b64 exec, 1
    global_atomic_add v3, v2, v3, s[26:27] sc0 sc1
    s_waitcnt vmcnt(0)
    s_mov_b64 exec, -1
    v_readfirstlane_b32 s66, v3
    s_nop 3
    s_add_u32 s66, s66, 1
    s_cmp_lg_u32 s66, 32
    s_cbranch_scc1 L_ga_44
    v_add_u32 v2, 1024, v2
    v_mov_b32 v3, 1
    s_mov_b64 exec, 1
    global_store_dword v2, v3, s[26:27] sc1
    s_mov_b64 exec, -1
L_ga_44:
L_os_43:
    s_cmp_ge_u32 s40, 4
    s_cbranch_scc1 L_ahi_41
    v_add_u32 v8, 0, v5
    v_mul_u32_u24 v9, 21846, v8
    v_lshrrev_b32 v9, 16, v9
    v_mul_u32_u24 v10, 3, v9
    v_sub_u32 v10, v8, v10
    v_mul_u32_u24 v9, 20, v9
    v_add_u32 v9, v9, v6
    v_lshlrev_b32 v11, 2, v10
    v_cmp_eq_u32 vcc, 2, v10
    v_add_u32 v12, 8, v11
    v_lshlrev_b32 v13, 1, v11
    v_cndmask_b32 v11, v11, v13, vcc
    v_add_u32 v11, v11, v9
    v_add_u32 v12, v12, v9
    v_mul_u32_u24 v13, 160, v11
    v_add3_u32 v80, v13, v7, s59
    v_mul_u32_u24 v13, 160, v12
    v_add3_u32 v81, v13, v7, s59
    v_add_u32 v8, 4, v5
    v_mul_u32_u24 v9, 21846, v8
    v_lshrrev_b32 v9, 16, v9
    v_mul_u32_u24 v10, 3, v9
    v_sub_u32 v10, v8, v10
    v_mul_u32_u24 v9, 20, v9
    v_add_u32 v9, v9, v6
    v_lshlrev_b32 v11, 2, v10
    v_cmp_eq_u32 vcc, 2, v10
    v_add_u32 v12, 8, v11
    v_lshlrev_b32 v13, 1, v11
    v_cndmask_b32 v11, v11, v13, vcc
    v_add_u32 v11, v11, v9
    v_add_u32 v12, v12, v9
    v_mul_u32_u24 v13, 160, v11
    v_add3_u32 v82, v13, v7, s59
    v_mul_u32_u24 v13, 160, v12
    v_add3_u32 v83, v13, v7, s59
    v_add_u32 v8, 8, v5
    v_mul_u32_u24 v9, 21846, v8
    v_lshrrev_b32 v9, 16, v9
    v_mul_u32_u24 v10, 3, v9
    v_sub_u32 v10, v8, v10
    v_mul_u32_u24 v9, 20, v9
    v_add_u32 v9, v9, v6
    v_lshlrev_b32 v11, 2, v10
    v_cmp_eq_u32 vcc, 2, v10
    v_add_u32 v12, 8, v11
    v_lshlrev_b32 v13, 1, v11
    v_cndmask_b32 v11, v11, v13, vcc
    v_add_u32 v11, v11, v9
    v_add_u32 v12, v12, v9
    v_mul_u32_u24 v13, 160, v11
    v_add3_u32 v84, v13, v7, s59
    v_mul_u32_u24 v13, 160, v12
    v_add3_u32 v85, v13, v7, s59
    s_branch L_adone_42
L_ahi_41:
    v_add_u32 v8, 48, v5
    v_mul_u32_u24 v9, 21846, v8
    v_lshrrev_b32 v9, 16, v9
    v_mul_u32_u24 v10, 3, v9
    v_sub_u32 v10, v8, v10
    v_mul_u32_u24 v9, 20, v9
    v_add_u32 v9, v9, v6
    v_lshlrev_b32 v11, 2, v10
    v_cmp_eq_u32 vcc, 2, v10
    v_add_u32 v12, 8, v11
    v_lshlrev_b32 v13, 1, v11
    v_cndmask_b32 v11, v11, v13, vcc
    v_add_u32 v11, v11, v9
    v_add_u32 v12, v12, v9
    v_mul_u32_u24 v13, 160, v11
    v_add3_u32 v14, v13, v7, s59
    v_subrev_u32 v13, 54400, v13
    v_add_u32 v13, v13, v7
    v_cmp_gt_u32 vcc, 340, v11
    s_nop 1
    v_cndmask_b32 v86, v13, v14, vcc
    v_mul_u32_u24 v13, 160, v12
    v_add3_u32 v14, v13, v7, s59
    v_subrev_u32 v13, 54400, v13
    v_add_u32 v13, v13, v7
    v_cmp_gt_u32 vcc, 340, v12
    s_nop 1
    v_cndmask_b32 v87, v13, v14, vcc
    v_add_u32 v8, 52, v5
    v_mul_u32_u24 v9, 21846, v8
    v_lshrrev_b32 v9, 16, v9
    v_mul_u32_u24 v10, 3, v9
    v_sub_u32 v10, v8, v10
    v_mul_u32_u24 v9, 20, v9
    v_add_u32 v9, v9, v6
    v_lshlrev_b32 v11, 2, v10
    v_cmp_eq_u32 vcc, 2, v10
    v_add_u32 v12, 8, v11
    v_lshlrev_b32 v13, 1, v11
    v_cndmask_b32 v11, v11, v13, vcc
    v_add_u32 v11, v11, v9
    v_add_u32 v12, v12, v9
    v_subrev_u32 v13, 340, v11
    v_mul_u32_u24 v13, 160, v13
    v_add_u32 v80, v13, v7
    v_subrev_u32 v13, 340, v12
    v_mul_u32_u24 v13, 160, v13
    v_add_u32 v81, v13, v7
    v_add_u32 v8, 56, v5
    v_mul_u32_u24 v9, 21846, v8
    v_lshrrev_b32 v9, 16, v9
    v_mul_u32_u24 v10, 3, v9
    v_sub_u32 v10, v8, v10
    v_mul_u32_u24 v9, 20, v9
    v_add_u32 v9, v9, v6
    v_lshlrev_b32 v11, 2, v10
    v_cmp_eq_u32 vcc, 2, v10
    v_add_u32 v12, 8, v11
    v_lshlrev_b32 v13, 1, v11
    v_cndmask_b32 v11, v11, v13, vcc
    v_add_u32 v11, v11, v9
    v_add_u32 v12, v12, v9
    v_subrev_u32 v13, 340, v11
    v_mul_u32_u24 v13, 160, v13
    v_add_u32 v82, v13, v7
    v_subrev_u32 v13, 340, v12
    v_mul_u32_u24 v13, 160, v13
    v_add_u32 v83, v13, v7
    v_add_u32 v8, 60, v5
    v_mul_u32_u24 v9, 21846, v8
    v_lshrrev_b32 v9, 16, v9
    v_mul_u32_u24 v10, 3, v9
    v_sub_u32 v10, v8, v10
    v_mul_u32_u24 v9, 20, v9
    v_add_u32 v9, v9, v6
    v_lshlrev_b32 v11, 2, v10
    v_cmp_eq_u32 vcc, 2, v10
    v_add_u32 v12, 8, v11
    v_lshlrev_b32 v13, 1, v11
    v_cndmask_b32 v11, v11, v13, vcc
    v_add_u32 v11, v11, v9
    v_add_u32 v12, v12, v9
    v_subrev_u32 v13, 340, v11
    v_mul_u32_u24 v13, 160, v13
    v_add_u32 v84, v13, v7
    v_subrev_u32 v13, 340, v12
    v_mul_u32_u24 v13, 160, v13
    v_add_u32 v85, v13, v7
L_adone_42:
    s_mov_b32 s36, s22
    s_mov_b32 s37, s23
    s_mov_b32 s38, 0x500000
    s_mov_b32 s39, 0x00020000
    s_cmp_eq_u32 s40, 0
    s_cbranch_scc1 L_wb_47
    s_cmp_ge_u32 s40, 4
    s_cbranch_scc1 L_wb_47
    s_cmp_eq_u32 s40, 3
    s_cbranch_scc1 L_t3_48
    s_lshl_b32 s56, s2, 1
    s_sub_u32 s57, s40, 1
    s_add_u32 s56, s56, s57
    s_branch L_tgo_49
L_t3_48:
    s_cmp_ge_u32 s2, 128
    s_cbranch_scc1 L_wb_47
    s_add_u32 s56, s2, 512
L_tgo_49:
    v_lshlrev_b32 v48, 16, v132
    v_lshlrev_b32 v49, 16, v134
    v_lshlrev_b32 v50, 16, v148
    v_and_b32 v51, 0xffff0000, v148
    v_pk_mul_f32 v[48:49], v[48:49], v[50:51]
    v_cvt_pk_bf16_f32 v52, v48, v49
    v_lshlrev_b32 v48, 16, v136
    v_lshlrev_b32 v49, 16, v138
    v_lshlrev_b32 v50, 16, v149
    v_and_b32 v51, 0xffff0000, v149
    v_pk_mul_f32 v[48:49], v[48:49], v[50:51]
    v_cvt_pk_bf16_f32 v53, v48, v49
    v_lshlrev_b32 v48, 16, v140
    v_lshlrev_b32 v49, 16, v142
    v_lshlrev_b32 v50, 16, v150
    v_and_b32 v51, 0xffff0000, v150
    v_pk_mul_f32 v[48:49], v[48:49], v[50:51]
    v_cvt_pk_bf16_f32 v54, v48, v49
    v_lshlrev_b32 v48, 16, v144
    v_lshlrev_b32 v49, 16, v146
    v_lshlrev_b32 v50, 16, v151
    v_and_b32 v51, 0xffff0000, v151
    v_pk_mul_f32 v[48:49], v[48:49], v[50:51]
    v_cvt_pk_bf16_f32 v55, v48, v49
    s_mov_b32 s54, 0
    buffer_store_dwordx4 v[52:55], v164, s[36:39], s54 offen
    v_and_b32 v48, 0xffff0000, v132
    v_and_b32 v49, 0xffff0000, v134
    v_lshlrev_b32 v50, 16, v152
    v_and_b32 v51, 0xffff0000, v152
    v_pk_mul_f32 v[48:49], v[48:49], v[50:51]
    v_cvt_pk_bf16_f32 v56, v48, v49
    v_and_b32 v48, 0xffff0000, v136
    v_and_b32 v49, 0xffff0000, v138
    v_lshlrev_b32 v50, 16, v153
    v_and_b32 v51, 0xffff0000, v153
    v_pk_mul_f32 v[48:49], v[48:49], v[50:51]
    v_cvt_pk_bf16_f32 v57, v48, v49
    v_and_b32 v48, 0xffff0000, v140
    v_and_b32 v49, 0xffff0000, v142
    v_lshlrev_b32 v50, 16, v154
    v_and_b32 v51, 0xffff0000, v154
    v_pk_mul_f32 v[48:49], v[48:49], v[50:51]
    v_cvt_pk_bf16_f32 v58, v48, v49
    v_and_b32 v48, 0xffff0000, v144
    v_and_b32 v49, 0xffff0000, v146
    v_lshlrev_b32 v50, 16, v155
    v_and_b32 v51, 0xffff0000, v155
    v_pk_mul_f32 v[48:49], v[48:49], v[50:51]
    v_cvt_pk_bf16_f32 v59, v48, v49
    s_mov_b32 s54, 2560
    buffer_store_dwordx4 v[56:59], v164, s[36:39], s54 offen
    v_lshlrev_b32 v48, 16, v133
    v_lshlrev_b32 v49, 16, v135
    v_lshlrev_b32 v50, 16, v156
    v_and_b32 v51, 0xffff0000, v156
    v_pk_mul_f32 v[48:49], v[48:49], v[50:51]
    v_cvt_pk_bf16_f32 v60, v48, v49
    v_lshlrev_b32 v48, 16, v137
    v_lshlrev_b32 v49, 16, v139
    v_lshlrev_b32 v50, 16, v157
    v_and_b32 v51, 0xffff0000, v157
    v_pk_mul_f32 v[48:49], v[48:49], v[50:51]
    v_cvt_pk_bf16_f32 v61, v48, v49
    v_lshlrev_b32 v48, 16, v141
    v_lshlrev_b32 v49, 16, v143
    v_lshlrev_b32 v50, 16, v158
    v_and_b32 v51, 0xffff0000, v158
    v_pk_mul_f32 v[48:49], v[48:49], v[50:51]
    v_cvt_pk_bf16_f32 v62, v48, v49
    v_lshlrev_b32 v48, 16, v145
    v_lshlrev_b32 v49, 16, v147
    v_lshlrev_b32 v50, 16, v159
    v_and_b32 v51, 0xffff0000, v159
    v_pk_mul_f32 v[48:49], v[48:49], v[50:51]
    v_cvt_pk_bf16_f32 v63, v48, v49
    s_mov_b32 s54, 5120
    buffer_store_dwordx4 v[60:63], v164, s[36:39], s54 offen
    v_and_b32 v48, 0xffff0000, v133
    v_and_b32 v49, 0xffff0000, v135
    v_lshlrev_b32 v50, 16, v160
    v_and_b32 v51, 0xffff0000, v160
    v_pk_mul_f32 v[48:49], v[48:49], v[50:51]
    v_cvt_pk_bf16_f32 v64, v48, v49
    v_and_b32 v48, 0xffff0000, v137
    v_and_b32 v49, 0xffff0000, v139
    v_lshlrev_b32 v50, 16, v161
    v_and_b32 v51, 0xffff0000, v161
    v_pk_mul_f32 v[48:49], v[48:49], v[50:51]
    v_cvt_pk_bf16_f32 v65, v48, v49
    v_and_b32 v48, 0xffff0000, v141
    v_and_b32 v49, 0xffff0000, v143
    v_lshlrev_b32 v50, 16, v162
    v_and_b32 v51, 0xffff0000, v162
    v_pk_mul_f32 v[48:49], v[48:49], v[50:51]
    v_cvt_pk_bf16_f32 v66, v48, v49
    v_and_b32 v48, 0xffff0000, v145
    v_and_b32 v49, 0xffff0000, v147
    v_lshlrev_b32 v50, 16, v163
    v_and_b32 v51, 0xffff0000, v163
    v_pk_mul_f32 v[48:49], v[48:49], v[50:51]
    v_cvt_pk_bf16_f32 v67, v48, v49
    s_mov_b32 s54, 7680
    buffer_store_dwordx4 v[64:67], v164, s[36:39], s54 offen
L_wb_47:
    s_barrier
    s_cmp_ge_u32 s40, 4
    s_cbranch_scc1 L_p3hi_50
    ds_read_b64_tr_b16 v[116:117], v80 offset:0
    ds_read_b64_tr_b16 v[118:119], v81 offset:0
    ds_read_b64_tr_b16 v[120:121], v80 offset:32
    ds_read_b64_tr_b16 v[122:123], v81 offset:32
    ds_read_b64_tr_b16 v[124:125], v80 offset:64
    ds_read_b64_tr_b16 v[126:127], v81 offset:64
    ds_read_b64_tr_b16 v[128:129], v80 offset:96
    ds_read_b64_tr_b16 v[130:131], v81 offset:96
    ds_read_b64_tr_b16 v[132:133], v80 offset:128
    ds_read_b64_tr_b16 v[134:135], v81 offset:128
    s_waitcnt lgkmcnt(4)
    ds_read_b64_tr_b16 v[136:137], v82 offset:0
    ds_read_b64_tr_b16 v[138:139], v83 offset:0
    ds_read_b64_tr_b16 v[140:141], v82 offset:32
    ds_read_b64_tr_b16 v[142:143], v83 offset:32
    ds_read_b64_tr_b16 v[144:145], v82 offset:64
    ds_read_b64_tr_b16 v[146:147], v83 offset:64
    ds_read_b64_tr_b16 v[148:149], v82 offset:96
    ds_read_b64_tr_b16 v[150:151], v83 offset:96
    ds_read_b64_tr_b16 v[152:153], v82 offset:128
    ds_read_b64_tr_b16 v[154:155], v83 offset:128
    s_waitcnt lgkmcnt(4)
    ds_read_b64_tr_b16 v[48:49], v84 offset:0
    ds_read_b64_tr_b16 v[50:51], v85 offset:0
    ds_read_b64_tr_b16 v[52:53], v84 offset:32
    ds_read_b64_tr_b16 v[54:55], v85 offset:32
    ds_read_b64_tr_b16 v[56:57], v84 offset:64
    ds_read_b64_tr_b16 v[58:59], v85 offset:64
    ds_read_b64_tr_b16 v[60:61], v84 offset:96
    ds_read_b64_tr_b16 v[62:63], v85 offset:96
    ds_read_b64_tr_b16 v[64:65], v84 offset:128
    ds_read_b64_tr_b16 v[66:67], v85 offset:128
    s_waitcnt lgkmcnt(4)
    ds_read_b64_tr_b16 v[68:69], v80 offset:12800
    ds_read_b64_tr_b16 v[70:71], v81 offset:12800
    ds_read_b64_tr_b16 v[72:73], v80 offset:12832
    ds_read_b64_tr_b16 v[74:75], v81 offset:12832
    ds_read_b64_tr_b16 v[76:77], v80 offset:12864
    ds_read_b64_tr_b16 v[78:79], v81 offset:12864
    ds_read_b64_tr_b16 v[156:157], v80 offset:12896
    ds_read_b64_tr_b16 v[158:159], v81 offset:12896
    ds_read_b64_tr_b16 v[160:161], v80 offset:12928
    ds_read_b64_tr_b16 v[162:163], v81 offset:12928
    s_waitcnt lgkmcnt(4)
    s_cmp_eq_u32 s40, 0
    s_cbranch_scc0 L_np_51
    s_lshl_b32 s54, s41, 7
    s_add_u32 s54, s54, 18878464
    v_mov_b32 v2, s54
    v_cmp_eq_u32 vcc, 0, v0
    v_mov_b32 v3, 1
    s_nop 0
    v_cndmask_b32 v4, 0, v3, vcc
    v_cmp_ne_u32 vcc, 0, v4
    s_mov_b32 s66, 200000
    s_nop 1
    s_mov_b64 exec, vcc
L_poll_52:
    global_load_dword v3, v2, s[26:27] sc1
    s_waitcnt vmcnt(0)
    v_cmp_ge_u32 vcc, v3, v4
    s_nop 3
    s_cmp_eq_u64 vcc, exec
    s_cbranch_scc1 L_polld_53
    s_sleep 2
    s_sub_u32 s66, s66, 1
    s_cmp_lg_u32 s66, 0
    s_cbranch_scc1 L_poll_52
L_polld_53:
    s_mov_b64 exec, -1
L_np_51:
    s_waitcnt lgkmcnt(0)
    s_barrier
    s_add_u32 s58, s62, 0
    buffer_load_dwordx4 v[28:31], v88, s[28:31], s58 offen sc1
    s_add_u32 s58, s62, 0
    buffer_load_dwordx4 v[32:35], v89, s[28:31], s58 offen sc1
    s_add_u32 s58, s62, 0
    buffer_load_dwordx4 v[36:39], v90, s[28:31], s58 offen sc1
    s_add_u32 s58, s62, 393216
    buffer_load_dwordx4 v[40:43], v88, s[28:31], s58 offen sc1
    s_waitcnt vmcnt(3)
    s_add_u32 s58, s62, 393216
    buffer_load_dwordx4 v[44:47], v89, s[28:31], s58 offen sc1
    v_mfma_f32_16x16x32_bf16 v[96:99], v[116:119], v[28:31], 0
    ds_read_b64_tr_b16 v[116:117], v82 offset:12800
    ds_read_b64_tr_b16 v[118:119], v83 offset:12800
    v_mfma_f32_16x16x32_bf16 v[100:103], v[120:123], v[28:31], 0
    ds_read_b64_tr_b16 v[120:121], v82 offset:12832
    ds_read_b64_tr_b16 v[122:123], v83 offset:12832
    v_mfma_f32_16x16x32_bf16 v[104:107], v[124:127], v[28:31], 0
    ds_read_b64_tr_b16 v[124:125], v82 offset:12864
    ds_read_b64_tr_b16 v[126:127], v83 offset:12864
    v_mfma_f32_16x16x32_bf16 v[108:111], v[128:131], v[28:31], 0
    ds_read_b64_tr_b16 v[128:129], v82 offset:12896
    ds_read_b64_tr_b16 v[130:131], v83 offset:12896
    v_mfma_f32_16x16x32_bf16 v[112:115], v[132:135], v[28:31], 0
    ds_read_b64_tr_b16 v[132:133], v82 offset:12928
    ds_read_b64_tr_b16 v[134:135], v83 offset:12928
    s_waitcnt vmcnt(3)
    s_add_u32 s58, s62, 393216
    buffer_load_dwordx4 v[28:31], v90, s[28:31], s58 offen sc1
    v_mfma_f32_16x16x32_bf16 v[96:99], v[136:139], v[32:35], v[96:99]
    ds_read_b64_tr_b16 v[136:137], v84 offset:12800
    ds_read_b64_tr_b16 v[138:139], v85 offset:12800
    v_mfma_f32_16x16x32_bf16 v[100:103], v[140:143], v[32:35], v[100:103]
    ds_read_b64_tr_b16 v[140:141], v84 offset:12832
    ds_read_b64_tr_b16 v[142:143], v85 offset:12832
    v_mfma_f32_16x16x32_bf16 v[104:107], v[144:147], v[32:35], v[104:107]
    ds_read_b64_tr_b16 v[144:145], v84 offset:12864
    ds_read_b64_tr_b16 v[146:147], v85 offset:12864
    v_mfma_f32_16x16x32_bf16 v[108:111], v[148:151], v[32:35], v[108:111]
    ds_read_b64_tr_b16 v[148:149], v84 offset:12896
    ds_read_b64_tr_b16 v[150:151], v85 offset:12896
    v_mfma_f32_16x16x32_bf16 v[112:115], v[152:155], v[32:35], v[112:115]
    ds_read_b64_tr_b16 v[152:153], v84 offset:12928
    ds_read_b64_tr_b16 v[154:155], v85 offset:12928
    s_waitcnt vmcnt(3)
    s_add_u32 s58, s62, 786432
    buffer_load_dwordx4 v[32:35], v88, s[28:31], s58 offen sc1
    v_mfma_f32_16x16x32_bf16 v[96:99], v[48:51], v[36:39], v[96:99]
    ds_read_b64_tr_b16 v[48:49], v80 offset:25600
    ds_read_b64_tr_b16 v[50:51], v81 offset:25600
    v_mfma_f32_16x16x32_bf16 v[100:103], v[52:55], v[36:39], v[100:103]
    ds_read_b64_tr_b16 v[52:53], v80 offset:25632
    ds_read_b64_tr_b16 v[54:55], v81 offset:25632
    v_mfma_f32_16x16x32_bf16 v[104:107], v[56:59], v[36:39], v[104:107]
    ds_read_b64_tr_b16 v[56:57], v80 offset:25664
    ds_read_b64_tr_b16 v[58:59], v81 offset:25664
    v_mfma_f32_16x16x32_bf16 v[108:111], v[60:63], v[36:39], v[108:111]
    ds_read_b64_tr_b16 v[60:61], v80 offset:25696
    ds_read_b64_tr_b16 v[62:63], v81 offset:25696
    v_mfma_f32_16x16x32_bf16 v[112:115], v[64:67], v[36:39], v[112:115]
    ds_read_b64_tr_b16 v[64:65], v80 offset:25728
    ds_read_b64_tr_b16 v[66:67], v81 offset:25728
    s_waitcnt vmcnt(3)
    s_add_u32 s58, s62, 786432
    buffer_load_dwordx4 v[36:39], v89, s[28:31], s58 offen sc1
    v_mfma_f32_16x16x32_bf16 v[96:99], v[68:71], v[40:43], v[96:99]
    ds_read_b64_tr_b16 v[68:69], v82 offset:25600
    ds_read_b64_tr_b16 v[70:71], v83 offset:25600
    v_mfma_f32_16x16x32_bf16 v[100:103], v[72:75], v[40:43], v[100:103]
    ds_read_b64_tr_b16 v[72:73], v82 offset:25632
    ds_read_b64_tr_b16 v[74:75], v83 offset:25632
    v_mfma_f32_16x16x32_bf16 v[104:107], v[76:79], v[40:43], v[104:107]
    ds_read_b64_tr_b16 v[76:77], v82 offset:25664
    ds_read_b64_tr_b16 v[78:79], v83 offset:25664
    v_mfma_f32_16x16x32_bf16 v[108:111], v[156:159], v[40:43], v[108:111]
    ds_read_b64_tr_b16 v[156:157], v82 offset:25696
    ds_read_b64_tr_b16 v[158:159], v83 offset:25696
    v_mfma_f32_16x16x32_bf16 v[112:115], v[160:163], v[40:43], v[112:115]
    ds_read_b64_tr_b16 v[160:161], v82 offset:25728
    ds_read_b64_tr_b16 v[162:163], v83 offset:25728
    s_waitcnt vmcnt(3) lgkmcnt(10)
    s_add_u32 s58, s62, 786432
    buffer_load_dwordx4 v[40:43], v90, s[28:31], s58 offen sc1
    v_mfma_f32_16x16x32_bf16 v[96:99], v[116:119], v[44:47], v[96:99]
    ds_read_b64_tr_b16 v[116:117], v84 offset:25600
    ds_read_b64_tr_b16 v[118:119], v85 offset:25600
    v_mfma_f32_16x16x32_bf16 v[100:103], v[120:123], v[44:47], v[100:103]
    ds_read_b64_tr_b16 v[120:121], v84 offset:25632
    ds_read_b64_tr_b16 v[122:123], v85 offset:25632
    v_mfma_f32_16x16x32_bf16 v[104:107], v[124:127], v[44:47], v[104:107]
    ds_read_b64_tr_b16 v[124:125], v84 offset:25664
    ds_read_b64_tr_b16 v[126:127], v85 offset:25664
    v_mfma_f32_16x16x32_bf16 v[108:111], v[128:131], v[44:47], v[108:111]
    ds_read_b64_tr_b16 v[128:129], v84 offset:25696
    ds_read_b64_tr_b16 v[130:131], v85 offset:25696
    v_mfma_f32_16x16x32_bf16 v[112:115], v[132:135], v[44:47], v[112:115]
    ds_read_b64_tr_b16 v[132:133], v84 offset:25728
    ds_read_b64_tr_b16 v[134:135], v85 offset:25728
    s_waitcnt vmcnt(3) lgkmcnt(10)
    s_add_u32 s58, s62, 1179648
    buffer_load_dwordx4 v[44:47], v88, s[28:31], s58 offen sc1
    v_mfma_f32_16x16x32_bf16 v[96:99], v[136:139], v[28:31], v[96:99]
    ds_read_b64_tr_b16 v[136:137], v80 offset:38400
    ds_read_b64_tr_b16 v[138:139], v81 offset:38400
    v_mfma_f32_16x16x32_bf16 v[100:103], v[140:143], v[28:31], v[100:103]
    ds_read_b64_tr_b16 v[140:141], v80 offset:38432
    ds_read_b64_tr_b16 v[142:143], v81 offset:38432
    v_mfma_f32_16x16x32_bf16 v[104:107], v[144:147], v[28:31], v[104:107]
    ds_read_b64_tr_b16 v[144:145], v80 offset:38464
    ds_read_b64_tr_b16 v[146:147], v81 offset:38464
    v_mfma_f32_16x16x32_bf16 v[108:111], v[148:151], v[28:31], v[108:111]
    ds_read_b64_tr_b16 v[148:149], v80 offset:38496
    ds_read_b64_tr_b16 v[150:151], v81 offset:38496
    v_mfma_f32_16x16x32_bf16 v[112:115], v[152:155], v[28:31], v[112:115]
    ds_read_b64_tr_b16 v[152:153], v80 offset:38528
    ds_read_b64_tr_b16 v[154:155], v81 offset:38528
    s_waitcnt vmcnt(3) lgkmcnt(10)
    s_add_u32 s58, s62, 1179648
    buffer_load_dwordx4 v[28:31], v89, s[28:31], s58 offen sc1
    v_mfma_f32_16x16x32_bf16 v[96:99], v[48:51], v[32:35], v[96:99]
    ds_read_b64_tr_b16 v[48:49], v82 offset:38400
    ds_read_b64_tr_b16 v[50:51], v83 offset:38400
    v_mfma_f32_16x16x32_bf16 v[100:103], v[52:55], v[32:35], v[100:103]
    ds_read_b64_tr_b16 v[52:53], v82 offset:38432
    ds_read_b64_tr_b16 v[54:55], v83 offset:38432
    v_mfma_f32_16x16x32_bf16 v[104:107], v[56:59], v[32:35], v[104:107]
    ds_read_b64_tr_b16 v[56:57], v82 offset:38464
    ds_read_b64_tr_b16 v[58:59], v83 offset:38464
    v_mfma_f32_16x16x32_bf16 v[108:111], v[60:63], v[32:35], v[108:111]
    ds_read_b64_tr_b16 v[60:61], v82 offset:38496
    ds_read_b64_tr_b16 v[62:63], v83 offset:38496
    v_mfma_f32_16x16x32_bf16 v[112:115], v[64:67], v[32:35], v[112:115]
    ds_read_b64_tr_b16 v[64:65], v82 offset:38528
    ds_read_b64_tr_b16 v[66:67], v83 offset:38528
    s_waitcnt vmcnt(3) lgkmcnt(10)
    s_add_u32 s58, s62, 1179648
    buffer_load_dwordx4 v[32:35], v90, s[28:31], s58 offen sc1
    v_mfma_f32_16x16x32_bf16 v[96:99], v[68:71], v[36:39], v[96:99]
    ds_read_b64_tr_b16 v[68:69], v84 offset:38400
    ds_read_b64_tr_b16 v[70:71], v85 offset:38400
    v_mfma_f32_16x16x32_bf16 v[100:103], v[72:75], v[36:39], v[100:103]
    ds_read_b64_tr_b16 v[72:73], v84 offset:38432
    ds_read_b64_tr_b16 v[74:75], v85 offset:38432
    v_mfma_f32_16x16x32_bf16 v[104:107], v[76:79], v[36:39], v[104:107]
    ds_read_b64_tr_b16 v[76:77], v84 offset:38464
    ds_read_b64_tr_b16 v[78:79], v85 offset:38464
    v_mfma_f32_16x16x32_bf16 v[108:111], v[156:159], v[36:39], v[108:111]
    ds_read_b64_tr_b16 v[156:157], v84 offset:38496
    ds_read_b64_tr_b16 v[158:159], v85 offset:38496
    v_mfma_f32_16x16x32_bf16 v[112:115], v[160:163], v[36:39], v[112:115]
    ds_read_b64_tr_b16 v[160:161], v84 offset:38528
    ds_read_b64_tr_b16 v[162:163], v85 offset:38528
    s_waitcnt vmcnt(3) lgkmcnt(10)
    v_mfma_f32_16x16x32_bf16 v[96:99], v[116:119], v[40:43], v[96:99]
    v_mfma_f32_16x16x32_bf16 v[100:103], v[120:123], v[40:43], v[100:103]
    v_mfma_f32_16x16x32_bf16 v[104:107], v[124:127], v[40:43], v[104:107]
    v_mfma_f32_16x16x32_bf16 v[108:111], v[128:131], v[40:43], v[108:111]
    v_mfma_f32_16x16x32_bf16 v[112:115], v[132:135], v[40:43], v[112:115]
    s_waitcnt vmcnt(2) lgkmcnt(0)
    v_mfma_f32_16x16x32_bf16 v[96:99], v[136:139], v[44:47], v[96:99]
    v_mfma_f32_16x16x32_bf16 v[100:103], v[140:143], v[44:47], v[100:103]
    v_mfma_f32_16x16x32_bf16 v[104:107], v[144:147], v[44:47], v[104:107]
    v_mfma_f32_16x16x32_bf16 v[108:111], v[148:151], v[44:47], v[108:111]
    v_mfma_f32_16x16x32_bf16 v[112:115], v[152:155], v[44:47], v[112:115]
    s_waitcnt vmcnt(1) lgkmcnt(0)
    v_mfma_f32_16x16x32_bf16 v[96:99], v[48:51], v[28:31], v[96:99]
    v_mfma_f32_16x16x32_bf16 v[100:103], v[52:55], v[28:31], v[100:103]
    v_mfma_f32_16x16x32_bf16 v[104:107], v[56:59], v[28:31], v[104:107]
    v_mfma_f32_16x16x32_bf16 v[108:111], v[60:63], v[28:31], v[108:111]
    v_mfma_f32_16x16x32_bf16 v[112:115], v[64:67], v[28:31], v[112:115]
    s_waitcnt vmcnt(0) lgkmcnt(0)
    v_mfma_f32_16x16x32_bf16 v[96:99], v[68:71], v[32:35], v[96:99]
    v_mfma_f32_16x16x32_bf16 v[100:103], v[72:75], v[32:35], v[100:103]
    v_mfma_f32_16x16x32_bf16 v[104:107], v[76:79], v[32:35], v[104:107]
    v_mfma_f32_16x16x32_bf16 v[108:111], v[156:159], v[32:35], v[108:111]
    v_mfma_f32_16x16x32_bf16 v[112:115], v[160:163], v[32:35], v[112:115]
    s_nop 7
    s_barrier
    ds_read_b128 v[32:35], v92 offset:0
    ds_read_b128 v[36:39], v92 offset:1024
    ds_read_b128 v[40:43], v92 offset:2048
    ds_read_b128 v[44:47], v92 offset:3072
    ds_read_b128 v[48:51], v92 offset:4096
    s_waitcnt lgkmcnt(0)
    v_pk_add_f32 v[96:97], v[96:97], v[32:33]
    v_pk_add_f32 v[98:99], v[98:99], v[34:35]
    v_cvt_pk_bf16_f32 v96, v96, v97
    v_cvt_pk_bf16_f32 v97, v98, v99
    buffer_store_dwordx2 v[96:97], v91, s[36:39], 0 offen offset:0
    v_pk_add_f32 v[100:101], v[100:101], v[36:37]
    v_pk_add_f32 v[102:103], v[102:103], v[38:39]
    v_cvt_pk_bf16_f32 v100, v100, v101
    v_cvt_pk_bf16_f32 v101, v102, v103
    buffer_store_dwordx2 v[100:101], v91, s[36:39], 0 offen offset:32
    v_pk_add_f32 v[104:105], v[104:105], v[40:41]
    v_pk_add_f32 v[106:107], v[106:107], v[42:43]
    v_cvt_pk_bf16_f32 v104, v104, v105
    v_cvt_pk_bf16_f32 v105, v106, v107
    buffer_store_dwordx2 v[104:105], v91, s[36:39], 0 offen offset:64
    v_pk_add_f32 v[108:109], v[108:109], v[44:45]
    v_pk_add_f32 v[110:111], v[110:111], v[46:47]
    v_cvt_pk_bf16_f32 v108, v108, v109
    v_cvt_pk_bf16_f32 v109, v110, v111
    buffer_store_dwordx2 v[108:109], v91, s[36:39], 0 offen offset:96
    v_pk_add_f32 v[112:113], v[112:113], v[48:49]
    v_pk_add_f32 v[114:115], v[114:115], v[50:51]
    v_cvt_pk_bf16_f32 v112, v112, v113
    v_cvt_pk_bf16_f32 v113, v114, v115
    buffer_store_dwordx2 v[112:113], v91, s[36:39], 0 offen offset:128
    s_endpgm
L_p3hi_50:
    ds_read_b64_tr_b16 v[116:117], v86 offset:0
    ds_read_b64_tr_b16 v[118:119], v87 offset:0
    ds_read_b64_tr_b16 v[120:121], v86 offset:32
    ds_read_b64_tr_b16 v[122:123], v87 offset:32
    ds_read_b64_tr_b16 v[124:125], v86 offset:64
    ds_read_b64_tr_b16 v[126:127], v87 offset:64
    ds_read_b64_tr_b16 v[128:129], v86 offset:96
    ds_read_b64_tr_b16 v[130:131], v87 offset:96
    ds_read_b64_tr_b16 v[132:133], v86 offset:128
    ds_read_b64_tr_b16 v[134:135], v87 offset:128
    s_waitcnt lgkmcnt(4)
    ds_read_b64_tr_b16 v[136:137], v80 offset:0
    ds_read_b64_tr_b16 v[138:139], v81 offset:0
    ds_read_b64_tr_b16 v[140:141], v80 offset:32
    ds_read_b64_tr_b16 v[142:143], v81 offset:32
    ds_read_b64_tr_b16 v[144:145], v80 offset:64
    ds_read_b64_tr_b16 v[146:147], v81 offset:64
    ds_read_b64_tr_b16 v[148:149], v80 offset:96
    ds_read_b64_tr_b16 v[150:151], v81 offset:96
    ds_read_b64_tr_b16 v[152:153], v80 offset:128
    ds_read_b64_tr_b16 v[154:155], v81 offset:128
    s_waitcnt lgkmcnt(4)
    ds_read_b64_tr_b16 v[48:49], v82 offset:0
    ds_read_b64_tr_b16 v[50:51], v83 offset:0
    ds_read_b64_tr_b16 v[52:53], v82 offset:32
    ds_read_b64_tr_b16 v[54:55], v83 offset:32
    ds_read_b64_tr_b16 v[56:57], v82 offset:64
    ds_read_b64_tr_b16 v[58:59], v83 offset:64
    ds_read_b64_tr_b16 v[60:61], v82 offset:96
    ds_read_b64_tr_b16 v[62:63], v83 offset:96
    ds_read_b64_tr_b16 v[64:65], v82 offset:128
    ds_read_b64_tr_b16 v[66:67], v83 offset:128
    s_waitcnt lgkmcnt(4)
    ds_read_b64_tr_b16 v[68:69], v84 offset:0
    ds_read_b64_tr_b16 v[70:71], v85 offset:0
    ds_read_b64_tr_b16 v[72:73], v84 offset:32
    ds_read_b64_tr_b16 v[74:75], v85 offset:32
    ds_read_b64_tr_b16 v[76:77], v84 offset:64
    ds_read_b64_tr_b16 v[78:79], v85 offset:64
    ds_read_b64_tr_b16 v[156:157], v84 offset:96
    ds_read_b64_tr_b16 v[158:159], v85 offset:96
    ds_read_b64_tr_b16 v[160:161], v84 offset:128
    ds_read_b64_tr_b16 v[162:163], v85 offset:128
    s_waitcnt lgkmcnt(4)
    s_waitcnt lgkmcnt(0)
    s_barrier
    s_add_u32 s58, s62, 0
    buffer_load_dwordx4 v[28:31], v88, s[28:31], s58 offen sc1
    s_add_u32 s58, s62, 0
    buffer_load_dwordx4 v[32:35], v89, s[28:31], s58 offen sc1
    s_add_u32 s58, s62, 0
    buffer_load_dwordx4 v[36:39], v90, s[28:31], s58 offen sc1
    s_add_u32 s58, s62, 393216
    buffer_load_dwordx4 v[40:43], v88, s[28:31], s58 offen sc1
    s_waitcnt vmcnt(3)
    s_add_u32 s58, s62, 393216
    buffer_load_dwordx4 v[44:47], v89, s[28:31], s58 offen sc1
    v_mfma_f32_16x16x32_bf16 v[96:99], v[116:119], v[28:31], 0
    ds_read_b64_tr_b16 v[116:117], v80 offset:12800
    ds_read_b64_tr_b16 v[118:119], v81 offset:12800
    v_mfma_f32_16x16x32_bf16 v[100:103], v[120:123], v[28:31], 0
    ds_read_b64_tr_b16 v[120:121], v80 offset:12832
    ds_read_b64_tr_b16 v[122:123], v81 offset:12832
    v_mfma_f32_16x16x32_bf16 v[104:107], v[124:127], v[28:31], 0
    ds_read_b64_tr_b16 v[124:125], v80 offset:12864
    ds_read_b64_tr_b16 v[126:127], v81 offset:12864
    v_mfma_f32_16x16x32_bf16 v[108:111], v[128:131], v[28:31], 0
    ds_read_b64_tr_b16 v[128:129], v80 offset:12896
    ds_read_b64_tr_b16 v[130:131], v81 offset:12896
    v_mfma_f32_16x16x32_bf16 v[112:115], v[132:135], v[28:31], 0
    ds_read_b64_tr_b16 v[132:133], v80 offset:12928
    ds_read_b64_tr_b16 v[134:135], v81 offset:12928
    s_waitcnt vmcnt(3)
    s_add_u32 s58, s62, 393216
    buffer_load_dwordx4 v[28:31], v90, s[28:31], s58 offen sc1
    v_mfma_f32_16x16x32_bf16 v[96:99], v[136:139], v[32:35], v[96:99]
    ds_read_b64_tr_b16 v[136:137], v82 offset:12800
    ds_read_b64_tr_b16 v[138:139], v83 offset:12800
    v_mfma_f32_16x16x32_bf16 v[100:103], v[140:143], v[32:35], v[100:103]
    ds_read_b64_tr_b16 v[140:141], v82 offset:12832
    ds_read_b64_tr_b16 v[142:143], v83 offset:12832
    v_mfma_f32_16x16x32_bf16 v[104:107], v[144:147], v[32:35], v[104:107]
    ds_read_b64_tr_b16 v[144:145], v82 offset:12864
    ds_read_b64_tr_b16 v[146:147], v83 offset:12864
    v_mfma_f32_16x16x32_bf16 v[108:111], v[148:151], v[32:35], v[108:111]
    ds_read_b64_tr_b16 v[148:149], v82 offset:12896
    ds_read_b64_tr_b16 v[150:151], v83 offset:12896
    v_mfma_f32_16x16x32_bf16 v[112:115], v[152:155], v[32:35], v[112:115]
    ds_read_b64_tr_b16 v[152:153], v82 offset:12928
    ds_read_b64_tr_b16 v[154:155], v83 offset:12928
    s_waitcnt vmcnt(3)
    s_add_u32 s58, s62, 786432
    buffer_load_dwordx4 v[32:35], v88, s[28:31], s58 offen sc1
    v_mfma_f32_16x16x32_bf16 v[96:99], v[48:51], v[36:39], v[96:99]
    ds_read_b64_tr_b16 v[48:49], v84 offset:12800
    ds_read_b64_tr_b16 v[50:51], v85 offset:12800
    v_mfma_f32_16x16x32_bf16 v[100:103], v[52:55], v[36:39], v[100:103]
    ds_read_b64_tr_b16 v[52:53], v84 offset:12832
    ds_read_b64_tr_b16 v[54:55], v85 offset:12832
    v_mfma_f32_16x16x32_bf16 v[104:107], v[56:59], v[36:39], v[104:107]
    ds_read_b64_tr_b16 v[56:57], v84 offset:12864
    ds_read_b64_tr_b16 v[58:59], v85 offset:12864
    v_mfma_f32_16x16x32_bf16 v[108:111], v[60:63], v[36:39], v[108:111]
    ds_read_b64_tr_b16 v[60:61], v84 offset:12896
    ds_read_b64_tr_b16 v[62:63], v85 offset:12896
    v_mfma_f32_16x16x32_bf16 v[112:115], v[64:67], v[36:39], v[112:115]
    ds_read_b64_tr_b16 v[64:65], v84 offset:12928
    ds_read_b64_tr_b16 v[66:67], v85 offset:12928
    s_waitcnt vmcnt(3)
    s_add_u32 s58, s62, 786432
    buffer_load_dwordx4 v[36:39], v89, s[28:31], s58 offen sc1
    v_mfma_f32_16x16x32_bf16 v[96:99], v[68:71], v[40:43], v[96:99]
    ds_read_b64_tr_b16 v[68:69], v80 offset:25600
    ds_read_b64_tr_b16 v[70:71], v81 offset:25600
    v_mfma_f32_16x16x32_bf16 v[100:103], v[72:75], v[40:43], v[100:103]
    ds_read_b64_tr_b16 v[72:73], v80 offset:25632
    ds_read_b64_tr_b16 v[74:75], v81 offset:25632
    v_mfma_f32_16x16x32_bf16 v[104:107], v[76:79], v[40:43], v[104:107]
    ds_read_b64_tr_b16 v[76:77], v80 offset:25664
    ds_read_b64_tr_b16 v[78:79], v81 offset:25664
    v_mfma_f32_16x16x32_bf16 v[108:111], v[156:159], v[40:43], v[108:111]
    ds_read_b64_tr_b16 v[156:157], v80 offset:25696
    ds_read_b64_tr_b16 v[158:159], v81 offset:25696
    v_mfma_f32_16x16x32_bf16 v[112:115], v[160:163], v[40:43], v[112:115]
    ds_read_b64_tr_b16 v[160:161], v80 offset:25728
    ds_read_b64_tr_b16 v[162:163], v81 offset:25728
    s_waitcnt vmcnt(3) lgkmcnt(10)
    s_add_u32 s58, s62, 786432
    buffer_load_dwordx4 v[40:43], v90, s[28:31], s58 offen sc1
    v_mfma_f32_16x16x32_bf16 v[96:99], v[116:119], v[44:47], v[96:99]
    ds_read_b64_tr_b16 v[116:117], v82 offset:25600
    ds_read_b64_tr_b16 v[118:119], v83 offset:25600
    v_mfma_f32_16x16x32_bf16 v[100:103], v[120:123], v[44:47], v[100:103]
    ds_read_b64_tr_b16 v[120:121], v82 offset:25632
    ds_read_b64_tr_b16 v[122:123], v83 offset:25632
    v_mfma_f32_16x16x32_bf16 v[104:107], v[124:127], v[44:47], v[104:107]
    ds_read_b64_tr_b16 v[124:125], v82 offset:25664
    ds_read_b64_tr_b16 v[126:127], v83 offset:25664
    v_mfma_f32_16x16x32_bf16 v[108:111], v[128:131], v[44:47], v[108:111]
    ds_read_b64_tr_b16 v[128:129], v82 offset:25696
    ds_read_b64_tr_b16 v[130:131], v83 offset:25696
    v_mfma_f32_16x16x32_bf16 v[112:115], v[132:135], v[44:47], v[112:115]
    ds_read_b64_tr_b16 v[132:133], v82 offset:25728
    ds_read_b64_tr_b16 v[134:135], v83 offset:25728
    s_waitcnt vmcnt(3) lgkmcnt(10)
    s_add_u32 s58, s62, 1179648
    buffer_load_dwordx4 v[44:47], v88, s[28:31], s58 offen sc1
    v_mfma_f32_16x16x32_bf16 v[96:99], v[136:139], v[28:31], v[96:99]
    ds_read_b64_tr_b16 v[136:137], v84 offset:25600
    ds_read_b64_tr_b16 v[138:139], v85 offset:25600
    v_mfma_f32_16x16x32_bf16 v[100:103], v[140:143], v[28:31], v[100:103]
    ds_read_b64_tr_b16 v[140:141], v84 offset:25632
    ds_read_b64_tr_b16 v[142:143], v85 offset:25632
    v_mfma_f32_16x16x32_bf16 v[104:107], v[144:147], v[28:31], v[104:107]
    ds_read_b64_tr_b16 v[144:145], v84 offset:25664
    ds_read_b64_tr_b16 v[146:147], v85 offset:25664
    v_mfma_f32_16x16x32_bf16 v[108:111], v[148:151], v[28:31], v[108:111]
    ds_read_b64_tr_b16 v[148:149], v84 offset:25696
    ds_read_b64_tr_b16 v[150:151], v85 offset:25696
    v_mfma_f32_16x16x32_bf16 v[112:115], v[152:155], v[28:31], v[112:115]
    ds_read_b64_tr_b16 v[152:153], v84 offset:25728
    ds_read_b64_tr_b16 v[154:155], v85 offset:25728
    s_waitcnt vmcnt(3) lgkmcnt(10)
    s_add_u32 s58, s62, 1179648
    buffer_load_dwordx4 v[28:31], v89, s[28:31], s58 offen sc1
    v_mfma_f32_16x16x32_bf16 v[96:99], v[48:51], v[32:35], v[96:99]
    ds_read_b64_tr_b16 v[48:49], v80 offset:38400
    ds_read_b64_tr_b16 v[50:51], v81 offset:38400
    v_mfma_f32_16x16x32_bf16 v[100:103], v[52:55], v[32:35], v[100:103]
    ds_read_b64_tr_b16 v[52:53], v80 offset:38432
    ds_read_b64_tr_b16 v[54:55], v81 offset:38432
    v_mfma_f32_16x16x32_bf16 v[104:107], v[56:59], v[32:35], v[104:107]
    ds_read_b64_tr_b16 v[56:57], v80 offset:38464
    ds_read_b64_tr_b16 v[58:59], v81 offset:38464
    v_mfma_f32_16x16x32_bf16 v[108:111], v[60:63], v[32:35], v[108:111]
    ds_read_b64_tr_b16 v[60:61], v80 offset:38496
    ds_read_b64_tr_b16 v[62:63], v81 offset:38496
    v_mfma_f32_16x16x32_bf16 v[112:115], v[64:67], v[32:35], v[112:115]
    ds_read_b64_tr_b16 v[64:65], v80 offset:38528
    ds_read_b64_tr_b16 v[66:67], v81 offset:38528
    s_waitcnt vmcnt(3) lgkmcnt(10)
    s_add_u32 s58, s62, 1179648
    buffer_load_dwordx4 v[32:35], v90, s[28:31], s58 offen sc1
    v_mfma_f32_16x16x32_bf16 v[96:99], v[68:71], v[36:39], v[96:99]
    ds_read_b64_tr_b16 v[68:69], v82 offset:38400
    ds_read_b64_tr_b16 v[70:71], v83 offset:38400
    v_mfma_f32_16x16x32_bf16 v[100:103], v[72:75], v[36:39], v[100:103]
    ds_read_b64_tr_b16 v[72:73], v82 offset:38432
    ds_read_b64_tr_b16 v[74:75], v83 offset:38432
    v_mfma_f32_16x16x32_bf16 v[104:107], v[76:79], v[36:39], v[104:107]
    ds_read_b64_tr_b16 v[76:77], v82 offset:38464
    ds_read_b64_tr_b16 v[78:79], v83 offset:38464
    v_mfma_f32_16x16x32_bf16 v[108:111], v[156:159], v[36:39], v[108:111]
    ds_read_b64_tr_b16 v[156:157], v82 offset:38496
    ds_read_b64_tr_b16 v[158:159], v83 offset:38496
    v_mfma_f32_16x16x32_bf16 v[112:115], v[160:163], v[36:39], v[112:115]
    ds_read_b64_tr_b16 v[160:161], v82 offset:38528
    ds_read_b64_tr_b16 v[162:163], v83 offset:38528
    s_waitcnt vmcnt(3) lgkmcnt(10)
    v_mfma_f32_16x16x32_bf16 v[96:99], v[116:119], v[40:43], v[96:99]
    v_mfma_f32_16x16x32_bf16 v[100:103], v[120:123], v[40:43], v[100:103]
    v_mfma_f32_16x16x32_bf16 v[104:107], v[124:127], v[40:43], v[104:107]
    v_mfma_f32_16x16x32_bf16 v[108:111], v[128:131], v[40:43], v[108:111]
    v_mfma_f32_16x16x32_bf16 v[112:115], v[132:135], v[40:43], v[112:115]
    s_waitcnt vmcnt(2) lgkmcnt(0)
    v_mfma_f32_16x16x32_bf16 v[96:99], v[136:139], v[44:47], v[96:99]
    v_mfma_f32_16x16x32_bf16 v[100:103], v[140:143], v[44:47], v[100:103]
    v_mfma_f32_16x16x32_bf16 v[104:107], v[144:147], v[44:47], v[104:107]
    v_mfma_f32_16x16x32_bf16 v[108:111], v[148:151], v[44:47], v[108:111]
    v_mfma_f32_16x16x32_bf16 v[112:115], v[152:155], v[44:47], v[112:115]
    s_waitcnt vmcnt(1) lgkmcnt(0)
    v_mfma_f32_16x16x32_bf16 v[96:99], v[48:51], v[28:31], v[96:99]
    v_mfma_f32_16x16x32_bf16 v[100:103], v[52:55], v[28:31], v[100:103]
    v_mfma_f32_16x16x32_bf16 v[104:107], v[56:59], v[28:31], v[104:107]
    v_mfma_f32_16x16x32_bf16 v[108:111], v[60:63], v[28:31], v[108:111]
    v_mfma_f32_16x16x32_bf16 v[112:115], v[64:67], v[28:31], v[112:115]
    s_waitcnt vmcnt(0) lgkmcnt(0)
    v_mfma_f32_16x16x32_bf16 v[96:99], v[68:71], v[32:35], v[96:99]
    v_mfma_f32_16x16x32_bf16 v[100:103], v[72:75], v[32:35], v[100:103]
    v_mfma_f32_16x16x32_bf16 v[104:107], v[76:79], v[32:35], v[104:107]
    v_mfma_f32_16x16x32_bf16 v[108:111], v[156:159], v[32:35], v[108:111]
    v_mfma_f32_16x16x32_bf16 v[112:115], v[160:163], v[32:35], v[112:115]
    s_nop 7
    ds_write_b128 v92, v[96:99] offset:0
    ds_write_b128 v92, v[100:103] offset:1024
    ds_write_b128 v92, v[104:107] offset:2048
    ds_write_b128 v92, v[108:111] offset:3072
    ds_write_b128 v92, v[112:115] offset:4096
    s_waitcnt lgkmcnt(0)
    s_barrier
    s_endpgm
L_conv:
    s_cmp_eq_u32 s65, 0
    s_cbranch_scc1 L_uf_77
    s_waitcnt vmcnt(0)
    v_readfirstlane_b32 s66, v11
    s_nop 3
    s_cmp_lg_u32 s66, 31
    s_cbranch_scc1 L_uf_77
    v_add_u32 v10, 5120, v10
    v_mov_b32 v11, 1
    s_mov_b64 exec, 1
    global_store_dword v10, v11, s[26:27] sc1
    s_mov_b64 exec, -1
L_uf_77:
    s_lshr_b32 s59, s56, 1
    s_lshl_b32 s59, s59, 2
    s_load_dword s60, s[20:21], s59
    v_mov_b32 v12, 0
    v_mov_b32 v13, 0
    v_mov_b32 v14, 0
    v_mov_b32 v15, 0
    v_lshlrev_b32 v6, 3, v0
    v_add_u32 v6, s57, v6
    v_add_u32 v6, 16640, v6
    v_cmp_gt_u32 vcc, 60, v0
    s_and_saveexec_b64 s[54:55], vcc
    ds_write_b64 v6, v[12:13]
    s_mov_b64 exec, s[54:55]
    v_and_b32 v6, 1, v0
    v_lshlrev_b32 v6, 4, v6
    v_lshrrev_b32 v7, 1, v0
    v_mul_u32_u24 v7, 4160, v7
    v_add3_u32 v6, v6, v7, s57
    v_cmp_gt_u32 vcc, 8, v0
    s_and_saveexec_b64 s[54:55], vcc
    ds_write_b128 v6, v[12:15]
    s_mov_b64 exec, s[54:55]
    s_waitcnt vmcnt(0)
    v_cmp_eq_u32 vcc, 0, v0
    v_lshlrev_b32 v6, 4, v0
    v_add_u32 v6, s57, v6
    v_add_u32 v6, 32, v6
    v_cndmask_b32 v136, v136, 0, vcc
    v_cndmask_b32 v137, v137, 0, vcc
    ds_write_b128 v6, v[138:141] offset:0
    v_alignbit_b32 v16, v138, v137, 16
    v_alignbit_b32 v17, v139, v138, 16
    v_alignbit_b32 v18, v140, v139, 16
    v_alignbit_b32 v19, v141, v140, 16
    v_mov_b32 v20, v137
    v_mov_b32 v21, v138
    v_mov_b32 v22, v139
    v_mov_b32 v23, v140
    v_alignbit_b32 v24, v137, v136, 16
    v_mov_b32 v25, v16
    v_mov_b32 v26, v17
    v_mov_b32 v27, v18
    ds_write_b128 v6, v[16:19] offset:4160
    ds_write_b128 v6, v[20:23] offset:8320
    ds_write_b128 v6, v[24:27] offset:12480
    ds_write_b128 v6, v[144:147] offset:1024
    v_alignbit_b32 v28, v144, v143, 16
    v_alignbit_b32 v29, v145, v144, 16
    v_alignbit_b32 v30, v146, v145, 16
    v_alignbit_b32 v31, v147, v146, 16
    v_mov_b32 v32, v143
    v_mov_b32 v33, v144
    v_mov_b32 v34, v145
    v_mov_b32 v35, v146
    v_alignbit_b32 v36, v143, v142, 16
    v_mov_b32 v37, v28
    v_mov_b32 v38, v29
    v_mov_b32 v39, v30
    ds_write_b128 v6, v[28:31] offset:5184
    ds_write_b128 v6, v[32:35] offset:9344
    ds_write_b128 v6, v[36:39] offset:13504
    ds_write_b128 v6, v[150:153] offset:2048
    v_alignbit_b32 v16, v150, v149, 16
    v_alignbit_b32 v17, v151, v150, 16
    v_alignbit_b32 v18, v152, v151, 16
    v_alignbit_b32 v19, v153, v152, 16
    v_mov_b32 v20, v149
    v_mov_b32 v21, v150
    v_mov_b32 v22, v151
    v_mov_b32 v23, v152
    v_alignbit_b32 v24, v149, v148, 16
    v_mov_b32 v25, v16
    v_mov_b32 v26, v17
    v_mov_b32 v27, v18
    ds_write_b128 v6, v[16:19] offset:6208
    ds_write_b128 v6, v[20:23] offset:10368
    ds_write_b128 v6, v[24:27] offset:14528
    ds_write_b128 v6, v[156:159] offset:3072
    v_alignbit_b32 v28, v156, v155, 16
    v_alignbit_b32 v29, v157, v156, 16
    v_alignbit_b32 v30, v158, v157, 16
    v_alignbit_b32 v31, v159, v158, 16
    v_mov_b32 v32, v155
    v_mov_b32 v33, v156
    v_mov_b32 v34, v157
    v_mov_b32 v35, v158
    v_alignbit_b32 v36, v155, v154, 16
    v_mov_b32 v37, v28
    v_mov_b32 v38, v29
    v_mov_b32 v39, v30
    ds_write_b128 v6, v[28:31] offset:7232
    ds_write_b128 v6, v[32:35] offset:11392
    ds_write_b128 v6, v[36:39] offset:15552
    s_lshl_b32 s43, s41, 2
    s_lshr_b32 s44, s42, 3
    s_add_u32 s43, s43, s44
    s_and_b32 s44, s42, 7
    s_lshl_b32 s46, s44, 3
    s_add_u32 s46, s46, s40
    s_mov_b32 s47, 0x60060
    s_cmp_eq_u32 s43, 1
    s_cmov_b32 s47, 0x60808
    s_cmp_eq_u32 s43, 2
    s_cmov_b32 s47, 0xe1068
    s_cmp_eq_u32 s43, 3
    s_cmov_b32 s47, 0xe1828
    s_cmp_eq_u32 s43, 4
    s_cmov_b32 s47, 0x162070
    s_cmp_eq_u32 s43, 5
    s_cmov_b32 s47, 0x162848
    s_cmp_eq_u32 s43, 6
    s_cmov_b32 s47, 0x640f8
    s_cmp_eq_u32 s43, 7
    s_cmov_b32 s47, 0x64889
    s_cmp_eq_u32 s43, 8
    s_cmov_b32 s47, 0xe50e1
    s_cmp_eq_u32 s43, 9
    s_cmov_b32 s47, 0xe58a9
    s_cmp_eq_u32 s43, 10
    s_cmov_b32 s47, 0x1660e9
    s_cmp_eq_u32 s43, 11
    s_cmov_b32 s47, 0x1668c9
    s_cmp_eq_u32 s43, 12
    s_cmov_b32 s47, 0x6bcf1
    s_cmp_eq_u32 s43, 13
    s_cmov_b32 s47, 0x68502
    s_cmp_eq_u32 s43, 14
    s_cmov_b32 s47, 0xe9112
    s_cmp_eq_u32 s43, 15
    s_cmov_b32 s47, 0xe992a
    s_cmp_eq_u32 s43, 16
    s_cmov_b32 s47, 0x16a162
    s_cmp_eq_u32 s43, 17
    s_cmov_b32 s47, 0x16a94a
    s_cmp_eq_u32 s43, 18
    s_cmov_b32 s47, 0x1eb96a
    s_cmp_eq_u32 s43, 19
    s_cmov_b32 s47, 0x1ea1a3
    s_cmp_eq_u32 s43, 20
    s_cmov_b32 s47, 0x6c1e3
    s_cmp_eq_u32 s43, 21
    s_cmov_b32 s47, 0x6c98b
    s_cmp_eq_u32 s43, 22
    s_cmov_b32 s47, 0xee5eb
    s_cmp_eq_u32 s43, 23
    s_cmov_b32 s47, 0xed9ab
    s_cmp_eq_u32 s43, 24
    s_cmov_b32 s47, 0x16fdf3
    s_cmp_eq_u32 s43, 25
    s_cmov_b32 s47, 0x16e253
    s_cmp_eq_u32 s43, 26
    s_cmov_b32 s47, 0x70264
    s_cmp_eq_u32 s43, 27
    s_cmov_b32 s47, 0x70a0c
    s_cmp_eq_u32 s43, 28
    s_cmov_b32 s47, 0xf126c
    s_cmp_eq_u32 s43, 29
    s_cmov_b32 s47, 0xf1a2c
    s_cmp_eq_u32 s43, 30
    s_cmov_b32 s47, 0x173e74
    s_cmp_eq_u32 s43, 31
    s_cmov_b32 s47, 0x172a4c
    s_bfe_u32 s54, s47, 0x30000
    s_bfe_u32 s55, s47, 0x40003
    s_mul_i32 s54, s54, 532480
    s_lshl_b32 s55, s55, 9
    s_add_u32 s50, s54, s55
    s_bfe_u32 s54, s47, 0x30007
    s_bfe_u32 s55, s47, 0x4000a
    s_mul_i32 s54, s54, 532480
    s_lshl_b32 s55, s55, 9
    s_add_u32 s51, s54, s55
    s_bfe_u32 s54, s47, 0x3000e
    s_bfe_u32 s55, s47, 0x40011
    s_mul_i32 s54, s54, 532480
    s_lshl_b32 s55, s55, 9
    s_add_u32 s52, s54, s55
    v_and_b32 v3, 31, v0
    v_lshrrev_b32 v12, 5, v0
    v_lshlrev_b32 v13, 4, v3
    v_cmp_eq_u32 vcc, 0, v12
    v_mov_b32 v14, s50
    v_mov_b32 v15, s51
    v_cndmask_b32 v14, v15, v14, vcc
    v_add_u32 v40, v14, v13
    s_and_b32 s54, s43, 1
    s_lshl_b32 s54, s54, 3
    s_add_u32 s54, s54, s52
    v_add_u32 v41, s54, v13
    v_add_u32 v160, 2679040, v40
    s_mul_i32 s53, s43, 20
    s_add_u32 s45, s53, 19
    s_lshr_b32 s45, s45, 7
    s_add_u32 s45, s45, 10
    s_mul_i32 s45, s45, 532480
    s_add_u32 s45, s45, 8192
    v_cmp_gt_u32 vcc, 56, v0
    v_subrev_u32 v8, 32, v0
    v_subrev_u32 v9, 56, v0
    v_cndmask_b32 v8, v9, v8, vcc
    v_mov_b32 v9, 1
    v_mov_b32 v10, 0
    v_cndmask_b32 v9, v9, v10, vcc
    v_add_u32 v5, s53, v8
    v_lshrrev_b32 v6, 7, v5
    v_add_u32 v6, 10, v6
    v_mul_u32_u24 v6, 8320, v6
    v_lshlrev_b32 v6, 6, v6
    v_bfe_u32 v7, v5, 5, 2
    v_lshlrev_b32 v7, 10, v7
    v_add_u32 v6, v6, v7
    v_and_b32 v7, 31, v5
    v_lshl_add_u32 v6, v7, 4, v6
    v_lshrrev_b32 v7, 1, v9
    v_lshl_add_u32 v6, v7, 12, v6
    v_and_b32 v7, 1, v9
    v_lshl_add_u32 v6, v7, 9, v6
    v_subrev_u32 v7, 20, v8
    v_and_b32 v7, 3, v7
    v_lshlrev_b32 v7, 4, v7
    v_add_u32 v7, s45, v7
    v_cmp_gt_u32 vcc, 20, v8
    s_nop 1
    v_cndmask_b32 v11, v7, v6, vcc
    v_add_u32 v6, s52, v13
    v_add_u32 v6, 2679040, v6
    v_cmp_gt_u32 vcc, 32, v0
    s_nop 1
    v_cndmask_b32 v161, v11, v6, vcc
    v_cmp_gt_u32 vcc, 16, v0
    v_cmp_gt_u32 s[54:55], 40, v0
    v_subrev_u32 v8, 40, v0
    v_subrev_u32 v10, 16, v0
    v_cndmask_b32 v8, v8, v10, s[54:55]
    v_add_u32 v10, 8, v0
    v_cndmask_b32 v8, v8, v10, vcc
    v_mov_b32 v9, 3
    v_mov_b32 v10, 2
    v_cndmask_b32 v9, v9, v10, s[54:55]
    v_mov_b32 v10, 1
    v_cndmask_b32 v9, v9, v10, vcc
    v_add_u32 v5, s53, v8
    v_lshrrev_b32 v6, 7, v5
    v_add_u32 v6, 10, v6
    v_mul_u32_u24 v6, 8320, v6
    v_lshlrev_b32 v6, 6, v6
    v_bfe_u32 v7, v5, 5, 2
    v_lshlrev_b32 v7, 10, v7
    v_add_u32 v6, v6, v7
    v_and_b32 v7, 31, v5
    v_lshl_add_u32 v6, v7, 4, v6
    v_lshrrev_b32 v7, 1, v9
    v_lshl_add_u32 v6, v7, 12, v6
    v_and_b32 v7, 1, v9
    v_lshl_add_u32 v6, v7, 9, v6
    v_subrev_u32 v7, 20, v8
    v_and_b32 v7, 3, v7
    v_lshlrev_b32 v7, 4, v7
    v_add_u32 v7, s45, v7
    v_cmp_gt_u32 vcc, 20, v8
    s_nop 1
    v_cndmask_b32 v162, v7, v6, vcc
    v_mov_b32 v8, v3
    v_mov_b32 v9, v12
    v_add_u32 v5, s53, v8
    v_lshrrev_b32 v6, 7, v5
    v_add_u32 v6, 10, v6
    v_mul_u32_u24 v6, 8320, v6
    v_lshlrev_b32 v6, 6, v6
    v_bfe_u32 v7, v5, 5, 2
    v_lshlrev_b32 v7, 10, v7
    v_add_u32 v6, v6, v7
    v_and_b32 v7, 31, v5
    v_lshl_add_u32 v6, v7, 4, v6
    v_lshrrev_b32 v7, 1, v9
    v_lshl_add_u32 v6, v7, 12, v6
    v_and_b32 v7, 1, v9
    v_lshl_add_u32 v6, v7, 9, v6
    v_subrev_u32 v7, 20, v8
    v_and_b32 v7, 3, v7
    v_lshlrev_b32 v7, 4, v7
    v_add_u32 v7, s45, v7
    v_cmp_gt_u32 vcc, 20, v8
    s_nop 1
    v_cndmask_b32 v42, v7, v6, vcc
    s_mov_b32 s32, s8
    s_mov_b32 s33, s9
    s_mov_b32 s34, 0xc8000
    s_mov_b32 s35, 0x00020000
    s_and_b32 s52, s42, 7
    s_mul_i32 s52, s52, 160
    v_add_u32 v5, 0, v0
    v_mul_u32_u24 v6, 52429, v5
    v_lshrrev_b32 v6, 19, v6
    v_mul_u32_u24 v7, 10, v6
    v_sub_u32 v7, v5, v7
    v_mul_u32_u24 v6, 1280, v6
    v_lshl_add_u32 v6, v7, 4, v6
    v_add_u32 v163, s52, v6
    v_add_u32 v5, 64, v0
    v_mul_u32_u24 v6, 52429, v5
    v_lshrrev_b32 v6, 19, v6
    v_mul_u32_u24 v7, 10, v6
    v_sub_u32 v7, v5, v7
    v_mul_u32_u24 v6, 1280, v6
    v_lshl_add_u32 v6, v7, 4, v6
    v_add_u32 v164, s52, v6
    v_add_u32 v5, 128, v0
    v_mul_u32_u24 v6, 52429, v5
    v_lshrrev_b32 v6, 19, v6
    v_mul_u32_u24 v7, 10, v6
    v_sub_u32 v7, v5, v7
    v_mul_u32_u24 v6, 1280, v6
    v_lshl_add_u32 v6, v7, 4, v6
    v_add_u32 v165, s52, v6
    v_add_u32 v5, 192, v0
    v_mul_u32_u24 v6, 52429, v5
    v_lshrrev_b32 v6, 19, v6
    v_mul_u32_u24 v7, 10, v6
    v_sub_u32 v7, v5, v7
    v_mul_u32_u24 v6, 1280, v6
    v_lshl_add_u32 v6, v7, 4, v6
    v_add_u32 v166, s52, v6
    v_add_u32 v5, 256, v0
    v_mul_u32_u24 v6, 52429, v5
    v_lshrrev_b32 v6, 19, v6
    v_mul_u32_u24 v7, 10, v6
    v_sub_u32 v7, v5, v7
    v_mul_u32_u24 v6, 1280, v6
    v_lshl_add_u32 v6, v7, 4, v6
    v_add_u32 v167, s52, v6
    s_lshr_b32 s54, s56, 6
    s_and_b32 s55, s56, 63
    s_and_b32 s61, s55, 7
    s_lshr_b32 s55, s55, 3
    s_lshl_b32 s61, s61, 9
    s_lshl_b32 s55, s55, 6
    s_add_u32 s61, s61, s55
    s_lshl_b32 s54, s54, 12
    s_add_u32 s61, s61, s54
    s_add_u32 s61, s61, 8388608
    v_lshrrev_b32 v8, 2, v0
    v_mul_u32_u24 v8, 40960, v8
    v_and_b32 v9, 3, v0
    v_lshl_add_u32 v8, v9, 4, v8
    s_cmp_lg_u32 s40, 8
    s_cbranch_scc1 L_uw_78
    v_lshlrev_b32 v2, 7, v0
    v_add_u32 v2, 18879488, v2
    v_cmp_gt_u32 vcc, 8, v0
    v_mov_b32 v3, 1
    s_nop 0
    v_cndmask_b32 v4, 0, v3, vcc
    v_cmp_ne_u32 vcc, 0, v4
    s_mov_b32 s66, 200000
    s_nop 1
    s_mov_b64 exec, vcc
L_poll_80:
    global_load_dword v3, v2, s[26:27] sc1
    s_waitcnt vmcnt(0)
    v_cmp_ge_u32 vcc, v3, v4
    s_nop 3
    s_cmp_eq_u64 vcc, exec
    s_cbranch_scc1 L_polld_81
    s_sleep 6
    s_sub_u32 s66, s66, 1
    s_cmp_lg_u32 s66, 0
    s_cbranch_scc1 L_poll_80
L_polld_81:
    s_mov_b64 exec, -1
    v_mov_b32 v2, 162064
    v_mov_b32 v3, 1
    ds_write_b32 v2, v3
    s_branch L_ud_79
L_uw_78:
    v_mov_b32 v2, 162064
    s_mov_b32 s66, 3200000
L_lw_82:
    ds_read_b32 v3, v2
    s_waitcnt lgkmcnt(0)
    v_readfirstlane_b32 s67, v3
    s_nop 3
    s_cmp_ge_u32 s67, 1
    s_cbranch_scc1 L_lwd_83
    s_sleep 1
    s_sub_u32 s66, s66, 1
    s_cmp_lg_u32 s66, 0
    s_cbranch_scc1 L_lw_82
L_lwd_83:
    s_waitcnt vmcnt(0)
L_ud_79:
    s_add_u32 m0, s57, 17120
    s_add_u32 s54, s61, 0
    buffer_load_dwordx4 v8, s[28:31], s54 offen sc1 lds
    s_add_u32 m0, s57, 18144
    s_add_u32 s54, s61, 655360
    buffer_load_dwordx4 v8, s[28:31], s54 offen sc1 lds
    s_add_u32 m0, s57, 19168
    s_add_u32 s54, s61, 1310720
    buffer_load_dwordx4 v8, s[28:31], s54 offen sc1 lds
    s_add_u32 m0, s57, 20192
    s_add_u32 s54, s61, 1966080
    buffer_load_dwordx4 v8, s[28:31], s54 offen sc1 lds
    v_lshrrev_b32 v6, 4, v0
    v_bfe_u32 v7, v0, 2, 2
    v_and_b32 v8, 3, v0
    v_mul_u32_u24 v7, 4160, v7
    v_lshlrev_b32 v8, 3, v8
    v_lshlrev_b32 v9, 4, v6
    v_sub_u32 v8, v8, v9
    v_add_u32 v8, 56, v8
    v_add3_u32 v4, v7, v8, s57
    v_and_b32 v7, 15, v0
    v_lshlrev_b32 v7, 5, v7
    v_lshl_add_u32 v7, v6, 4, v7
    v_add_u32 v7, 16640, v7
    v_add_u32 v5, s57, v7
    s_waitcnt vmcnt(0) lgkmcnt(0)
    s_and_b32 s54, s56, 1
    s_lshl_b32 s54, s54, 4
    s_lshr_b32 s60, s60, s54
    s_lshl_b32 s60, s60, 16
    s_setprio 0
    ds_read_b128 v[156:159], v5 offset:4032
    ds_read_b128 v[152:155], v5 offset:3520
    ds_read_b128 v[148:151], v5 offset:3008
    ds_read_b128 v[144:147], v5 offset:2496
    ds_read_b128 v[140:143], v5 offset:1984
    ds_read_b128 v[136:139], v5 offset:1472
    ds_read_b128 v[132:135], v5 offset:960
    ds_read_b128 v[128:131], v5 offset:448
    s_waitcnt lgkmcnt(4)
    ds_read_b64_tr_b16 v[64:65], v4 offset:8
    ds_read_b64_tr_b16 v[66:67], v4 offset:0
    ds_read_b64_tr_b16 v[68:69], v4 offset:520
    ds_read_b64_tr_b16 v[70:71], v4 offset:512
    ds_read_b64_tr_b16 v[72:73], v4 offset:1032
    ds_read_b64_tr_b16 v[74:75], v4 offset:1024
    ds_read_b64_tr_b16 v[76:77], v4 offset:1544
    ds_read_b64_tr_b16 v[78:79], v4 offset:1536
    s_waitcnt lgkmcnt(4)
    ds_read_b64_tr_b16 v[80:81], v4 offset:2056
    ds_read_b64_tr_b16 v[82:83], v4 offset:2048
    ds_read_b64_tr_b16 v[84:85], v4 offset:2568
    ds_read_b64_tr_b16 v[86:87], v4 offset:2560
    ds_read_b64_tr_b16 v[88:89], v4 offset:3080
    ds_read_b64_tr_b16 v[90:91], v4 offset:3072
    ds_read_b64_tr_b16 v[92:93], v4 offset:3592
    ds_read_b64_tr_b16 v[94:95], v4 offset:3584
    s_waitcnt lgkmcnt(0)
    v_mfma_f32_16x16x32_bf16 v[60:63], v[64:67], v[156:159], 0
    ds_read_b64_tr_b16 v[96:97], v4 offset:72
    v_mfma_f32_16x16x32_bf16 v[56:59], v[64:67], v[152:155], 0
    ds_read_b64_tr_b16 v[98:99], v4 offset:64
    v_mfma_f32_16x16x32_bf16 v[52:55], v[64:67], v[148:151], 0
    ds_read_b64_tr_b16 v[100:101], v4 offset:584
    v_mfma_f32_16x16x32_bf16 v[48:51], v[64:67], v[144:147], 0
    ds_read_b64_tr_b16 v[102:103], v4 offset:576
    v_mfma_f32_16x16x32_bf16 v[44:47], v[64:67], v[140:143], 0
    ds_read_b64_tr_b16 v[104:105], v4 offset:1096
    v_mfma_f32_16x16x32_bf16 v[40:43], v[64:67], v[136:139], 0
    ds_read_b64_tr_b16 v[106:107], v4 offset:1088
    v_mfma_f32_16x16x32_bf16 v[36:39], v[64:67], v[132:135], 0
    ds_read_b64_tr_b16 v[108:109], v4 offset:1608
    v_mfma_f32_16x16x32_bf16 v[32:35], v[64:67], v[128:131], 0
    ds_read_b64_tr_b16 v[110:111], v4 offset:1600
    ds_read_b128 v[156:159], v5 offset:3968
    v_mfma_f32_16x16x32_bf16 v[60:63], v[68:71], v[152:155], v[60:63]
    ds_read_b64_tr_b16 v[112:113], v4 offset:2120
    v_mfma_f32_16x16x32_bf16 v[56:59], v[68:71], v[148:151], v[56:59]
    ds_read_b64_tr_b16 v[114:115], v4 offset:2112
    v_mfma_f32_16x16x32_bf16 v[52:55], v[68:71], v[144:147], v[52:55]
    ds_read_b64_tr_b16 v[116:117], v4 offset:2632
    v_mfma_f32_16x16x32_bf16 v[48:51], v[68:71], v[140:143], v[48:51]
    ds_read_b64_tr_b16 v[118:119], v4 offset:2624
    v_mfma_f32_16x16x32_bf16 v[44:47], v[68:71], v[136:139], v[44:47]
    ds_read_b64_tr_b16 v[120:121], v4 offset:3144
    v_mfma_f32_16x16x32_bf16 v[40:43], v[68:71], v[132:135], v[40:43]
    ds_read_b64_tr_b16 v[122:123], v4 offset:3136
    v_mfma_f32_16x16x32_bf16 v[36:39], v[68:71], v[128:131], v[36:39]
    ds_read_b64_tr_b16 v[124:125], v4 offset:3656
    ds_read_b128 v[152:155], v5 offset:3456
    v_mfma_f32_16x16x32_bf16 v[60:63], v[72:75], v[148:151], v[60:63]
    ds_read_b64_tr_b16 v[126:127], v4 offset:3648
    v_mfma_f32_16x16x32_bf16 v[56:59], v[72:75], v[144:147], v[56:59]
    v_mfma_f32_16x16x32_bf16 v[52:55], v[72:75], v[140:143], v[52:55]
    v_mfma_f32_16x16x32_bf16 v[48:51], v[72:75], v[136:139], v[48:51]
    v_mfma_f32_16x16x32_bf16 v[44:47], v[72:75], v[132:135], v[44:47]
    v_mfma_f32_16x16x32_bf16 v[40:43], v[72:75], v[128:131], v[40:43]
    ds_read_b128 v[148:151], v5 offset:2944
    v_mfma_f32_16x16x32_bf16 v[60:63], v[76:79], v[144:147], v[60:63]
    v_mfma_f32_16x16x32_bf16 v[56:59], v[76:79], v[140:143], v[56:59]
    v_mfma_f32_16x16x32_bf16 v[52:55], v[76:79], v[136:139], v[52:55]
    v_mfma_f32_16x16x32_bf16 v[48:51], v[76:79], v[132:135], v[48:51]
    v_mfma_f32_16x16x32_bf16 v[44:47], v[76:79], v[128:131], v[44:47]
    ds_read_b128 v[144:147], v5 offset:2432
    v_mfma_f32_16x16x32_bf16 v[60:63], v[80:83], v[140:143], v[60:63]
    v_mfma_f32_16x16x32_bf16 v[56:59], v[80:83], v[136:139], v[56:59]
    v_mfma_f32_16x16x32_bf16 v[52:55], v[80:83], v[132:135], v[52:55]
    v_mfma_f32_16x16x32_bf16 v[48:51], v[80:83], v[128:131], v[48:51]
    ds_read_b128 v[140:143], v5 offset:1920
    v_mfma_f32_16x16x32_bf16 v[60:63], v[84:87], v[136:139], v[60:63]
    v_mfma_f32_16x16x32_bf16 v[56:59], v[84:87], v[132:135], v[56:59]
    v_mfma_f32_16x16x32_bf16 v[52:55], v[84:87], v[128:131], v[52:55]
    ds_read_b128 v[136:139], v5 offset:1408
    v_mfma_f32_16x16x32_bf16 v[60:63], v[88:91], v[132:135], v[60:63]
    v_mfma_f32_16x16x32_bf16 v[56:59], v[88:91], v[128:131], v[56:59]
    ds_read_b128 v[132:135], v5 offset:896
    v_mfma_f32_16x16x32_bf16 v[60:63], v[92:95], v[128:131], v[60:63]
    ds_read_b128 v[128:131], v5 offset:384
    s_waitcnt lgkmcnt(4)
    v_mfma_f32_16x16x32_bf16 v[60:63], v[96:99], v[156:159], v[60:63]
    ds_read_b64_tr_b16 v[64:65], v4 offset:136
    v_mfma_f32_16x16x32_bf16 v[56:59], v[96:99], v[152:155], v[56:59]
    ds_read_b64_tr_b16 v[66:67], v4 offset:128
    v_mfma_f32_16x16x32_bf16 v[52:55], v[96:99], v[148:151], v[52:55]
    ds_read_b64_tr_b16 v[68:69], v4 offset:648
    v_mfma_f32_16x16x32_bf16 v[48:51], v[96:99], v[144:147], v[48:51]
    ds_read_b64_tr_b16 v[70:71], v4 offset:640
    s_waitcnt lgkmcnt(7)
    v_mfma_f32_16x16x32_bf16 v[44:47], v[96:99], v[140:143], v[44:47]
    ds_read_b64_tr_b16 v[72:73], v4 offset:1160
    s_waitcnt lgkmcnt(7)
    v_mfma_f32_16x16x32_bf16 v[40:43], v[96:99], v[136:139], v[40:43]
    ds_read_b64_tr_b16 v[74:75], v4 offset:1152
    s_waitcnt lgkmcnt(7)
    v_mfma_f32_16x16x32_bf16 v[36:39], v[96:99], v[132:135], v[36:39]
    ds_read_b64_tr_b16 v[76:77], v4 offset:1672
    s_waitcnt lgkmcnt(7)
    v_mfma_f32_16x16x32_bf16 v[32:35], v[96:99], v[128:131], v[32:35]
    ds_read_b64_tr_b16 v[78:79], v4 offset:1664
    ds_read_b128 v[156:159], v5 offset:3904
    v_mfma_f32_16x16x32_bf16 v[60:63], v[100:103], v[152:155], v[60:63]
    ds_read_b64_tr_b16 v[80:81], v4 offset:2184
    v_mfma_f32_16x16x32_bf16 v[56:59], v[100:103], v[148:151], v[56:59]
    ds_read_b64_tr_b16 v[82:83], v4 offset:2176
    v_mfma_f32_16x16x32_bf16 v[52:55], v[100:103], v[144:147], v[52:55]
    ds_read_b64_tr_b16 v[84:85], v4 offset:2696
    v_mfma_f32_16x16x32_bf16 v[48:51], v[100:103], v[140:143], v[48:51]
    ds_read_b64_tr_b16 v[86:87], v4 offset:2688
    v_mfma_f32_16x16x32_bf16 v[44:47], v[100:103], v[136:139], v[44:47]
    ds_read_b64_tr_b16 v[88:89], v4 offset:3208
    v_mfma_f32_16x16x32_bf16 v[40:43], v[100:103], v[132:135], v[40:43]
    ds_read_b64_tr_b16 v[90:91], v4 offset:3200
    v_mfma_f32_16x16x32_bf16 v[36:39], v[100:103], v[128:131], v[36:39]
    ds_read_b64_tr_b16 v[92:93], v4 offset:3720
    ds_read_b128 v[152:155], v5 offset:3392
    v_mfma_f32_16x16x32_bf16 v[60:63], v[104:107], v[148:151], v[60:63]
    ds_read_b64_tr_b16 v[94:95], v4 offset:3712
    v_mfma_f32_16x16x32_bf16 v[56:59], v[104:107], v[144:147], v[56:59]
    v_mfma_f32_16x16x32_bf16 v[52:55], v[104:107], v[140:143], v[52:55]
    v_mfma_f32_16x16x32_bf16 v[48:51], v[104:107], v[136:139], v[48:51]
    v_mfma_f32_16x16x32_bf16 v[44:47], v[104:107], v[132:135], v[44:47]
    v_mfma_f32_16x16x32_bf16 v[40:43], v[104:107], v[128:131], v[40:43]
    ds_read_b128 v[148:151], v5 offset:2880
    v_mfma_f32_16x16x32_bf16 v[60:63], v[108:111], v[144:147], v[60:63]
    v_mfma_f32_16x16x32_bf16 v[56:59], v[108:111], v[140:143], v[56:59]
    v_mfma_f32_16x16x32_bf16 v[52:55], v[108:111], v[136:139], v[52:55]
    v_mfma_f32_16x16x32_bf16 v[48:51], v[108:111], v[132:135], v[48:51]
    v_mfma_f32_16x16x32_bf16 v[44:47], v[108:111], v[128:131], v[44:47]
    ds_read_b128 v[144:147], v5 offset:2368
    v_mfma_f32_16x16x32_bf16 v[60:63], v[112:115], v[140:143], v[60:63]
    v_mfma_f32_16x16x32_bf16 v[56:59], v[112:115], v[136:139], v[56:59]
    v_mfma_f32_16x16x32_bf16 v[52:55], v[112:115], v[132:135], v[52:55]
    v_mfma_f32_16x16x32_bf16 v[48:51], v[112:115], v[128:131], v[48:51]
    ds_read_b128 v[140:143], v5 offset:1856
    v_mfma_f32_16x16x32_bf16 v[60:63], v[116:119], v[136:139], v[60:63]
    v_mfma_f32_16x16x32_bf16 v[56:59], v[116:119], v[132:135], v[56:59]
    v_mfma_f32_16x16x32_bf16 v[52:55], v[116:119], v[128:131], v[52:55]
    ds_read_b128 v[136:139], v5 offset:1344
    v_mfma_f32_16x16x32_bf16 v[60:63], v[120:123], v[132:135], v[60:63]
    v_mfma_f32_16x16x32_bf16 v[56:59], v[120:123], v[128:131], v[56:59]
    ds_read_b128 v[132:135], v5 offset:832
    v_mfma_f32_16x16x32_bf16 v[60:63], v[124:127], v[128:131], v[60:63]
    ds_read_b128 v[128:131], v5 offset:320
    s_waitcnt lgkmcnt(4)
    v_mfma_f32_16x16x32_bf16 v[60:63], v[64:67], v[156:159], v[60:63]
    ds_read_b64_tr_b16 v[96:97], v4 offset:200
    v_mfma_f32_16x16x32_bf16 v[56:59], v[64:67], v[152:155], v[56:59]
    ds_read_b64_tr_b16 v[98:99], v4 offset:192
    v_mfma_f32_16x16x32_bf16 v[52:55], v[64:67], v[148:151], v[52:55]
    ds_read_b64_tr_b16 v[100:101], v4 offset:712
    v_mfma_f32_16x16x32_bf16 v[48:51], v[64:67], v[144:147], v[48:51]
    ds_read_b64_tr_b16 v[102:103], v4 offset:704
    s_waitcnt lgkmcnt(7)
    v_mfma_f32_16x16x32_bf16 v[44:47], v[64:67], v[140:143], v[44:47]
    ds_read_b64_tr_b16 v[104:105], v4 offset:1224
    s_waitcnt lgkmcnt(7)
    v_mfma_f32_16x16x32_bf16 v[40:43], v[64:67], v[136:139], v[40:43]
    ds_read_b64_tr_b16 v[106:107], v4 offset:1216
    s_waitcnt lgkmcnt(7)
    v_mfma_f32_16x16x32_bf16 v[36:39], v[64:67], v[132:135], v[36:39]
    ds_read_b64_tr_b16 v[108:109], v4 offset:1736
    s_waitcnt lgkmcnt(7)
    v_mfma_f32_16x16x32_bf16 v[32:35], v[64:67], v[128:131], v[32:35]
    ds_read_b64_tr_b16 v[110:111], v4 offset:1728
    ds_read_b128 v[156:159], v5 offset:3840
    v_mfma_f32_16x16x32_bf16 v[60:63], v[68:71], v[152:155], v[60:63]
    ds_read_b64_tr_b16 v[112:113], v4 offset:2248
    v_mfma_f32_16x16x32_bf16 v[56:59], v[68:71], v[148:151], v[56:59]
    ds_read_b64_tr_b16 v[114:115], v4 offset:2240
    v_mfma_f32_16x16x32_bf16 v[52:55], v[68:71], v[144:147], v[52:55]
    ds_read_b64_tr_b16 v[116:117], v4 offset:2760
    v_mfma_f32_16x16x32_bf16 v[48:51], v[68:71], v[140:143], v[48:51]
    ds_read_b64_tr_b16 v[118:119], v4 offset:2752
    v_mfma_f32_16x16x32_bf16 v[44:47], v[68:71], v[136:139], v[44:47]
    ds_read_b64_tr_b16 v[120:121], v4 offset:3272
    v_mfma_f32_16x16x32_bf16 v[40:43], v[68:71], v[132:135], v[40:43]
    ds_read_b64_tr_b16 v[122:123], v4 offset:3264
    v_mfma_f32_16x16x32_bf16 v[36:39], v[68:71], v[128:131], v[36:39]
    ds_read_b64_tr_b16 v[124:125], v4 offset:3784
    ds_read_b128 v[152:155], v5 offset:3328
    v_mfma_f32_16x16x32_bf16 v[60:63], v[72:75], v[148:151], v[60:63]
    ds_read_b64_tr_b16 v[126:127], v4 offset:3776
    v_mfma_f32_16x16x32_bf16 v[56:59], v[72:75], v[144:147], v[56:59]
    v_mfma_f32_16x16x32_bf16 v[52:55], v[72:75], v[140:143], v[52:55]
    v_mfma_f32_16x16x32_bf16 v[48:51], v[72:75], v[136:139], v[48:51]
    v_mfma_f32_16x16x32_bf16 v[44:47], v[72:75], v[132:135], v[44:47]
    v_mfma_f32_16x16x32_bf16 v[40:43], v[72:75], v[128:131], v[40:43]
    ds_read_b128 v[148:151], v5 offset:2816
    v_mfma_f32_16x16x32_bf16 v[60:63], v[76:79], v[144:147], v[60:63]
    v_mfma_f32_16x16x32_bf16 v[56:59], v[76:79], v[140:143], v[56:59]
    v_mfma_f32_16x16x32_bf16 v[52:55], v[76:79], v[136:139], v[52:55]
    v_mfma_f32_16x16x32_bf16 v[48:51], v[76:79], v[132:135], v[48:51]
    v_mfma_f32_16x16x32_bf16 v[44:47], v[76:79], v[128:131], v[44:47]
    ds_read_b128 v[144:147], v5 offset:2304
    v_mfma_f32_16x16x32_bf16 v[60:63], v[80:83], v[140:143], v[60:63]
    v_mfma_f32_16x16x32_bf16 v[56:59], v[80:83], v[136:139], v[56:59]
    v_mfma_f32_16x16x32_bf16 v[52:55], v[80:83], v[132:135], v[52:55]
    v_mfma_f32_16x16x32_bf16 v[48:51], v[80:83], v[128:131], v[48:51]
    ds_read_b128 v[140:143], v5 offset:1792
    v_mfma_f32_16x16x32_bf16 v[60:63], v[84:87], v[136:139], v[60:63]
    v_mfma_f32_16x16x32_bf16 v[56:59], v[84:87], v[132:135], v[56:59]
    v_mfma_f32_16x16x32_bf16 v[52:55], v[84:87], v[128:131], v[52:55]
    ds_read_b128 v[136:139], v5 offset:1280
    v_mfma_f32_16x16x32_bf16 v[60:63], v[88:91], v[132:135], v[60:63]
    v_mfma_f32_16x16x32_bf16 v[56:59], v[88:91], v[128:131], v[56:59]
    ds_read_b128 v[132:135], v5 offset:768
    v_mfma_f32_16x16x32_bf16 v[60:63], v[92:95], v[128:131], v[60:63]
    ds_read_b128 v[128:131], v5 offset:256
    s_waitcnt lgkmcnt(4)
    v_mfma_f32_16x16x32_bf16 v[60:63], v[96:99], v[156:159], v[60:63]
    ds_read_b64_tr_b16 v[64:65], v4 offset:264
    v_mfma_f32_16x16x32_bf16 v[56:59], v[96:99], v[152:155], v[56:59]
    ds_read_b64_tr_b16 v[66:67], v4 offset:256
    v_mfma_f32_16x16x32_bf16 v[52:55], v[96:99], v[148:151], v[52:55]
    ds_read_b64_tr_b16 v[68:69], v4 offset:776
    v_mfma_f32_16x16x32_bf16 v[48:51], v[96:99], v[144:147], v[48:51]
    ds_read_b64_tr_b16 v[70:71], v4 offset:768
    s_waitcnt lgkmcnt(7)
    v_mfma_f32_16x16x32_bf16 v[44:47], v[96:99], v[140:143], v[44:47]
    ds_read_b64_tr_b16 v[72:73], v4 offset:1288
    s_waitcnt lgkmcnt(7)
    v_mfma_f32_16x16x32_bf16 v[40:43], v[96:99], v[136:139], v[40:43]
    ds_read_b64_tr_b16 v[74:75], v4 offset:1280
    s_waitcnt lgkmcnt(7)
    v_mfma_f32_16x16x32_bf16 v[36:39], v[96:99], v[132:135], v[36:39]
    ds_read_b64_tr_b16 v[76:77], v4 offset:1800
    s_waitcnt lgkmcnt(7)
    v_mfma_f32_16x16x32_bf16 v[32:35], v[96:99], v[128:131], v[32:35]
    ds_read_b64_tr_b16 v[78:79], v4 offset:1792
    ds_read_b128 v[156:159], v5 offset:3776
    v_mfma_f32_16x16x32_bf16 v[60:63], v[100:103], v[152:155], v[60:63]
    ds_read_b64_tr_b16 v[80:81], v4 offset:2312
    v_mfma_f32_16x16x32_bf16 v[56:59], v[100:103], v[148:151], v[56:59]
    ds_read_b64_tr_b16 v[82:83], v4 offset:2304
    v_mfma_f32_16x16x32_bf16 v[52:55], v[100:103], v[144:147], v[52:55]
    ds_read_b64_tr_b16 v[84:85], v4 offset:2824
    v_mfma_f32_16x16x32_bf16 v[48:51], v[100:103], v[140:143], v[48:51]
    ds_read_b64_tr_b16 v[86:87], v4 offset:2816
    v_mfma_f32_16x16x32_bf16 v[44:47], v[100:103], v[136:139], v[44:47]
    ds_read_b64_tr_b16 v[88:89], v4 offset:3336
    v_mfma_f32_16x16x32_bf16 v[40:43], v[100:103], v[132:135], v[40:43]
    ds_read_b64_tr_b16 v[90:91], v4 offset:3328
    v_mfma_f32_16x16x32_bf16 v[36:39], v[100:103], v[128:131], v[36:39]
    ds_read_b64_tr_b16 v[92:93], v4 offset:3848
    ds_read_b128 v[152:155], v5 offset:3264
    v_mfma_f32_16x16x32_bf16 v[60:63], v[104:107], v[148:151], v[60:63]
    ds_read_b64_tr_b16 v[94:95], v4 offset:3840
    v_mfma_f32_16x16x32_bf16 v[56:59], v[104:107], v[144:147], v[56:59]
    v_mfma_f32_16x16x32_bf16 v[52:55], v[104:107], v[140:143], v[52:55]
    v_mfma_f32_16x16x32_bf16 v[48:51], v[104:107], v[136:139], v[48:51]
    v_mfma_f32_16x16x32_bf16 v[44:47], v[104:107], v[132:135], v[44:47]
    v_mfma_f32_16x16x32_bf16 v[40:43], v[104:107], v[128:131], v[40:43]
    ds_read_b128 v[148:151], v5 offset:2752
    v_mfma_f32_16x16x32_bf16 v[60:63], v[108:111], v[144:147], v[60:63]
    v_mfma_f32_16x16x32_bf16 v[56:59], v[108:111], v[140:143], v[56:59]
    v_mfma_f32_16x16x32_bf16 v[52:55], v[108:111], v[136:139], v[52:55]
    v_mfma_f32_16x16x32_bf16 v[48:51], v[108:111], v[132:135], v[48:51]
    v_mfma_f32_16x16x32_bf16 v[44:47], v[108:111], v[128:131], v[44:47]
    ds_read_b128 v[144:147], v5 offset:2240
    v_mfma_f32_16x16x32_bf16 v[60:63], v[112:115], v[140:143], v[60:63]
    v_mfma_f32_16x16x32_bf16 v[56:59], v[112:115], v[136:139], v[56:59]
    v_mfma_f32_16x16x32_bf16 v[52:55], v[112:115], v[132:135], v[52:55]
    v_mfma_f32_16x16x32_bf16 v[48:51], v[112:115], v[128:131], v[48:51]
    ds_read_b128 v[140:143], v5 offset:1728
    v_mfma_f32_16x16x32_bf16 v[60:63], v[116:119], v[136:139], v[60:63]
    v_mfma_f32_16x16x32_bf16 v[56:59], v[116:119], v[132:135], v[56:59]
    v_mfma_f32_16x16x32_bf16 v[52:55], v[116:119], v[128:131], v[52:55]
    ds_read_b128 v[136:139], v5 offset:1216
    v_mfma_f32_16x16x32_bf16 v[60:63], v[120:123], v[132:135], v[60:63]
    v_mfma_f32_16x16x32_bf16 v[56:59], v[120:123], v[128:131], v[56:59]
    ds_read_b128 v[132:135], v5 offset:704
    v_mfma_f32_16x16x32_bf16 v[60:63], v[124:127], v[128:131], v[60:63]
    ds_read_b128 v[128:131], v5 offset:192
    s_waitcnt lgkmcnt(4)
    v_mfma_f32_16x16x32_bf16 v[60:63], v[64:67], v[156:159], v[60:63]
    ds_read_b64_tr_b16 v[96:97], v4 offset:328
    v_mfma_f32_16x16x32_bf16 v[56:59], v[64:67], v[152:155], v[56:59]
    ds_read_b64_tr_b16 v[98:99], v4 offset:320
    v_mfma_f32_16x16x32_bf16 v[52:55], v[64:67], v[148:151], v[52:55]
    ds_read_b64_tr_b16 v[100:101], v4 offset:840
    v_mfma_f32_16x16x32_bf16 v[48:51], v[64:67], v[144:147], v[48:51]
    ds_read_b64_tr_b16 v[102:103], v4 offset:832
    s_waitcnt lgkmcnt(7)
    v_mfma_f32_16x16x32_bf16 v[44:47], v[64:67], v[140:143], v[44:47]
    ds_read_b64_tr_b16 v[104:105], v4 offset:1352
    s_waitcnt lgkmcnt(7)
    v_mfma_f32_16x16x32_bf16 v[40:43], v[64:67], v[136:139], v[40:43]
    ds_read_b64_tr_b16 v[106:107], v4 offset:1344
    s_waitcnt lgkmcnt(7)
    v_mfma_f32_16x16x32_bf16 v[36:39], v[64:67], v[132:135], v[36:39]
    ds_read_b64_tr_b16 v[108:109], v4 offset:1864
    s_waitcnt lgkmcnt(7)
    v_mfma_f32_16x16x32_bf16 v[32:35], v[64:67], v[128:131], v[32:35]
    ds_read_b64_tr_b16 v[110:111], v4 offset:1856
    ds_read_b128 v[156:159], v5 offset:3712
    v_mfma_f32_16x16x32_bf16 v[60:63], v[68:71], v[152:155], v[60:63]
    ds_read_b64_tr_b16 v[112:113], v4 offset:2376
    v_mfma_f32_16x16x32_bf16 v[56:59], v[68:71], v[148:151], v[56:59]
    ds_read_b64_tr_b16 v[114:115], v4 offset:2368
    v_mfma_f32_16x16x32_bf16 v[52:55], v[68:71], v[144:147], v[52:55]
    ds_read_b64_tr_b16 v[116:117], v4 offset:2888
    v_mfma_f32_16x16x32_bf16 v[48:51], v[68:71], v[140:143], v[48:51]
    ds_read_b64_tr_b16 v[118:119], v4 offset:2880
    v_mfma_f32_16x16x32_bf16 v[44:47], v[68:71], v[136:139], v[44:47]
    ds_read_b64_tr_b16 v[120:121], v4 offset:3400
    v_mfma_f32_16x16x32_bf16 v[40:43], v[68:71], v[132:135], v[40:43]
    ds_read_b64_tr_b16 v[122:123], v4 offset:3392
    v_mfma_f32_16x16x32_bf16 v[36:39], v[68:71], v[128:131], v[36:39]
    ds_read_b64_tr_b16 v[124:125], v4 offset:3912
    ds_read_b128 v[152:155], v5 offset:3200
    v_mfma_f32_16x16x32_bf16 v[60:63], v[72:75], v[148:151], v[60:63]
    ds_read_b64_tr_b16 v[126:127], v4 offset:3904
    v_mfma_f32_16x16x32_bf16 v[56:59], v[72:75], v[144:147], v[56:59]
    v_mfma_f32_16x16x32_bf16 v[52:55], v[72:75], v[140:143], v[52:55]
    v_mfma_f32_16x16x32_bf16 v[48:51], v[72:75], v[136:139], v[48:51]
    v_mfma_f32_16x16x32_bf16 v[44:47], v[72:75], v[132:135], v[44:47]
    v_mfma_f32_16x16x32_bf16 v[40:43], v[72:75], v[128:131], v[40:43]
    ds_read_b128 v[148:151], v5 offset:2688
    v_mfma_f32_16x16x32_bf16 v[60:63], v[76:79], v[144:147], v[60:63]
    v_mfma_f32_16x16x32_bf16 v[56:59], v[76:79], v[140:143], v[56:59]
    v_mfma_f32_16x16x32_bf16 v[52:55], v[76:79], v[136:139], v[52:55]
    v_mfma_f32_16x16x32_bf16 v[48:51], v[76:79], v[132:135], v[48:51]
    v_mfma_f32_16x16x32_bf16 v[44:47], v[76:79], v[128:131], v[44:47]
    ds_read_b128 v[144:147], v5 offset:2176
    v_mfma_f32_16x16x32_bf16 v[60:63], v[80:83], v[140:143], v[60:63]
    v_mfma_f32_16x16x32_bf16 v[56:59], v[80:83], v[136:139], v[56:59]
    v_mfma_f32_16x16x32_bf16 v[52:55], v[80:83], v[132:135], v[52:55]
    v_mfma_f32_16x16x32_bf16 v[48:51], v[80:83], v[128:131], v[48:51]
    ds_read_b128 v[140:143], v5 offset:1664
    v_mfma_f32_16x16x32_bf16 v[60:63], v[84:87], v[136:139], v[60:63]
    v_mfma_f32_16x16x32_bf16 v[56:59], v[84:87], v[132:135], v[56:59]
    v_mfma_f32_16x16x32_bf16 v[52:55], v[84:87], v[128:131], v[52:55]
    ds_read_b128 v[136:139], v5 offset:1152
    v_mfma_f32_16x16x32_bf16 v[60:63], v[88:91], v[132:135], v[60:63]
    v_mfma_f32_16x16x32_bf16 v[56:59], v[88:91], v[128:131], v[56:59]
    ds_read_b128 v[132:135], v5 offset:640
    v_mfma_f32_16x16x32_bf16 v[60:63], v[92:95], v[128:131], v[60:63]
    ds_read_b128 v[128:131], v5 offset:128
    s_waitcnt lgkmcnt(4)
    v_mfma_f32_16x16x32_bf16 v[60:63], v[96:99], v[156:159], v[60:63]
    ds_read_b64_tr_b16 v[64:65], v4 offset:392
    v_mfma_f32_16x16x32_bf16 v[56:59], v[96:99], v[152:155], v[56:59]
    ds_read_b64_tr_b16 v[66:67], v4 offset:384
    v_mfma_f32_16x16x32_bf16 v[52:55], v[96:99], v[148:151], v[52:55]
    ds_read_b64_tr_b16 v[68:69], v4 offset:904
    v_mfma_f32_16x16x32_bf16 v[48:51], v[96:99], v[144:147], v[48:51]
    ds_read_b64_tr_b16 v[70:71], v4 offset:896
    s_waitcnt lgkmcnt(7)
    v_mfma_f32_16x16x32_bf16 v[44:47], v[96:99], v[140:143], v[44:47]
    ds_read_b64_tr_b16 v[72:73], v4 offset:1416
    s_waitcnt lgkmcnt(7)
    v_mfma_f32_16x16x32_bf16 v[40:43], v[96:99], v[136:139], v[40:43]
    ds_read_b64_tr_b16 v[74:75], v4 offset:1408
    s_waitcnt lgkmcnt(7)
    v_mfma_f32_16x16x32_bf16 v[36:39], v[96:99], v[132:135], v[36:39]
    ds_read_b64_tr_b16 v[76:77], v4 offset:1928
    s_waitcnt lgkmcnt(7)
    v_mfma_f32_16x16x32_bf16 v[32:35], v[96:99], v[128:131], v[32:35]
    ds_read_b64_tr_b16 v[78:79], v4 offset:1920
    ds_read_b128 v[156:159], v5 offset:3648
    v_mfma_f32_16x16x32_bf16 v[60:63], v[100:103], v[152:155], v[60:63]
    ds_read_b64_tr_b16 v[80:81], v4 offset:2440
    v_mfma_f32_16x16x32_bf16 v[56:59], v[100:103], v[148:151], v[56:59]
    ds_read_b64_tr_b16 v[82:83], v4 offset:2432
    v_mfma_f32_16x16x32_bf16 v[52:55], v[100:103], v[144:147], v[52:55]
    ds_read_b64_tr_b16 v[84:85], v4 offset:2952
    v_mfma_f32_16x16x32_bf16 v[48:51], v[100:103], v[140:143], v[48:51]
    ds_read_b64_tr_b16 v[86:87], v4 offset:2944
    v_mfma_f32_16x16x32_bf16 v[44:47], v[100:103], v[136:139], v[44:47]
    ds_read_b64_tr_b16 v[88:89], v4 offset:3464
    v_mfma_f32_16x16x32_bf16 v[40:43], v[100:103], v[132:135], v[40:43]
    ds_read_b64_tr_b16 v[90:91], v4 offset:3456
    v_mfma_f32_16x16x32_bf16 v[36:39], v[100:103], v[128:131], v[36:39]
    ds_read_b64_tr_b16 v[92:93], v4 offset:3976
    ds_read_b128 v[152:155], v5 offset:3136
    v_mfma_f32_16x16x32_bf16 v[60:63], v[104:107], v[148:151], v[60:63]
    ds_read_b64_tr_b16 v[94:95], v4 offset:3968
    v_mfma_f32_16x16x32_bf16 v[56:59], v[104:107], v[144:147], v[56:59]
    v_mfma_f32_16x16x32_bf16 v[52:55], v[104:107], v[140:143], v[52:55]
    v_mfma_f32_16x16x32_bf16 v[48:51], v[104:107], v[136:139], v[48:51]
    v_mfma_f32_16x16x32_bf16 v[44:47], v[104:107], v[132:135], v[44:47]
    v_mfma_f32_16x16x32_bf16 v[40:43], v[104:107], v[128:131], v[40:43]
    ds_read_b128 v[148:151], v5 offset:2624
    v_mfma_f32_16x16x32_bf16 v[60:63], v[108:111], v[144:147], v[60:63]
    v_mfma_f32_16x16x32_bf16 v[56:59], v[108:111], v[140:143], v[56:59]
    v_mfma_f32_16x16x32_bf16 v[52:55], v[108:111], v[136:139], v[52:55]
    v_mfma_f32_16x16x32_bf16 v[48:51], v[108:111], v[132:135], v[48:51]
    v_mfma_f32_16x16x32_bf16 v[44:47], v[108:111], v[128:131], v[44:47]
    ds_read_b128 v[144:147], v5 offset:2112
    v_mfma_f32_16x16x32_bf16 v[60:63], v[112:115], v[140:143], v[60:63]
    v_mfma_f32_16x16x32_bf16 v[56:59], v[112:115], v[136:139], v[56:59]
    v_mfma_f32_16x16x32_bf16 v[52:55], v[112:115], v[132:135], v[52:55]
    v_mfma_f32_16x16x32_bf16 v[48:51], v[112:115], v[128:131], v[48:51]
    ds_read_b128 v[140:143], v5 offset:1600
    v_mfma_f32_16x16x32_bf16 v[60:63], v[116:119], v[136:139], v[60:63]
    v_mfma_f32_16x16x32_bf16 v[56:59], v[116:119], v[132:135], v[56:59]
    v_mfma_f32_16x16x32_bf16 v[52:55], v[116:119], v[128:131], v[52:55]
    ds_read_b128 v[136:139], v5 offset:1088
    v_mfma_f32_16x16x32_bf16 v[60:63], v[120:123], v[132:135], v[60:63]
    v_mfma_f32_16x16x32_bf16 v[56:59], v[120:123], v[128:131], v[56:59]
    ds_read_b128 v[132:135], v5 offset:576
    v_mfma_f32_16x16x32_bf16 v[60:63], v[124:127], v[128:131], v[60:63]
    ds_read_b128 v[128:131], v5 offset:64
    s_waitcnt lgkmcnt(4)
    v_mfma_f32_16x16x32_bf16 v[60:63], v[64:67], v[156:159], v[60:63]
    ds_read_b64_tr_b16 v[96:97], v4 offset:456
    v_mfma_f32_16x16x32_bf16 v[56:59], v[64:67], v[152:155], v[56:59]
    ds_read_b64_tr_b16 v[98:99], v4 offset:448
    v_mfma_f32_16x16x32_bf16 v[52:55], v[64:67], v[148:151], v[52:55]
    ds_read_b64_tr_b16 v[100:101], v4 offset:968
    v_mfma_f32_16x16x32_bf16 v[48:51], v[64:67], v[144:147], v[48:51]
    ds_read_b64_tr_b16 v[102:103], v4 offset:960
    s_waitcnt lgkmcnt(7)
    v_mfma_f32_16x16x32_bf16 v[44:47], v[64:67], v[140:143], v[44:47]
    ds_read_b64_tr_b16 v[104:105], v4 offset:1480
    s_waitcnt lgkmcnt(7)
    v_mfma_f32_16x16x32_bf16 v[40:43], v[64:67], v[136:139], v[40:43]
    ds_read_b64_tr_b16 v[106:107], v4 offset:1472
    s_waitcnt lgkmcnt(7)
    v_mfma_f32_16x16x32_bf16 v[36:39], v[64:67], v[132:135], v[36:39]
    ds_read_b64_tr_b16 v[108:109], v4 offset:1992
    s_waitcnt lgkmcnt(7)
    v_mfma_f32_16x16x32_bf16 v[32:35], v[64:67], v[128:131], v[32:35]
    ds_read_b64_tr_b16 v[110:111], v4 offset:1984
    ds_read_b128 v[156:159], v5 offset:3584
    v_mfma_f32_16x16x32_bf16 v[60:63], v[68:71], v[152:155], v[60:63]
    ds_read_b64_tr_b16 v[112:113], v4 offset:2504
    v_mfma_f32_16x16x32_bf16 v[56:59], v[68:71], v[148:151], v[56:59]
    ds_read_b64_tr_b16 v[114:115], v4 offset:2496
    v_mfma_f32_16x16x32_bf16 v[52:55], v[68:71], v[144:147], v[52:55]
    ds_read_b64_tr_b16 v[116:117], v4 offset:3016
    v_mfma_f32_16x16x32_bf16 v[48:51], v[68:71], v[140:143], v[48:51]
    ds_read_b64_tr_b16 v[118:119], v4 offset:3008
    v_mfma_f32_16x16x32_bf16 v[44:47], v[68:71], v[136:139], v[44:47]
    ds_read_b64_tr_b16 v[120:121], v4 offset:3528
    v_mfma_f32_16x16x32_bf16 v[40:43], v[68:71], v[132:135], v[40:43]
    ds_read_b64_tr_b16 v[122:123], v4 offset:3520
    v_mfma_f32_16x16x32_bf16 v[36:39], v[68:71], v[128:131], v[36:39]
    ds_read_b64_tr_b16 v[124:125], v4 offset:4040
    ds_read_b128 v[152:155], v5 offset:3072
    v_mfma_f32_16x16x32_bf16 v[60:63], v[72:75], v[148:151], v[60:63]
    ds_read_b64_tr_b16 v[126:127], v4 offset:4032
    v_mfma_f32_16x16x32_bf16 v[56:59], v[72:75], v[144:147], v[56:59]
    v_mfma_f32_16x16x32_bf16 v[52:55], v[72:75], v[140:143], v[52:55]
    v_mfma_f32_16x16x32_bf16 v[48:51], v[72:75], v[136:139], v[48:51]
    v_mfma_f32_16x16x32_bf16 v[44:47], v[72:75], v[132:135], v[44:47]
    v_mfma_f32_16x16x32_bf16 v[40:43], v[72:75], v[128:131], v[40:43]
    ds_read_b128 v[148:151], v5 offset:2560
    v_mfma_f32_16x16x32_bf16 v[60:63], v[76:79], v[144:147], v[60:63]
    v_mfma_f32_16x16x32_bf16 v[56:59], v[76:79], v[140:143], v[56:59]
    v_mfma_f32_16x16x32_bf16 v[52:55], v[76:79], v[136:139], v[52:55]
    v_mfma_f32_16x16x32_bf16 v[48:51], v[76:79], v[132:135], v[48:51]
    v_mfma_f32_16x16x32_bf16 v[44:47], v[76:79], v[128:131], v[44:47]
    ds_read_b128 v[144:147], v5 offset:2048
    v_mfma_f32_16x16x32_bf16 v[60:63], v[80:83], v[140:143], v[60:63]
    v_mfma_f32_16x16x32_bf16 v[56:59], v[80:83], v[136:139], v[56:59]
    v_mfma_f32_16x16x32_bf16 v[52:55], v[80:83], v[132:135], v[52:55]
    v_mfma_f32_16x16x32_bf16 v[48:51], v[80:83], v[128:131], v[48:51]
    ds_read_b128 v[140:143], v5 offset:1536
    v_mfma_f32_16x16x32_bf16 v[60:63], v[84:87], v[136:139], v[60:63]
    v_mfma_f32_16x16x32_bf16 v[56:59], v[84:87], v[132:135], v[56:59]
    v_mfma_f32_16x16x32_bf16 v[52:55], v[84:87], v[128:131], v[52:55]
    ds_read_b128 v[136:139], v5 offset:1024
    v_mfma_f32_16x16x32_bf16 v[60:63], v[88:91], v[132:135], v[60:63]
    v_mfma_f32_16x16x32_bf16 v[56:59], v[88:91], v[128:131], v[56:59]
    ds_read_b128 v[132:135], v5 offset:512
    v_mfma_f32_16x16x32_bf16 v[60:63], v[92:95], v[128:131], v[60:63]
    ds_read_b128 v[128:131], v5 offset:0
    s_waitcnt lgkmcnt(4)
    v_mfma_f32_16x16x32_bf16 v[60:63], v[96:99], v[156:159], v[60:63]
    v_mfma_f32_16x16x32_bf16 v[56:59], v[96:99], v[152:155], v[56:59]
    v_mfma_f32_16x16x32_bf16 v[52:55], v[96:99], v[148:151], v[52:55]
    v_mfma_f32_16x16x32_bf16 v[48:51], v[96:99], v[144:147], v[48:51]
    s_waitcnt lgkmcnt(3)
    v_mfma_f32_16x16x32_bf16 v[44:47], v[96:99], v[140:143], v[44:47]
    s_waitcnt lgkmcnt(2)
    v_mfma_f32_16x16x32_bf16 v[40:43], v[96:99], v[136:139], v[40:43]
    s_waitcnt lgkmcnt(1)
    v_mfma_f32_16x16x32_bf16 v[36:39], v[96:99], v[132:135], v[36:39]
    s_waitcnt lgkmcnt(0)
    v_mfma_f32_16x16x32_bf16 v[32:35], v[96:99], v[128:131], v[32:35]
    v_mfma_f32_16x16x32_bf16 v[60:63], v[100:103], v[152:155], v[60:63]
    v_mfma_f32_16x16x32_bf16 v[56:59], v[100:103], v[148:151], v[56:59]
    v_mfma_f32_16x16x32_bf16 v[52:55], v[100:103], v[144:147], v[52:55]
    v_mfma_f32_16x16x32_bf16 v[48:51], v[100:103], v[140:143], v[48:51]
    v_mfma_f32_16x16x32_bf16 v[44:47], v[100:103], v[136:139], v[44:47]
    v_mfma_f32_16x16x32_bf16 v[40:43], v[100:103], v[132:135], v[40:43]
    v_mfma_f32_16x16x32_bf16 v[36:39], v[100:103], v[128:131], v[36:39]
    v_mfma_f32_16x16x32_bf16 v[60:63], v[104:107], v[148:151], v[60:63]
    v_mfma_f32_16x16x32_bf16 v[56:59], v[104:107], v[144:147], v[56:59]
    v_mfma_f32_16x16x32_bf16 v[52:55], v[104:107], v[140:143], v[52:55]
    v_mfma_f32_16x16x32_bf16 v[48:51], v[104:107], v[136:139], v[48:51]
    v_mfma_f32_16x16x32_bf16 v[44:47], v[104:107], v[132:135], v[44:47]
    v_mfma_f32_16x16x32_bf16 v[40:43], v[104:107], v[128:131], v[40:43]
    v_mfma_f32_16x16x32_bf16 v[60:63], v[108:111], v[144:147], v[60:63]
    v_mfma_f32_16x16x32_bf16 v[56:59], v[108:111], v[140:143], v[56:59]
    v_mfma_f32_16x16x32_bf16 v[52:55], v[108:111], v[136:139], v[52:55]
    v_mfma_f32_16x16x32_bf16 v[48:51], v[108:111], v[132:135], v[48:51]
    v_mfma_f32_16x16x32_bf16 v[44:47], v[108:111], v[128:131], v[44:47]
    v_mfma_f32_16x16x32_bf16 v[60:63], v[112:115], v[140:143], v[60:63]
    v_mfma_f32_16x16x32_bf16 v[56:59], v[112:115], v[136:139], v[56:59]
    v_mfma_f32_16x16x32_bf16 v[52:55], v[112:115], v[132:135], v[52:55]
    v_mfma_f32_16x16x32_bf16 v[48:51], v[112:115], v[128:131], v[48:51]
    v_mfma_f32_16x16x32_bf16 v[60:63], v[116:119], v[136:139], v[60:63]
    v_mfma_f32_16x16x32_bf16 v[56:59], v[116:119], v[132:135], v[56:59]
    v_mfma_f32_16x16x32_bf16 v[52:55], v[116:119], v[128:131], v[52:55]
    v_mfma_f32_16x16x32_bf16 v[60:63], v[120:123], v[132:135], v[60:63]
    v_mfma_f32_16x16x32_bf16 v[56:59], v[120:123], v[128:131], v[56:59]
    v_mfma_f32_16x16x32_bf16 v[60:63], v[124:127], v[128:131], v[60:63]
    s_setprio 3
    s_sub_u32 s54, s40, 8
    s_mul_i32 s49, s54, 24576
    s_mul_i32 s50, s54, 66560
    v_and_b32 v7, 15, v0
    v_lshrrev_b32 v6, 4, v0
    v_lshlrev_b32 v7, 5, v7
    v_lshl_add_u32 v7, v6, 3, v7
    v_add_u32 v8, s57, v7
    v_add_u32 v8, 17120, v8
    s_add_u32 s61, s58, 11534336
    ds_read_b64 v[64:65], v8 offset:0
    ds_read_b64 v[66:67], v8 offset:512
    ds_read_b64 v[68:69], v8 offset:1024
    ds_read_b64 v[70:71], v8 offset:1536
    ds_read_b64 v[72:73], v8 offset:2048
    ds_read_b64 v[74:75], v8 offset:2560
    ds_read_b64 v[76:77], v8 offset:3072
    ds_read_b64 v[78:79], v8 offset:3584
    s_waitcnt lgkmcnt(0)
    s_nop 3
    v_lshlrev_b32 v96, 16, v64
    v_and_b32 v97, 0xffff0000, v64
    v_lshlrev_b32 v98, 16, v65
    v_and_b32 v99, 0xffff0000, v65
    v_fma_f32 v32, v96, s60, v32
    v_fma_f32 v33, v97, s60, v33
    v_fma_f32 v34, v98, s60, v34
    v_fma_f32 v35, v99, s60, v35
    v_cvt_pk_bf16_f32 v32, v32, v33
    v_cvt_pk_bf16_f32 v33, v34, v35
    buffer_store_dwordx2 v[32:33], v7, s[28:31], s61 offen offset:0 sc1
    v_lshlrev_b32 v96, 16, v66
    v_and_b32 v97, 0xffff0000, v66
    v_lshlrev_b32 v98, 16, v67
    v_and_b32 v99, 0xffff0000, v67
    v_fma_f32 v36, v96, s60, v36
    v_fma_f32 v37, v97, s60, v37
    v_fma_f32 v38, v98, s60, v38
    v_fma_f32 v39, v99, s60, v39
    v_cvt_pk_bf16_f32 v36, v36, v37
    v_cvt_pk_bf16_f32 v37, v38, v39
    buffer_store_dwordx2 v[36:37], v7, s[28:31], s61 offen offset:512 sc1
    v_lshlrev_b32 v96, 16, v68
    v_and_b32 v97, 0xffff0000, v68
    v_lshlrev_b32 v98, 16, v69
    v_and_b32 v99, 0xffff0000, v69
    v_fma_f32 v40, v96, s60, v40
    v_fma_f32 v41, v97, s60, v41
    v_fma_f32 v42, v98, s60, v42
    v_fma_f32 v43, v99, s60, v43
    v_cvt_pk_bf16_f32 v40, v40, v41
    v_cvt_pk_bf16_f32 v41, v42, v43
    buffer_store_dwordx2 v[40:41], v7, s[28:31], s61 offen offset:1024 sc1
    v_lshlrev_b32 v96, 16, v70
    v_and_b32 v97, 0xffff0000, v70
    v_lshlrev_b32 v98, 16, v71
    v_and_b32 v99, 0xffff0000, v71
    v_fma_f32 v44, v96, s60, v44
    v_fma_f32 v45, v97, s60, v45
    v_fma_f32 v46, v98, s60, v46
    v_fma_f32 v47, v99, s60, v47
    v_cvt_pk_bf16_f32 v44, v44, v45
    v_cvt_pk_bf16_f32 v45, v46, v47
    buffer_store_dwordx2 v[44:45], v7, s[28:31], s61 offen offset:1536 sc1
    v_lshlrev_b32 v96, 16, v72
    v_and_b32 v97, 0xffff0000, v72
    v_lshlrev_b32 v98, 16, v73
    v_and_b32 v99, 0xffff0000, v73
    v_fma_f32 v48, v96, s60, v48
    v_fma_f32 v49, v97, s60, v49
    v_fma_f32 v50, v98, s60, v50
    v_fma_f32 v51, v99, s60, v51
    v_cvt_pk_bf16_f32 v48, v48, v49
    v_cvt_pk_bf16_f32 v49, v50, v51
    buffer_store_dwordx2 v[48:49], v7, s[28:31], s61 offen offset:2048 sc1
    v_lshlrev_b32 v96, 16, v74
    v_and_b32 v97, 0xffff0000, v74
    v_lshlrev_b32 v98, 16, v75
    v_and_b32 v99, 0xffff0000, v75
    v_fma_f32 v52, v96, s60, v52
    v_fma_f32 v53, v97, s60, v53
    v_fma_f32 v54, v98, s60, v54
    v_fma_f32 v55, v99, s60, v55
    v_cvt_pk_bf16_f32 v52, v52, v53
    v_cvt_pk_bf16_f32 v53, v54, v55
    buffer_store_dwordx2 v[52:53], v7, s[28:31], s61 offen offset:2560 sc1
    v_lshlrev_b32 v96, 16, v76
    v_and_b32 v97, 0xffff0000, v76
    v_lshlrev_b32 v98, 16, v77
    v_and_b32 v99, 0xffff0000, v77
    v_fma_f32 v56, v96, s60, v56
    v_fma_f32 v57, v97, s60, v57
    v_fma_f32 v58, v98, s60, v58
    v_fma_f32 v59, v99, s60, v59
    v_cvt_pk_bf16_f32 v56, v56, v57
    v_cvt_pk_bf16_f32 v57, v58, v59
    buffer_store_dwordx2 v[56:57], v7, s[28:31], s61 offen offset:3072 sc1
    v_lshlrev_b32 v96, 16, v78
    v_and_b32 v97, 0xffff0000, v78
    v_lshlrev_b32 v98, 16, v79
    v_and_b32 v99, 0xffff0000, v79
    v_fma_f32 v60, v96, s60, v60
    v_fma_f32 v61, v97, s60, v61
    v_fma_f32 v62, v98, s60, v62
    v_fma_f32 v63, v99, s60, v63
    v_cvt_pk_bf16_f32 v60, v60, v61
    v_cvt_pk_bf16_f32 v61, v62, v63
    buffer_store_dwordx2 v[60:61], v7, s[28:31], s61 offen offset:3584 sc1
    s_cmp_lg_u32 s40, 10
    s_cbranch_scc1 L_srv_84
    s_barrier
    s_waitcnt vmcnt(0)
    s_cmp_lt_u32 s2, 128
    s_cselect_b32 s64, 3, 2
    v_mov_b32 v2, 162056
    v_mov_b32 v3, 1
    s_mov_b64 exec, 1
    ds_add_rtn_u32 v3, v2, v3
    s_waitcnt lgkmcnt(0)
    s_mov_b64 exec, -1
    v_readfirstlane_b32 s66, v3
    s_nop 3
    s_add_u32 s66, s66, 1
    s_cmp_lg_u32 s66, s64
    s_cbranch_scc1 L_zs_85
    s_and_b32 s65, s2, 7
    s_add_u32 s65, s65, 8
    s_lshl_b32 s66, s65, 7
    s_add_u32 s66, s66, 18874368
    v_mov_b32 v2, s66
    v_mov_b32 v3, 1
    s_mov_b64 exec, 1
    global_atomic_add v3, v2, v3, s[26:27] sc0 sc1
    s_waitcnt vmcnt(0)
    s_mov_b64 exec, -1
    v_readfirstlane_b32 s66, v3
    s_nop 3
    s_add_u32 s66, s66, 1
    s_cmp_lg_u32 s66, 32
    s_cbranch_scc1 L_ga_86
    v_add_u32 v2, 1024, v2
    v_mov_b32 v3, 1
    s_mov_b64 exec, 1
    global_store_dword v2, v3, s[26:27] sc1
    s_mov_b64 exec, -1
L_ga_86:
L_zs_85:
    s_endpgm
L_srv_84:
    s_sub_u32 s56, s40, 8
    s_mul_i32 s53, s56, 5120
    s_mul_i32 s62, s56, 40960
    s_barrier
    s_waitcnt vmcnt(0)
    s_cmp_lt_u32 s2, 128
    s_cselect_b32 s64, 3, 2
    v_mov_b32 v2, 162056
    v_mov_b32 v3, 1
    s_mov_b64 exec, 1
    ds_add_rtn_u32 v3, v2, v3
    s_waitcnt lgkmcnt(0)
    s_mov_b64 exec, -1
    v_readfirstlane_b32 s66, v3
    s_nop 3
    s_add_u32 s66, s66, 1
    s_cmp_lg_u32 s66, s64
    s_cbranch_scc1 L_zs_87
    s_and_b32 s65, s2, 7
    s_add_u32 s65, s65, 8
    s_lshl_b32 s66, s65, 7
    s_add_u32 s66, s66, 18874368
    v_mov_b32 v2, s66
    v_mov_b32 v3, 1
    s_mov_b64 exec, 1
    global_atomic_add v3, v2, v3, s[26:27] sc0 sc1
    s_waitcnt vmcnt(0)
    s_mov_b64 exec, -1
    v_readfirstlane_b32 s66, v3
    s_nop 3
    s_add_u32 s66, s66, 1
    s_cmp_lg_u32 s66, 32
    s_cbranch_scc1 L_ga_88
    v_add_u32 v2, 1024, v2
    v_mov_b32 v3, 1
    s_mov_b64 exec, 1
    global_store_dword v2, v3, s[26:27] sc1
    s_mov_b64 exec, -1
L_ga_88:
L_zs_87:
    s_add_u32 m0, s49, 0
    s_add_u32 s51, s50, 266240
    buffer_load_dwordx4 v160, s[28:31], s51 offen sc1 lds
    s_add_u32 m0, s49, 1024
    s_add_u32 s51, s50, 266240
    buffer_load_dwordx4 v161, s[28:31], s51 offen sc1 lds
    s_add_u32 m0, s49, 2048
    s_add_u32 s51, s50, 266240
    buffer_load_dwordx4 v162, s[28:31], s51 offen sc1 lds
    s_add_u32 m0, s49, 3072
    s_add_u32 s51, s50, 274560
    buffer_load_dwordx4 v160, s[28:31], s51 offen sc1 lds
    s_add_u32 m0, s49, 4096
    s_add_u32 s51, s50, 274560
    buffer_load_dwordx4 v161, s[28:31], s51 offen sc1 lds
    s_add_u32 m0, s49, 5120
    s_add_u32 s51, s50, 274560
    buffer_load_dwordx4 v162, s[28:31], s51 offen sc1 lds
    s_add_u32 m0, s49, 6144
    s_add_u32 s51, s50, 282880
    buffer_load_dwordx4 v160, s[28:31], s51 offen sc1 lds
    s_add_u32 m0, s49, 7168
    s_add_u32 s51, s50, 282880
    buffer_load_dwordx4 v161, s[28:31], s51 offen sc1 lds
    s_add_u32 m0, s49, 8192
    s_add_u32 s51, s50, 282880
    buffer_load_dwordx4 v162, s[28:31], s51 offen sc1 lds
    s_add_u32 m0, s49, 9216
    s_add_u32 s51, s50, 291200
    buffer_load_dwordx4 v160, s[28:31], s51 offen sc1 lds
    s_add_u32 m0, s49, 10240
    s_add_u32 s51, s50, 291200
    buffer_load_dwordx4 v161, s[28:31], s51 offen sc1 lds
    s_add_u32 m0, s49, 11264
    s_add_u32 s51, s50, 291200
    buffer_load_dwordx4 v162, s[28:31], s51 offen sc1 lds
    s_add_u32 m0, s49, 12288
    s_add_u32 s51, s50, 299520
    buffer_load_dwordx4 v160, s[28:31], s51 offen sc1 lds
    s_add_u32 m0, s49, 13312
    s_add_u32 s51, s50, 299520
    buffer_load_dwordx4 v161, s[28:31], s51 offen sc1 lds
    s_add_u32 m0, s49, 14336
    s_add_u32 s51, s50, 299520
    buffer_load_dwordx4 v162, s[28:31], s51 offen sc1 lds
    s_add_u32 m0, s49, 15360
    s_add_u32 s51, s50, 307840
    buffer_load_dwordx4 v160, s[28:31], s51 offen sc1 lds
    s_add_u32 m0, s49, 16384
    s_add_u32 s51, s50, 307840
    buffer_load_dwordx4 v161, s[28:31], s51 offen sc1 lds
    s_add_u32 m0, s49, 17408
    s_add_u32 s51, s50, 307840
    buffer_load_dwordx4 v162, s[28:31], s51 offen sc1 lds
    s_add_u32 m0, s49, 18432
    s_add_u32 s51, s50, 316160
    buffer_load_dwordx4 v160, s[28:31], s51 offen sc1 lds
    s_add_u32 m0, s49, 19456
    s_add_u32 s51, s50, 316160
    buffer_load_dwordx4 v161, s[28:31], s51 offen sc1 lds
    s_add_u32 m0, s49, 20480
    s_add_u32 s51, s50, 316160
    buffer_load_dwordx4 v162, s[28:31], s51 offen sc1 lds
    s_add_u32 m0, s49, 21504
    s_add_u32 s51, s50, 324480
    buffer_load_dwordx4 v160, s[28:31], s51 offen sc1 lds
    s_add_u32 m0, s49, 22528
    s_add_u32 s51, s50, 324480
    buffer_load_dwordx4 v161, s[28:31], s51 offen sc1 lds
    s_add_u32 m0, s49, 23552
    s_add_u32 s51, s50, 324480
    buffer_load_dwordx4 v162, s[28:31], s51 offen sc1 lds
    s_add_u32 m0, s53, 98304
    s_add_u32 s51, s62, 0
    buffer_load_dwordx4 v163, s[32:35], s51 offen lds
    s_add_u32 m0, s53, 99328
    s_add_u32 s51, s62, 0
    buffer_load_dwordx4 v164, s[32:35], s51 offen lds
    s_add_u32 m0, s53, 100352
    s_add_u32 s51, s62, 0
    buffer_load_dwordx4 v165, s[32:35], s51 offen lds
    s_add_u32 m0, s53, 101376
    s_add_u32 s51, s62, 0
    buffer_load_dwordx4 v166, s[32:35], s51 offen lds
    s_add_u32 m0, s53, 102400
    s_add_u32 s51, s62, 0
    buffer_load_dwordx4 v167, s[32:35], s51 offen lds
    s_add_u32 m0, s53, 108544
    s_add_u32 s51, s62, 81920
    buffer_load_dwordx4 v163, s[32:35], s51 offen lds
    s_add_u32 m0, s53, 109568
    s_add_u32 s51, s62, 81920
    buffer_load_dwordx4 v164, s[32:35], s51 offen lds
    s_add_u32 m0, s53, 110592
    s_add_u32 s51, s62, 81920
    buffer_load_dwordx4 v165, s[32:35], s51 offen lds
    s_add_u32 m0, s53, 111616
    s_add_u32 s51, s62, 81920
    buffer_load_dwordx4 v166, s[32:35], s51 offen lds
    s_add_u32 m0, s53, 112640
    s_add_u32 s51, s62, 81920
    buffer_load_dwordx4 v167, s[32:35], s51 offen lds
    s_add_u32 m0, s53, 118784
    s_add_u32 s51, s62, 163840
    buffer_load_dwordx4 v163, s[32:35], s51 offen lds
    s_add_u32 m0, s53, 119808
    s_add_u32 s51, s62, 163840
    buffer_load_dwordx4 v164, s[32:35], s51 offen lds
    s_add_u32 m0, s53, 120832
    s_add_u32 s51, s62, 163840
    buffer_load_dwordx4 v165, s[32:35], s51 offen lds
    s_add_u32 m0, s53, 121856
    s_add_u32 s51, s62, 163840
    buffer_load_dwordx4 v166, s[32:35], s51 offen lds
    s_add_u32 m0, s53, 122880
    s_add_u32 s51, s62, 163840
    buffer_load_dwordx4 v167, s[32:35], s51 offen lds
    s_add_u32 m0, s53, 129024
    s_add_u32 s51, s62, 245760
    buffer_load_dwordx4 v163, s[32:35], s51 offen lds
    s_add_u32 m0, s53, 130048
    s_add_u32 s51, s62, 245760
    buffer_load_dwordx4 v164, s[32:35], s51 offen lds
    s_add_u32 m0, s53, 131072
    s_add_u32 s51, s62, 245760
    buffer_load_dwordx4 v165, s[32:35], s51 offen lds
    s_add_u32 m0, s53, 132096
    s_add_u32 s51, s62, 245760
    buffer_load_dwordx4 v166, s[32:35], s51 offen lds
    s_add_u32 m0, s53, 133120
    s_add_u32 s51, s62, 245760
    buffer_load_dwordx4 v167, s[32:35], s51 offen lds
    s_add_u32 m0, s53, 139264
    s_add_u32 s51, s62, 327680
    buffer_load_dwordx4 v163, s[32:35], s51 offen lds
    s_add_u32 m0, s53, 140288
    s_add_u32 s51, s62, 327680
    buffer_load_dwordx4 v164, s[32:35], s51 offen lds
    s_add_u32 m0, s53, 141312
    s_add_u32 s51, s62, 327680
    buffer_load_dwordx4 v165, s[32:35], s51 offen lds
    s_add_u32 m0, s53, 142336
    s_add_u32 s51, s62, 327680
    buffer_load_dwordx4 v166, s[32:35], s51 offen lds
    s_add_u32 m0, s53, 143360
    s_add_u32 s51, s62, 327680
    buffer_load_dwordx4 v167, s[32:35], s51 offen lds
    s_cmp_lg_u32 s56, 0
    s_cbranch_scc1 L_wsk_89
    s_add_u32 m0, s53, 149504
    s_add_u32 s51, s62, 409600
    buffer_load_dwordx4 v163, s[32:35], s51 offen lds
L_wsk_89:
    s_cmp_lg_u32 s56, 0
    s_cbranch_scc1 L_wsk_90
    s_add_u32 m0, s53, 150528
    s_add_u32 s51, s62, 409600
    buffer_load_dwordx4 v164, s[32:35], s51 offen lds
L_wsk_90:
    s_cmp_lg_u32 s56, 0
    s_cbranch_scc1 L_wsk_91
    s_add_u32 m0, s53, 151552
    s_add_u32 s51, s62, 409600
    buffer_load_dwordx4 v165, s[32:35], s51 offen lds
L_wsk_91:
    s_cmp_lg_u32 s56, 0
    s_cbranch_scc1 L_wsk_92
    s_add_u32 m0, s53, 152576
    s_add_u32 s51, s62, 409600
    buffer_load_dwordx4 v166, s[32:35], s51 offen lds
L_wsk_92:
    s_cmp_lg_u32 s56, 0
    s_cbranch_scc1 L_wsk_93
    s_add_u32 m0, s53, 153600
    s_add_u32 s51, s62, 409600
    buffer_load_dwordx4 v167, s[32:35], s51 offen lds
L_wsk_93:
    s_waitcnt vmcnt(25)
    s_barrier
    s_add_u32 m0, s49, 49152
    s_add_u32 s51, s50, 399360
    buffer_load_dwordx4 v160, s[28:31], s51 offen sc1 lds
    s_add_u32 m0, s49, 50176
    s_add_u32 s51, s50, 399360
    buffer_load_dwordx4 v161, s[28:31], s51 offen sc1 lds
    s_add_u32 m0, s49, 51200
    s_add_u32 s51, s50, 399360
    buffer_load_dwordx4 v162, s[28:31], s51 offen sc1 lds
    s_add_u32 m0, s49, 52224
    s_add_u32 s51, s50, 407680
    buffer_load_dwordx4 v160, s[28:31], s51 offen sc1 lds
    s_add_u32 m0, s49, 53248
    s_add_u32 s51, s50, 407680
    buffer_load_dwordx4 v161, s[28:31], s51 offen sc1 lds
    s_add_u32 m0, s49, 54272
    s_add_u32 s51, s50, 407680
    buffer_load_dwordx4 v162, s[28:31], s51 offen sc1 lds
    s_add_u32 m0, s49, 55296
    s_add_u32 s51, s50, 416000
    buffer_load_dwordx4 v160, s[28:31], s51 offen sc1 lds
    s_add_u32 m0, s49, 56320
    s_add_u32 s51, s50, 416000
    buffer_load_dwordx4 v161, s[28:31], s51 offen sc1 lds
    s_add_u32 m0, s49, 57344
    s_add_u32 s51, s50, 416000
    buffer_load_dwordx4 v162, s[28:31], s51 offen sc1 lds
    s_add_u32 m0, s49, 58368
    s_add_u32 s51, s50, 424320
    buffer_load_dwordx4 v160, s[28:31], s51 offen sc1 lds
    s_add_u32 m0, s49, 59392
    s_add_u32 s51, s50, 424320
    buffer_load_dwordx4 v161, s[28:31], s51 offen sc1 lds
    s_add_u32 m0, s49, 60416
    s_add_u32 s51, s50, 424320
    buffer_load_dwordx4 v162, s[28:31], s51 offen sc1 lds
    s_add_u32 m0, s49, 61440
    s_add_u32 s51, s50, 432640
    buffer_load_dwordx4 v160, s[28:31], s51 offen sc1 lds
    s_add_u32 m0, s49, 62464
    s_add_u32 s51, s50, 432640
    buffer_load_dwordx4 v161, s[28:31], s51 offen sc1 lds
    s_add_u32 m0, s49, 63488
    s_add_u32 s51, s50, 432640
    buffer_load_dwordx4 v162, s[28:31], s51 offen sc1 lds
    s_add_u32 m0, s49, 64512
    s_add_u32 s51, s50, 440960
    buffer_load_dwordx4 v160, s[28:31], s51 offen sc1 lds
    s_add_u32 m0, s49, 65536
    s_add_u32 s51, s50, 440960
    buffer_load_dwordx4 v161, s[28:31], s51 offen sc1 lds
    s_add_u32 m0, s49, 66560
    s_add_u32 s51, s50, 440960
    buffer_load_dwordx4 v162, s[28:31], s51 offen sc1 lds
    s_add_u32 m0, s49, 67584
    s_add_u32 s51, s50, 449280
    buffer_load_dwordx4 v160, s[28:31], s51 offen sc1 lds
    s_add_u32 m0, s49, 68608
    s_add_u32 s51, s50, 449280
    buffer_load_dwordx4 v161, s[28:31], s51 offen sc1 lds
    s_add_u32 m0, s49, 69632
    s_add_u32 s51, s50, 449280
    buffer_load_dwordx4 v162, s[28:31], s51 offen sc1 lds
    s_add_u32 m0, s49, 70656
    s_add_u32 s51, s50, 457600
    buffer_load_dwordx4 v160, s[28:31], s51 offen sc1 lds
    s_add_u32 m0, s49, 71680
    s_add_u32 s51, s50, 457600
    buffer_load_dwordx4 v161, s[28:31], s51 offen sc1 lds
    s_add_u32 m0, s49, 72704
    s_add_u32 s51, s50, 457600
    buffer_load_dwordx4 v162, s[28:31], s51 offen sc1 lds
    s_waitcnt vmcnt(0)
    s_barrier
    s_add_u32 m0, s53, 0
    s_add_u32 s51, s62, 435200
    buffer_load_dwordx4 v163, s[32:35], s51 offen lds
    s_add_u32 m0, s53, 1024
    s_add_u32 s51, s62, 435200
    buffer_load_dwordx4 v164, s[32:35], s51 offen lds
    s_add_u32 m0, s53, 2048
    s_add_u32 s51, s62, 435200
    buffer_load_dwordx4 v165, s[32:35], s51 offen lds
    s_add_u32 m0, s53, 3072
    s_add_u32 s51, s62, 435200
    buffer_load_dwordx4 v166, s[32:35], s51 offen lds
    s_add_u32 m0, s53, 4096
    s_add_u32 s51, s62, 435200
    buffer_load_dwordx4 v167, s[32:35], s51 offen lds
    s_add_u32 m0, s53, 10240
    s_add_u32 s51, s62, 517120
    buffer_load_dwordx4 v163, s[32:35], s51 offen lds
    s_add_u32 m0, s53, 11264
    s_add_u32 s51, s62, 517120
    buffer_load_dwordx4 v164, s[32:35], s51 offen lds
    s_add_u32 m0, s53, 12288
    s_add_u32 s51, s62, 517120
    buffer_load_dwordx4 v165, s[32:35], s51 offen lds
    s_add_u32 m0, s53, 13312
    s_add_u32 s51, s62, 517120
    buffer_load_dwordx4 v166, s[32:35], s51 offen lds
    s_add_u32 m0, s53, 14336
    s_add_u32 s51, s62, 517120
    buffer_load_dwordx4 v167, s[32:35], s51 offen lds
    s_add_u32 m0, s53, 20480
    s_add_u32 s51, s62, 599040
    buffer_load_dwordx4 v163, s[32:35], s51 offen lds
    s_add_u32 m0, s53, 21504
    s_add_u32 s51, s62, 599040
    buffer_load_dwordx4 v164, s[32:35], s51 offen lds
    s_add_u32 m0, s53, 22528
    s_add_u32 s51, s62, 599040
    buffer_load_dwordx4 v165, s[32:35], s51 offen lds
    s_add_u32 m0, s53, 23552
    s_add_u32 s51, s62, 599040
    buffer_load_dwordx4 v166, s[32:35], s51 offen lds
    s_add_u32 m0, s53, 24576
    s_add_u32 s51, s62, 599040
    buffer_load_dwordx4 v167, s[32:35], s51 offen lds
    s_add_u32 m0, s53, 30720
    s_add_u32 s51, s62, 680960
    buffer_load_dwordx4 v163, s[32:35], s51 offen lds
    s_add_u32 m0, s53, 31744
    s_add_u32 s51, s62, 680960
    buffer_load_dwordx4 v164, s[32:35], s51 offen lds
    s_add_u32 m0, s53, 32768
    s_add_u32 s51, s62, 680960
    buffer_load_dwordx4 v165, s[32:35], s51 offen lds
    s_add_u32 m0, s53, 33792
    s_add_u32 s51, s62, 680960
    buffer_load_dwordx4 v166, s[32:35], s51 offen lds
    s_add_u32 m0, s53, 34816
    s_add_u32 s51, s62, 680960
    buffer_load_dwordx4 v167, s[32:35], s51 offen lds
    s_add_u32 m0, s53, 40960
    s_add_u32 s51, s62, 762880
    buffer_load_dwordx4 v163, s[32:35], s51 offen lds
    s_add_u32 m0, s53, 41984
    s_add_u32 s51, s62, 762880
    buffer_load_dwordx4 v164, s[32:35], s51 offen lds
    s_cmp_lg_u32 s56, 0
    s_cbranch_scc1 L_wsk_94
    s_add_u32 m0, s53, 43008
    s_add_u32 s51, s62, 762880
    buffer_load_dwordx4 v165, s[32:35], s51 offen lds
L_wsk_94:
    s_cmp_lg_u32 s56, 0
    s_cbranch_scc1 L_wsk_95
    s_add_u32 m0, s53, 44032
    s_add_u32 s51, s62, 762880
    buffer_load_dwordx4 v166, s[32:35], s51 offen lds
L_wsk_95:
    s_cmp_lg_u32 s56, 0
    s_cbranch_scc1 L_wsk_96
    s_add_u32 m0, s53, 45056
    s_add_u32 s51, s62, 762880
    buffer_load_dwordx4 v167, s[32:35], s51 offen lds
L_wsk_96:
    s_waitcnt vmcnt(0)
L_exit:
    s_endpgm
.section .rodata,"a"
.p2align 6
.amdhsa_kernel concat_heads__softmax_full_mha__ssm_conv_h3__prompt_kernel
  .amdhsa_next_free_vgpr 168
  .amdhsa_next_free_sgpr 102
  .amdhsa_accum_offset 168
  .amdhsa_group_segment_fixed_size 0
  .amdhsa_kernarg_size 96
  .amdhsa_user_sgpr_count 2
  .amdhsa_user_sgpr_kernarg_segment_ptr 1
  .amdhsa_system_sgpr_workgroup_id_x 1
  .amdhsa_float_denorm_mode_32 3
.end_amdhsa_kernel
```
